```python
import torch

def _softmax(x, axis=-1):
    return torch.softmax(x, dim=axis)
def _gelu(x):
    return torch.nn.functional.gelu(x, approximate="tanh")
def _silu(x):
    return torch.nn.functional.silu(x)
def _sigmoid(x):
    return torch.sigmoid(x)
def _layernorm(x, axis=-1, eps=1e-5):
    m = x.mean(dim=axis, keepdim=True)
    v = x.var(dim=axis, keepdim=True, unbiased=False)
    return (x - m) / torch.sqrt(v + eps)
def _scatter_add(tgt, idx, src, axis=0):
    return tgt.clone().index_add_(axis, idx, src)
def _segment_sum(src, seg, n):
    out = torch.zeros((n,) + src.shape[1:], dtype=src.dtype)
    return out.index_add_(0, seg, src)
def _pad(x, pw):
    flat = tuple(v for pair in reversed(pw) for v in pair)
    return torch.nn.functional.pad(x, flat)

kernel_name = 'sequential_preLN__linear_attn_block__dense_activation_squared_relu__prompt'

def setup_inputs():

    _w = (lambda a: (lambda t: t.to(torch.bfloat16) if t.is_floating_point() else t)(torch.as_tensor(a)))
    def _A_setup():
        B, S, D = 1, 2048, 576
        return {
            "x": _w((lambda *s: torch.randn(*s, dtype=torch.bfloat16) * 0.05)(B, S, D)),
            "wqkv": _w((lambda *s: torch.randn(*s, dtype=torch.bfloat16) * 0.1)(D, 3 * D)),
            "wo": _w((lambda *s: torch.randn(*s, dtype=torch.bfloat16) * 0.05)(D, D)),
        }
    _A_in = _A_setup()

    def _B_setup():
        B, S, D, F = 1, 2048, 576, 4608
        return {
            "x": _w((lambda *s: torch.randn(*s, dtype=torch.bfloat16) * 0.05)(B, S, D)),
            "w1": _w((lambda *s: torch.randn(*s, dtype=torch.bfloat16) * 0.05)(D, F)),
            "b1": _w((lambda *s: torch.randn(*s, dtype=torch.bfloat16) * 0.2)(F)),
            "w2": _w((lambda *s: torch.randn(*s, dtype=torch.bfloat16) * 0.05)(F, D)),
            "b2": _w((lambda *s: torch.randn(*s, dtype=torch.bfloat16) * 1.6)(D)),
        }
    _B_in = _B_setup()

    return {
        "A_x": _A_in["x"],
        "A_wqkv": _A_in["wqkv"],
        "A_wo": _A_in["wo"],
        "B_x": _B_in["x"],
        "B_w1": _B_in["w1"],
        "B_b1": _B_in["b1"],
        "B_w2": _B_in["w2"],
        "B_b2": _B_in["b2"],
    }

def reference(A_x, A_wqkv, A_wo, B_x, B_w1, B_b1, B_w2, B_b2):
    def _A_ref(x, wqkv, wo):
        B, S, D = x.shape
        H = 32; Dh = D // H
        qkv = (lambda x, *d: x.permute(*d))((x @ wqkv).reshape(B, S, 3, H, Dh), 2, 0, 3, 1, 4)
        q, k, v = qkv[0], qkv[1], qkv[2]
        phi = lambda t: torch.where(t > 0, t + 1, torch.exp(t)) + 1e-6
        pq, pk = phi(q), phi(k)
        kv = torch.einsum("bhsd,bhse->bhde", pk, v)
        z = torch.einsum("bhsd->bhd", pk)
        num = torch.einsum("bhqd,bhde->bhqe", pq, kv)
        den = torch.einsum("bhqd,bhd->bhq", pq, z)[..., None] + 1e-6
        o = num / den
        return (lambda x, *d: x.permute(*d))(o, 0, 2, 1, 3).reshape(B, S, D) @ wo

    def _B_ref(x, w1, b1, w2, b2):
        h = torch.einsum("bsd,df->bsf", x, w1) + b1
        zero = torch.zeros_like(h)
        r = torch.where(h > zero, h, zero)
        h = r * r
        out = torch.einsum("bsf,fd->bsd", h, w2) + b2
        return out

    x = A_x
    h = x + _A_ref(_layernorm(x, axis=-1), A_wqkv, A_wo)
    h2 = h + _B_ref(_layernorm(h, axis=-1), B_w1, B_b1, B_w2, B_b2)
    return h2
```

```asm
; @launch kernel=qkv_kernel grid=(256,1,1) block=(256,1,1) lds=163840
; @launch kernel=attn_kernel grid=(256,1,1) block=(256,1,1) lds=160256
.amdgcn_target "amdgcn-amd-amdhsa--gfx950"
.text
.globl qkv_kernel
.p2align 8
.type qkv_kernel,@function
qkv_kernel:
  s_cmp_ge_u32 s2, 256
  s_cbranch_scc1 L_k1_end
  s_getpc_b64 s[4:5]
  L_k1_pc:
  s_lshr_b32 s3, s2, 3
  v_lshrrev_b32 v1, 3, v0
  s_lshl_b32 s3, s3, 5
  v_and_or_b32 v1, v0, 7, v1
  s_mov_b64 exec, 0xff
  v_add_lshl_u32 v1, v1, s3, 7
  v_min_u32 v1, L_code_end-L_k1_pc-4, v1
  global_load_dword v255, v1, s[4:5]
  s_mov_b64 exec, -1
  s_cmp_lt_u32 s2, 64
  s_cbranch_scc1 L_k1_sw
  s_load_dwordx2 s[8:9], s[0:1], 0
  s_load_dwordx2 s[12:13], s[0:1], 8
  s_load_dwordx4 s[4:7], s[0:1], 72
  v_lshrrev_b32 v2, 6, v0
  v_and_b32 v1, 63, v0
  v_readfirstlane_b32 s32, v2
  s_mov_b32 s10, 2359296
  s_mov_b32 s11, 0x20000
  s_mov_b32 s14, 1990656
  s_mov_b32 s15, 0x20000
  s_cmp_ge_u32 s2, 192
  s_cselect_b32 s37, 1, 0
  s_cselect_b32 s35, 128, 0
  s_sub_u32 s35, s2, s35
  s_sub_u32 s35, s35, 64
  s_lshr_b32 s35, s35, 3
  s_lshr_b32 s33, s35, 2
  s_and_b32 s35, s35, 3
  s_bfe_u32 s34, s2, 0x20001
  s_lshl_b32 s34, s34, 2
  s_add_u32 s34, s34, s35
  s_and_b32 s35, s2, 1
  s_sub_u32 s36, 2, s37
  s_lshl_b32 s35, s35, s36
  s_add_u32 s33, s33, s35
  s_lshl_b32 s35, s33, s37
  s_add_u32 s38, s34, s35
  s_mul_i32 s35, s38, 57
  s_lshr_b32 s35, s35, 9
  s_mul_i32 s35, s35, 9
  s_sub_u32 s38, s38, s35
  s_lshl_b32 s35, s34, 7
  s_lshl_b32 s36, s32, 5
  s_add_u32 s35, s35, s36
  v_lshrrev_b32 v2, 3, v1
  v_add_u32 v2, s35, v2
  v_mul_u32_u24 v2, 1152, v2
  v_lshrrev_b32 v5, 4, v1
  v_and_b32 v244, 7, v1
  v_xor_b32 v3, v5, v244
  v_lshl_add_u32 v7, v3, 4, v2
  v_xor_b32 v3, 4, v3
  v_lshl_add_u32 v8, v3, 4, v2
  v_add_u32 v8, 8192, v8
  s_lshl_b32 s48, s32, 12
  s_add_u32 s49, s48, 2048
  s_add_u32 s50, s48, 16384
  s_lshl_b32 s51, s32, 9
  s_add_u32 s51, s51, 32768
  s_lshl_b32 s44, s38, 7
  s_add_u32 s45, s44, 18432
  s_mul_i32 s46, s38, 221184
  s_mov_b32 s20, 0
  s_waitcnt lgkmcnt(0)
  s_and_b32 s9, s9, 0xffff
  s_and_b32 s13, s13, 0xffff
  s_add_u32 m0, s20, s48
  s_nop 0
  buffer_load_dwordx4 v7, s[8:11], s44 offen offset:0 lds
  buffer_load_dwordx4 v8, s[8:11], s44 offen offset:1024 lds
  s_add_u32 m0, s20, s49
  s_nop 0
  buffer_load_dwordx4 v7, s[8:11], s45 offen offset:0 lds
  buffer_load_dwordx4 v8, s[8:11], s45 offen offset:1024 lds
  s_mul_i32 s35, s33, 144
  s_add_u32 s72, s35, 1152
  s_lshl_b32 s35, s35, 1
  s_cmp_eq_u32 s37, 1
  s_cselect_b32 s72, s35, s72
  s_cselect_b32 s73, 0, 1008
  s_lshl_b32 s35, s32, 8
  s_add_u32 s35, s35, 0
  v_add_u32 v2, s35, v1
  v_mul_u32_u24 v3, 3641, v2
  v_lshrrev_b32 v3, 16, v3
  v_mul_u32_u24 v244, 18, v3
  v_sub_u32 v2, v2, v244
  v_and_b32 v244, 0x33, v3
  v_bfe_u32 v245, v3, 2, 1
  v_lshl_or_b32 v244, v245, 3, v244
  v_bfe_u32 v245, v3, 3, 1
  v_lshl_or_b32 v244, v245, 2, v244
  v_mul_u32_u24 v244, 3456, v244
  v_lshl_add_u32 v244, v2, 4, v244
  v_cmp_lt_u32 vcc, 8, v2
  v_add_u32 v244, s72, v244
  v_add_u32 v245, s73, v244
  v_cndmask_b32 v9, v244, v245, vcc
  s_add_u32 m0, s20, s50
  s_nop 0
  buffer_load_dwordx4 v9, s[12:15], s46 offen offset:0 lds
  s_lshl_b32 s35, s32, 8
  s_add_u32 s35, s35, 64
  v_add_u32 v2, s35, v1
  v_mul_u32_u24 v3, 3641, v2
  v_lshrrev_b32 v3, 16, v3
  v_mul_u32_u24 v244, 18, v3
  v_sub_u32 v2, v2, v244
  v_and_b32 v244, 0x33, v3
  v_bfe_u32 v245, v3, 2, 1
  v_lshl_or_b32 v244, v245, 3, v244
  v_bfe_u32 v245, v3, 3, 1
  v_lshl_or_b32 v244, v245, 2, v244
  v_mul_u32_u24 v244, 3456, v244
  v_lshl_add_u32 v244, v2, 4, v244
  v_cmp_lt_u32 vcc, 8, v2
  v_add_u32 v244, s72, v244
  v_add_u32 v245, s73, v244
  v_cndmask_b32 v10, v244, v245, vcc
  v_subrev_u32 v10, 1024, v10
  buffer_load_dwordx4 v10, s[12:15], s46 offen offset:1024 lds
  s_lshl_b32 s35, s32, 8
  s_add_u32 s35, s35, 128
  v_add_u32 v2, s35, v1
  v_mul_u32_u24 v3, 3641, v2
  v_lshrrev_b32 v3, 16, v3
  v_mul_u32_u24 v244, 18, v3
  v_sub_u32 v2, v2, v244
  v_and_b32 v244, 0x33, v3
  v_bfe_u32 v245, v3, 2, 1
  v_lshl_or_b32 v244, v245, 3, v244
  v_bfe_u32 v245, v3, 3, 1
  v_lshl_or_b32 v244, v245, 2, v244
  v_mul_u32_u24 v244, 3456, v244
  v_lshl_add_u32 v244, v2, 4, v244
  v_cmp_lt_u32 vcc, 8, v2
  v_add_u32 v244, s72, v244
  v_add_u32 v245, s73, v244
  v_cndmask_b32 v11, v244, v245, vcc
  v_subrev_u32 v11, 2048, v11
  buffer_load_dwordx4 v11, s[12:15], s46 offen offset:2048 lds
  s_lshl_b32 s35, s32, 8
  s_add_u32 s35, s35, 192
  v_add_u32 v2, s35, v1
  v_mul_u32_u24 v3, 3641, v2
  v_lshrrev_b32 v3, 16, v3
  v_mul_u32_u24 v244, 18, v3
  v_sub_u32 v2, v2, v244
  v_and_b32 v244, 0x33, v3
  v_bfe_u32 v245, v3, 2, 1
  v_lshl_or_b32 v244, v245, 3, v244
  v_bfe_u32 v245, v3, 3, 1
  v_lshl_or_b32 v244, v245, 2, v244
  v_mul_u32_u24 v244, 3456, v244
  v_lshl_add_u32 v244, v2, 4, v244
  v_cmp_lt_u32 vcc, 8, v2
  v_add_u32 v244, s72, v244
  v_add_u32 v245, s73, v244
  v_cndmask_b32 v12, v244, v245, vcc
  v_subrev_u32 v12, 3072, v12
  buffer_load_dwordx4 v12, s[12:15], s46 offen offset:3072 lds
  s_lshl_b32 s35, s32, 5
  s_add_u32 s35, s35, 1024
  v_add_u32 v2, s35, v1
  v_mul_u32_u24 v3, 3641, v2
  v_lshrrev_b32 v3, 16, v3
  v_mul_u32_u24 v244, 18, v3
  v_sub_u32 v2, v2, v244
  v_and_b32 v244, 0x33, v3
  v_bfe_u32 v245, v3, 2, 1
  v_lshl_or_b32 v244, v245, 3, v244
  v_bfe_u32 v245, v3, 3, 1
  v_lshl_or_b32 v244, v245, 2, v244
  v_mul_u32_u24 v244, 3456, v244
  v_lshl_add_u32 v244, v2, 4, v244
  v_cmp_lt_u32 vcc, 8, v2
  v_add_u32 v244, s72, v244
  v_add_u32 v245, s73, v244
  v_cndmask_b32 v13, v244, v245, vcc
  s_add_u32 m0, s20, s51
  s_mov_b32 exec_hi, 0
  buffer_load_dwordx4 v13, s[12:15], s46 offen lds
  s_mov_b32 exec_hi, -1
  s_add_u32 s44, s44, 128
  s_cmp_eq_u32 s44, 1152
  s_cselect_b32 s44, 0, s44
  s_mul_i32 s46, s44, 1728
  s_add_u32 s45, s44, 18432
  s_add_u32 s20, s20, 34816
  v_and_b32 v6, 15, v0
  v_lshlrev_b32 v4, 4, v1
  v_lshrrev_b32 v2, 1, v6
  v_xor_b32 v2, v2, v5
  v_lshlrev_b32 v2, 4, v2
  v_lshl_add_u32 v2, v6, 7, v2
  s_add_u32 m0, s20, s48
  s_nop 0
  buffer_load_dwordx4 v7, s[8:11], s44 offen offset:0 lds
  v_xor_b32 v3, 64, v2
  s_add_u32 s28, s32, 0
  s_and_b32 s28, s28, 3
  s_lshl_b32 s35, s28, 12
  v_add_u32 v14, s35, v2
  v_add_u32 v18, s35, v3
  buffer_load_dwordx4 v8, s[8:11], s44 offen offset:1024 lds
  s_add_u32 s29, s32, 1
  s_and_b32 s29, s29, 3
  s_lshl_b32 s35, s29, 12
  v_add_u32 v15, s35, v2
  v_add_u32 v19, s35, v3
  s_add_u32 s30, s32, 2
  s_add_u32 m0, s20, s49
  s_nop 0
  buffer_load_dwordx4 v7, s[8:11], s45 offen offset:0 lds
  s_and_b32 s30, s30, 3
  s_lshl_b32 s35, s30, 12
  v_add_u32 v16, s35, v2
  v_add_u32 v20, s35, v3
  s_add_u32 s31, s32, 3
  s_and_b32 s31, s31, 3
  buffer_load_dwordx4 v8, s[8:11], s45 offen offset:1024 lds
  s_lshl_b32 s35, s31, 12
  v_add_u32 v17, s35, v2
  v_add_u32 v21, s35, v3
  v_bfe_u32 v2, v1, 2, 2
  v_lshrrev_b32 v3, 1, v5
  v_lshl_add_u32 v2, v3, 4, v2
  s_add_u32 m0, s20, s50
  s_nop 0
  buffer_load_dwordx4 v9, s[12:15], s46 offen offset:0 lds
  v_and_b32 v3, 1, v5
  v_lshl_add_u32 v2, v3, 2, v2
  v_mul_u32_u24 v2, 288, v2
  v_add_u32 v2, 16384, v2
  v_and_b32 v3, 3, v1
  v_lshl_add_u32 v244, v3, 3, v2
  buffer_load_dwordx4 v10, s[12:15], s46 offen offset:1024 lds
  v_mul_u32_u24 v3, 72, v3
  v_add3_u32 v24, v2, v3, 32
  s_lshr_b32 s35, s32, 1
  s_mul_i32 s35, s35, 72
  s_and_b32 s36, s32, 1
  s_mul_i32 s36, s36, 40
  buffer_load_dwordx4 v11, s[12:15], s46 offen offset:2048 lds
  s_add_u32 s35, s35, s36
  s_add_u32 s36, s35, 144
  s_mul_i32 s72, s32, 72
  s_add_u32 s72, s72, 40
  s_mul_i32 s73, s29, 72
  s_cmp_eq_u32 s37, 1
  s_cselect_b32 s35, s72, s35
  s_cselect_b32 s36, s73, s36
  buffer_load_dwordx4 v12, s[12:15], s46 offen offset:3072 lds
  v_add_u32 v22, s35, v244
  v_add_u32 v23, s36, v244
  s_mov_b32 s22, s35
  s_mov_b32 s23, s36
  v_add_u32 v25, 9216, v22
  v_add_u32 v26, 9216, v23
  s_add_u32 m0, s20, s51
  s_mov_b32 exec_hi, 0
  buffer_load_dwordx4 v13, s[12:15], s46 offen lds
  s_mov_b32 exec_hi, -1
  v_add_u32 v27, 9216, v24
  s_mov_b32 s21, 0
  s_mov_b32 s56, 69632
  s_mov_b32 s39, 0x3f803f80
  s_mov_b32 s54, 0x3fb8aa3b
  s_mov_b32 s55, 0x358637bd
  v_mov_b32 v52, s39
  v_mov_b32 v53, s39
  v_mov_b32 v54, s39
  v_mov_b32 v55, s39
  s_add_u32 s44, s44, 128
  s_cmp_eq_u32 s44, 1152
  s_cselect_b32 s44, 0, s44
  s_mul_i32 s46, s44, 1728
  s_add_u32 s45, s44, 18432
  s_add_u32 s20, s20, 34816
  s_cmp_eq_u32 s37, 1
  s_cbranch_scc1 L_k1_q
  s_waitcnt vmcnt(9)
  s_barrier
  ds_read_b64_tr_b16 v[220:221], v22 offset:0
  ds_read_b64_tr_b16 v[222:223], v22 offset:2304
  ds_read_b64_tr_b16 v[224:225], v23 offset:0
  ds_read_b64_tr_b16 v[226:227], v23 offset:2304
  ds_read_b128 v[156:159], v14 offset:0
  ds_read_b128 v[160:163], v14 offset:2048
  ds_read_b64_tr_b16 v[228:229], v24 offset:0
  ds_read_b64_tr_b16 v[230:231], v24 offset:2304
  ds_read_b128 v[164:167], v15 offset:0
  ds_read_b128 v[168:171], v15 offset:2048
  ds_read_b128 v[172:175], v16 offset:0
  ds_read_b128 v[176:179], v16 offset:2048
  ds_read_b128 v[180:183], v17 offset:0
  ds_read_b128 v[184:187], v17 offset:2048
  s_add_u32 m0, s20, s48
  s_nop 0
  buffer_load_dwordx4 v7, s[8:11], s44 offen offset:0 lds
  buffer_load_dwordx4 v8, s[8:11], s44 offen offset:1024 lds
  s_add_u32 m0, s20, s49
  s_nop 0
  buffer_load_dwordx4 v7, s[8:11], s45 offen offset:0 lds
  buffer_load_dwordx4 v8, s[8:11], s45 offen offset:1024 lds
  s_waitcnt lgkmcnt(8)
  v_mfma_f32_16x16x32_bf16 v[84:87], v[156:159], v[220:223], 0
  v_mfma_f32_16x16x32_bf16 v[116:119], v[156:159], v[224:227], 0
  ds_read_b64_tr_b16 v[232:233], v25 offset:0
  s_add_u32 m0, s20, s50
  v_mfma_f32_16x16x32_bf16 v[64:67], v[156:159], v[156:159], 0
  ds_read_b64_tr_b16 v[234:235], v25 offset:2304
  buffer_load_dwordx4 v9, s[12:15], s46 offen offset:0 lds
  v_mfma_f32_16x16x32_bf16 v[56:59], v[52:55], v[156:159], 0
  ds_read_b64_tr_b16 v[236:237], v26 offset:0
  v_mfma_f32_16x16x32_bf16 v[88:91], v[160:163], v[220:223], 0
  ds_read_b64_tr_b16 v[238:239], v26 offset:2304
  v_mfma_f32_16x16x32_bf16 v[120:123], v[160:163], v[224:227], 0
  buffer_load_dwordx4 v10, s[12:15], s46 offen offset:1024 lds
  v_mfma_f32_16x16x32_bf16 v[68:71], v[160:163], v[160:163], 0
  ds_read_b128 v[188:191], v18 offset:0
  v_mfma_f32_16x16x32_bf16 v[60:63], v[52:55], v[160:163], 0
  ds_read_b128 v[192:195], v18 offset:2048
  s_waitcnt lgkmcnt(12)
  v_mfma_f32_16x16x32_bf16 v[148:151], v[156:159], v[228:231], 0
  ds_read_b64_tr_b16 v[240:241], v27 offset:0
  v_mfma_f32_16x16x32_bf16 v[152:155], v[160:163], v[228:231], 0
  buffer_load_dwordx4 v11, s[12:15], s46 offen offset:2048 lds
  s_waitcnt lgkmcnt(10)
  v_mfma_f32_16x16x32_bf16 v[92:95], v[164:167], v[220:223], 0
  ds_read_b64_tr_b16 v[242:243], v27 offset:2304
  v_mfma_f32_16x16x32_bf16 v[124:127], v[164:167], v[224:227], 0
  ds_read_b128 v[196:199], v19 offset:0
  v_mfma_f32_16x16x32_bf16 v[96:99], v[168:171], v[220:223], 0
  ds_read_b128 v[200:203], v19 offset:2048
  buffer_load_dwordx4 v12, s[12:15], s46 offen offset:3072 lds
  v_mfma_f32_16x16x32_bf16 v[128:131], v[168:171], v[224:227], 0
  ds_read_b128 v[204:207], v20 offset:0
  v_mfma_f32_16x16x32_bf16 v[100:103], v[172:175], v[220:223], 0
  v_mfma_f32_16x16x32_bf16 v[132:135], v[172:175], v[224:227], 0
  ds_read_b128 v[208:211], v20 offset:2048
  s_add_u32 m0, s20, s51
  s_waitcnt lgkmcnt(12)
  v_mfma_f32_16x16x32_bf16 v[104:107], v[176:179], v[220:223], 0
  ds_read_b128 v[212:215], v21 offset:0
  s_mov_b32 exec_hi, 0
  buffer_load_dwordx4 v13, s[12:15], s46 offen lds
  s_mov_b32 exec_hi, -1
  v_mfma_f32_16x16x32_bf16 v[136:139], v[176:179], v[224:227], 0
  ds_read_b128 v[216:219], v21 offset:2048
  s_add_u32 s44, s44, 128
  v_mfma_f32_16x16x32_bf16 v[108:111], v[180:183], v[220:223], 0
  s_cmp_eq_u32 s44, 1152
  s_cselect_b32 s44, 0, s44
  v_mfma_f32_16x16x32_bf16 v[140:143], v[180:183], v[224:227], 0
  s_mul_i32 s46, s44, 1728
  v_mfma_f32_16x16x32_bf16 v[112:115], v[184:187], v[220:223], 0
  s_add_u32 s45, s44, 18432
  v_mfma_f32_16x16x32_bf16 v[144:147], v[184:187], v[224:227], 0
  s_add_u32 s20, s20, 34816
  s_waitcnt lgkmcnt(8)
  v_mfma_f32_16x16x32_bf16 v[84:87], v[188:191], v[232:235], v[84:87]
  s_waitcnt vmcnt(9)
  s_barrier
  v_mfma_f32_16x16x32_bf16 v[116:119], v[188:191], v[236:239], v[116:119]
  ds_read_b64_tr_b16 v[220:221], v22 offset:34816
  s_add_u32 m0, s20, s48
  v_mfma_f32_16x16x32_bf16 v[64:67], v[188:191], v[188:191], v[64:67]
  ds_read_b64_tr_b16 v[222:223], v22 offset:37120
  buffer_load_dwordx4 v7, s[8:11], s44 offen offset:0 lds
  v_mfma_f32_16x16x32_bf16 v[56:59], v[52:55], v[188:191], v[56:59]
  ds_read_b64_tr_b16 v[224:225], v23 offset:34816
  v_mfma_f32_16x16x32_bf16 v[88:91], v[192:195], v[232:235], v[88:91]
  ds_read_b64_tr_b16 v[226:227], v23 offset:37120
  v_mfma_f32_16x16x32_bf16 v[120:123], v[192:195], v[236:239], v[120:123]
  buffer_load_dwordx4 v8, s[8:11], s44 offen offset:1024 lds
  v_mfma_f32_16x16x32_bf16 v[68:71], v[192:195], v[192:195], v[68:71]
  ds_read_b128 v[156:159], v14 offset:34816
  v_mfma_f32_16x16x32_bf16 v[60:63], v[52:55], v[192:195], v[60:63]
  ds_read_b128 v[160:163], v14 offset:36864
  s_waitcnt lgkmcnt(12)
  v_mfma_f32_16x16x32_bf16 v[148:151], v[188:191], v[240:243], v[148:151]
  ds_read_b64_tr_b16 v[228:229], v24 offset:34816
  s_add_u32 m0, s20, s49
  v_mfma_f32_16x16x32_bf16 v[152:155], v[192:195], v[240:243], v[152:155]
  buffer_load_dwordx4 v7, s[8:11], s45 offen offset:0 lds
  s_waitcnt lgkmcnt(10)
  v_mfma_f32_16x16x32_bf16 v[92:95], v[196:199], v[232:235], v[92:95]
  ds_read_b64_tr_b16 v[230:231], v24 offset:37120
  v_mfma_f32_16x16x32_bf16 v[124:127], v[196:199], v[236:239], v[124:127]
  ds_read_b128 v[164:167], v15 offset:34816
  v_mfma_f32_16x16x32_bf16 v[96:99], v[200:203], v[232:235], v[96:99]
  ds_read_b128 v[168:171], v15 offset:36864
  buffer_load_dwordx4 v8, s[8:11], s45 offen offset:1024 lds
  v_mfma_f32_16x16x32_bf16 v[128:131], v[200:203], v[236:239], v[128:131]
  ds_read_b128 v[172:175], v16 offset:34816
  v_mfma_f32_16x16x32_bf16 v[100:103], v[204:207], v[232:235], v[100:103]
  v_mfma_f32_16x16x32_bf16 v[132:135], v[204:207], v[236:239], v[132:135]
  ds_read_b128 v[176:179], v16 offset:36864
  s_waitcnt lgkmcnt(12)
  v_mfma_f32_16x16x32_bf16 v[104:107], v[208:211], v[232:235], v[104:107]
  ds_read_b128 v[180:183], v17 offset:34816
  v_mfma_f32_16x16x32_bf16 v[136:139], v[208:211], v[236:239], v[136:139]
  ds_read_b128 v[184:187], v17 offset:36864
  v_mfma_f32_16x16x32_bf16 v[108:111], v[212:215], v[232:235], v[108:111]
  v_mfma_f32_16x16x32_bf16 v[140:143], v[212:215], v[236:239], v[140:143]
  v_mfma_f32_16x16x32_bf16 v[112:115], v[216:219], v[232:235], v[112:115]
  v_mfma_f32_16x16x32_bf16 v[144:147], v[216:219], v[236:239], v[144:147]
L_k1_loop0:
  s_waitcnt lgkmcnt(8)
  v_mfma_f32_16x16x32_bf16 v[84:87], v[156:159], v[220:223], v[84:87]
  v_mfma_f32_16x16x32_bf16 v[116:119], v[156:159], v[224:227], v[116:119]
  ds_read_b64_tr_b16 v[232:233], v25 offset:34816
  s_add_u32 m0, s20, s50
  v_mfma_f32_16x16x32_bf16 v[64:67], v[156:159], v[156:159], v[64:67]
  ds_read_b64_tr_b16 v[234:235], v25 offset:37120
  buffer_load_dwordx4 v9, s[12:15], s46 offen offset:0 lds
  v_mfma_f32_16x16x32_bf16 v[56:59], v[52:55], v[156:159], v[56:59]
  ds_read_b64_tr_b16 v[236:237], v26 offset:34816
  v_add_u32 v14, s56, v14
  v_mfma_f32_16x16x32_bf16 v[88:91], v[160:163], v[220:223], v[88:91]
  ds_read_b64_tr_b16 v[238:239], v26 offset:37120
  v_add_u32 v15, s56, v15
  v_mfma_f32_16x16x32_bf16 v[120:123], v[160:163], v[224:227], v[120:123]
  buffer_load_dwordx4 v10, s[12:15], s46 offen offset:1024 lds
  v_add_u32 v16, s56, v16
  v_mfma_f32_16x16x32_bf16 v[68:71], v[160:163], v[160:163], v[68:71]
  ds_read_b128 v[188:191], v18 offset:34816
  v_add_u32 v17, s56, v17
  v_mfma_f32_16x16x32_bf16 v[60:63], v[52:55], v[160:163], v[60:63]
  ds_read_b128 v[192:195], v18 offset:36864
  v_add_u32 v22, s56, v22
  s_waitcnt lgkmcnt(12)
  v_mfma_f32_16x16x32_bf16 v[148:151], v[156:159], v[228:231], v[148:151]
  ds_read_b64_tr_b16 v[240:241], v27 offset:34816
  v_add_u32 v23, s56, v23
  v_mfma_f32_16x16x32_bf16 v[152:155], v[160:163], v[228:231], v[152:155]
  buffer_load_dwordx4 v11, s[12:15], s46 offen offset:2048 lds
  v_add_u32 v24, s56, v24
  s_waitcnt lgkmcnt(10)
  v_mfma_f32_16x16x32_bf16 v[92:95], v[164:167], v[220:223], v[92:95]
  ds_read_b64_tr_b16 v[242:243], v27 offset:37120
  v_mfma_f32_16x16x32_bf16 v[124:127], v[164:167], v[224:227], v[124:127]
  ds_read_b128 v[196:199], v19 offset:34816
  v_mfma_f32_16x16x32_bf16 v[96:99], v[168:171], v[220:223], v[96:99]
  ds_read_b128 v[200:203], v19 offset:36864
  buffer_load_dwordx4 v12, s[12:15], s46 offen offset:3072 lds
  v_mfma_f32_16x16x32_bf16 v[128:131], v[168:171], v[224:227], v[128:131]
  ds_read_b128 v[204:207], v20 offset:34816
  v_mfma_f32_16x16x32_bf16 v[100:103], v[172:175], v[220:223], v[100:103]
  v_mfma_f32_16x16x32_bf16 v[132:135], v[172:175], v[224:227], v[132:135]
  ds_read_b128 v[208:211], v20 offset:36864
  s_add_u32 m0, s20, s51
  s_waitcnt lgkmcnt(12)
  v_mfma_f32_16x16x32_bf16 v[104:107], v[176:179], v[220:223], v[104:107]
  ds_read_b128 v[212:215], v21 offset:34816
  s_mov_b32 exec_hi, 0
  buffer_load_dwordx4 v13, s[12:15], s46 offen lds
  s_mov_b32 exec_hi, -1
  v_mfma_f32_16x16x32_bf16 v[136:139], v[176:179], v[224:227], v[136:139]
  ds_read_b128 v[216:219], v21 offset:36864
  s_add_u32 s44, s44, 128
  v_mfma_f32_16x16x32_bf16 v[108:111], v[180:183], v[220:223], v[108:111]
  s_cmp_eq_u32 s44, 1152
  s_cselect_b32 s44, 0, s44
  v_mfma_f32_16x16x32_bf16 v[140:143], v[180:183], v[224:227], v[140:143]
  s_mul_i32 s46, s44, 1728
  v_mfma_f32_16x16x32_bf16 v[112:115], v[184:187], v[220:223], v[112:115]
  s_add_u32 s45, s44, 18432
  v_mfma_f32_16x16x32_bf16 v[144:147], v[184:187], v[224:227], v[144:147]
  s_add_u32 s20, s20, 34816
  s_cmp_eq_u32 s20, 139264
  s_cselect_b32 s20, 0, s20
  s_waitcnt lgkmcnt(8)
  v_mfma_f32_16x16x32_bf16 v[84:87], v[188:191], v[232:235], v[84:87]
  s_waitcnt vmcnt(9)
  s_barrier
  v_mfma_f32_16x16x32_bf16 v[116:119], v[188:191], v[236:239], v[116:119]
  ds_read_b64_tr_b16 v[220:221], v22 offset:0
  s_add_u32 m0, s20, s48
  v_mfma_f32_16x16x32_bf16 v[64:67], v[188:191], v[188:191], v[64:67]
  ds_read_b64_tr_b16 v[222:223], v22 offset:2304
  buffer_load_dwordx4 v7, s[8:11], s44 offen offset:0 lds
  v_mfma_f32_16x16x32_bf16 v[56:59], v[52:55], v[188:191], v[56:59]
  ds_read_b64_tr_b16 v[224:225], v23 offset:0
  v_add_u32 v18, s56, v18
  v_mfma_f32_16x16x32_bf16 v[88:91], v[192:195], v[232:235], v[88:91]
  ds_read_b64_tr_b16 v[226:227], v23 offset:2304
  v_add_u32 v19, s56, v19
  v_mfma_f32_16x16x32_bf16 v[120:123], v[192:195], v[236:239], v[120:123]
  buffer_load_dwordx4 v8, s[8:11], s44 offen offset:1024 lds
  v_add_u32 v20, s56, v20
  v_mfma_f32_16x16x32_bf16 v[68:71], v[192:195], v[192:195], v[68:71]
  ds_read_b128 v[156:159], v14 offset:0
  v_add_u32 v21, s56, v21
  v_mfma_f32_16x16x32_bf16 v[60:63], v[52:55], v[192:195], v[60:63]
  ds_read_b128 v[160:163], v14 offset:2048
  v_add_u32 v25, s56, v25
  s_waitcnt lgkmcnt(12)
  v_mfma_f32_16x16x32_bf16 v[148:151], v[188:191], v[240:243], v[148:151]
  ds_read_b64_tr_b16 v[228:229], v24 offset:0
  s_add_u32 m0, s20, s49
  v_mfma_f32_16x16x32_bf16 v[152:155], v[192:195], v[240:243], v[152:155]
  buffer_load_dwordx4 v7, s[8:11], s45 offen offset:0 lds
  v_add_u32 v26, s56, v26
  s_waitcnt lgkmcnt(10)
  v_mfma_f32_16x16x32_bf16 v[92:95], v[196:199], v[232:235], v[92:95]
  ds_read_b64_tr_b16 v[230:231], v24 offset:2304
  v_add_u32 v27, s56, v27
  v_mfma_f32_16x16x32_bf16 v[124:127], v[196:199], v[236:239], v[124:127]
  ds_read_b128 v[164:167], v15 offset:0
  s_sub_u32 s56, 0, s56
  v_mfma_f32_16x16x32_bf16 v[96:99], v[200:203], v[232:235], v[96:99]
  ds_read_b128 v[168:171], v15 offset:2048
  buffer_load_dwordx4 v8, s[8:11], s45 offen offset:1024 lds
  v_mfma_f32_16x16x32_bf16 v[128:131], v[200:203], v[236:239], v[128:131]
  ds_read_b128 v[172:175], v16 offset:0
  v_mfma_f32_16x16x32_bf16 v[100:103], v[204:207], v[232:235], v[100:103]
  v_mfma_f32_16x16x32_bf16 v[132:135], v[204:207], v[236:239], v[132:135]
  ds_read_b128 v[176:179], v16 offset:2048
  s_waitcnt lgkmcnt(12)
  v_mfma_f32_16x16x32_bf16 v[104:107], v[208:211], v[232:235], v[104:107]
  ds_read_b128 v[180:183], v17 offset:0
  v_mfma_f32_16x16x32_bf16 v[136:139], v[208:211], v[236:239], v[136:139]
  ds_read_b128 v[184:187], v17 offset:2048
  v_mfma_f32_16x16x32_bf16 v[108:111], v[212:215], v[232:235], v[108:111]
  v_mfma_f32_16x16x32_bf16 v[140:143], v[212:215], v[236:239], v[140:143]
  v_mfma_f32_16x16x32_bf16 v[112:115], v[216:219], v[232:235], v[112:115]
  v_mfma_f32_16x16x32_bf16 v[144:147], v[216:219], v[236:239], v[144:147]
  s_waitcnt lgkmcnt(8)
  v_mfma_f32_16x16x32_bf16 v[84:87], v[156:159], v[220:223], v[84:87]
  v_mfma_f32_16x16x32_bf16 v[116:119], v[156:159], v[224:227], v[116:119]
  ds_read_b64_tr_b16 v[232:233], v25 offset:0
  s_add_u32 m0, s20, s50
  v_mfma_f32_16x16x32_bf16 v[64:67], v[156:159], v[156:159], v[64:67]
  ds_read_b64_tr_b16 v[234:235], v25 offset:2304
  buffer_load_dwordx4 v9, s[12:15], s46 offen offset:0 lds
  v_mfma_f32_16x16x32_bf16 v[56:59], v[52:55], v[156:159], v[56:59]
  ds_read_b64_tr_b16 v[236:237], v26 offset:0
  v_mfma_f32_16x16x32_bf16 v[88:91], v[160:163], v[220:223], v[88:91]
  ds_read_b64_tr_b16 v[238:239], v26 offset:2304
  v_mfma_f32_16x16x32_bf16 v[120:123], v[160:163], v[224:227], v[120:123]
  buffer_load_dwordx4 v10, s[12:15], s46 offen offset:1024 lds
  v_mfma_f32_16x16x32_bf16 v[68:71], v[160:163], v[160:163], v[68:71]
  ds_read_b128 v[188:191], v18 offset:0
  v_mfma_f32_16x16x32_bf16 v[60:63], v[52:55], v[160:163], v[60:63]
  ds_read_b128 v[192:195], v18 offset:2048
  s_waitcnt lgkmcnt(12)
  v_mfma_f32_16x16x32_bf16 v[148:151], v[156:159], v[228:231], v[148:151]
  ds_read_b64_tr_b16 v[240:241], v27 offset:0
  v_mfma_f32_16x16x32_bf16 v[152:155], v[160:163], v[228:231], v[152:155]
  buffer_load_dwordx4 v11, s[12:15], s46 offen offset:2048 lds
  s_waitcnt lgkmcnt(10)
  v_mfma_f32_16x16x32_bf16 v[92:95], v[164:167], v[220:223], v[92:95]
  ds_read_b64_tr_b16 v[242:243], v27 offset:2304
  v_mfma_f32_16x16x32_bf16 v[124:127], v[164:167], v[224:227], v[124:127]
  ds_read_b128 v[196:199], v19 offset:0
  v_mfma_f32_16x16x32_bf16 v[96:99], v[168:171], v[220:223], v[96:99]
  ds_read_b128 v[200:203], v19 offset:2048
  buffer_load_dwordx4 v12, s[12:15], s46 offen offset:3072 lds
  v_mfma_f32_16x16x32_bf16 v[128:131], v[168:171], v[224:227], v[128:131]
  ds_read_b128 v[204:207], v20 offset:0
  v_mfma_f32_16x16x32_bf16 v[100:103], v[172:175], v[220:223], v[100:103]
  v_mfma_f32_16x16x32_bf16 v[132:135], v[172:175], v[224:227], v[132:135]
  ds_read_b128 v[208:211], v20 offset:2048
  s_add_u32 m0, s20, s51
  s_waitcnt lgkmcnt(12)
  v_mfma_f32_16x16x32_bf16 v[104:107], v[176:179], v[220:223], v[104:107]
  ds_read_b128 v[212:215], v21 offset:0
  s_mov_b32 exec_hi, 0
  buffer_load_dwordx4 v13, s[12:15], s46 offen lds
  s_mov_b32 exec_hi, -1
  v_mfma_f32_16x16x32_bf16 v[136:139], v[176:179], v[224:227], v[136:139]
  ds_read_b128 v[216:219], v21 offset:2048
  s_add_u32 s44, s44, 128
  v_mfma_f32_16x16x32_bf16 v[108:111], v[180:183], v[220:223], v[108:111]
  s_cmp_eq_u32 s44, 1152
  s_cselect_b32 s44, 0, s44
  v_mfma_f32_16x16x32_bf16 v[140:143], v[180:183], v[224:227], v[140:143]
  s_mul_i32 s46, s44, 1728
  v_mfma_f32_16x16x32_bf16 v[112:115], v[184:187], v[220:223], v[112:115]
  s_add_u32 s45, s44, 18432
  v_mfma_f32_16x16x32_bf16 v[144:147], v[184:187], v[224:227], v[144:147]
  s_add_u32 s20, s20, 34816
  s_cmp_eq_u32 s21, 2
  s_cselect_b32 s10, 0, s10
  s_cselect_b32 s14, 0, s14
  s_waitcnt lgkmcnt(8)
  v_mfma_f32_16x16x32_bf16 v[84:87], v[188:191], v[232:235], v[84:87]
  s_waitcnt vmcnt(9)
  s_barrier
  v_mfma_f32_16x16x32_bf16 v[116:119], v[188:191], v[236:239], v[116:119]
  ds_read_b64_tr_b16 v[220:221], v22 offset:34816
  s_add_u32 m0, s20, s48
  v_mfma_f32_16x16x32_bf16 v[64:67], v[188:191], v[188:191], v[64:67]
  ds_read_b64_tr_b16 v[222:223], v22 offset:37120
  buffer_load_dwordx4 v7, s[8:11], s44 offen offset:0 lds
  v_mfma_f32_16x16x32_bf16 v[56:59], v[52:55], v[188:191], v[56:59]
  ds_read_b64_tr_b16 v[224:225], v23 offset:34816
  v_mfma_f32_16x16x32_bf16 v[88:91], v[192:195], v[232:235], v[88:91]
  ds_read_b64_tr_b16 v[226:227], v23 offset:37120
  v_mfma_f32_16x16x32_bf16 v[120:123], v[192:195], v[236:239], v[120:123]
  buffer_load_dwordx4 v8, s[8:11], s44 offen offset:1024 lds
  v_mfma_f32_16x16x32_bf16 v[68:71], v[192:195], v[192:195], v[68:71]
  ds_read_b128 v[156:159], v14 offset:34816
  v_mfma_f32_16x16x32_bf16 v[60:63], v[52:55], v[192:195], v[60:63]
  ds_read_b128 v[160:163], v14 offset:36864
  s_waitcnt lgkmcnt(12)
  v_mfma_f32_16x16x32_bf16 v[148:151], v[188:191], v[240:243], v[148:151]
  ds_read_b64_tr_b16 v[228:229], v24 offset:34816
  s_add_u32 m0, s20, s49
  v_mfma_f32_16x16x32_bf16 v[152:155], v[192:195], v[240:243], v[152:155]
  buffer_load_dwordx4 v7, s[8:11], s45 offen offset:0 lds
  s_waitcnt lgkmcnt(10)
  v_mfma_f32_16x16x32_bf16 v[92:95], v[196:199], v[232:235], v[92:95]
  ds_read_b64_tr_b16 v[230:231], v24 offset:37120
  v_mfma_f32_16x16x32_bf16 v[124:127], v[196:199], v[236:239], v[124:127]
  ds_read_b128 v[164:167], v15 offset:34816
  v_mfma_f32_16x16x32_bf16 v[96:99], v[200:203], v[232:235], v[96:99]
  ds_read_b128 v[168:171], v15 offset:36864
  buffer_load_dwordx4 v8, s[8:11], s45 offen offset:1024 lds
  v_mfma_f32_16x16x32_bf16 v[128:131], v[200:203], v[236:239], v[128:131]
  ds_read_b128 v[172:175], v16 offset:34816
  v_mfma_f32_16x16x32_bf16 v[100:103], v[204:207], v[232:235], v[100:103]
  v_mfma_f32_16x16x32_bf16 v[132:135], v[204:207], v[236:239], v[132:135]
  ds_read_b128 v[176:179], v16 offset:36864
  s_waitcnt lgkmcnt(12)
  v_mfma_f32_16x16x32_bf16 v[104:107], v[208:211], v[232:235], v[104:107]
  ds_read_b128 v[180:183], v17 offset:34816
  v_mfma_f32_16x16x32_bf16 v[136:139], v[208:211], v[236:239], v[136:139]
  ds_read_b128 v[184:187], v17 offset:36864
  v_mfma_f32_16x16x32_bf16 v[108:111], v[212:215], v[232:235], v[108:111]
  v_mfma_f32_16x16x32_bf16 v[140:143], v[212:215], v[236:239], v[140:143]
  v_mfma_f32_16x16x32_bf16 v[112:115], v[216:219], v[232:235], v[112:115]
  v_mfma_f32_16x16x32_bf16 v[144:147], v[216:219], v[236:239], v[144:147]
  s_add_u32 s21, s21, 1
  s_cmp_lt_u32 s21, 3
  s_cbranch_scc1 L_k1_loop0
  s_waitcnt lgkmcnt(8)
  v_mfma_f32_16x16x32_bf16 v[84:87], v[156:159], v[220:223], v[84:87]
  v_mfma_f32_16x16x32_bf16 v[116:119], v[156:159], v[224:227], v[116:119]
  ds_read_b64_tr_b16 v[232:233], v25 offset:34816
  s_mov_b32 s24, s4
  s_mov_b32 s25, s5
  v_mfma_f32_16x16x32_bf16 v[64:67], v[156:159], v[156:159], v[64:67]
  ds_read_b64_tr_b16 v[234:235], v25 offset:37120
  s_and_b32 s25, s25, 0xffff
  s_mov_b32 s26, 256
  v_mfma_f32_16x16x32_bf16 v[56:59], v[52:55], v[156:159], v[56:59]
  ds_read_b64_tr_b16 v[236:237], v26 offset:34816
  v_add_u32 v14, s56, v14
  s_mov_b32 s27, 0x20000
  v_mfma_f32_16x16x32_bf16 v[88:91], v[160:163], v[220:223], v[88:91]
  ds_read_b64_tr_b16 v[238:239], v26 offset:37120
  v_add_u32 v15, s56, v15
  buffer_load_dword v11, off, s[24:27], 0 offset:128 sc1
  v_mfma_f32_16x16x32_bf16 v[120:123], v[160:163], v[224:227], v[120:123]
  v_add_u32 v16, s56, v16
  s_add_u32 s40, s6, 11491328
  s_addc_u32 s41, s7, 0
  v_mfma_f32_16x16x32_bf16 v[68:71], v[160:163], v[160:163], v[68:71]
  ds_read_b128 v[188:191], v18 offset:34816
  v_add_u32 v17, s56, v17
  s_and_b32 s41, s41, 0xffff
  v_mfma_f32_16x16x32_bf16 v[60:63], v[52:55], v[160:163], v[60:63]
  ds_read_b128 v[192:195], v18 offset:36864
  v_add_u32 v22, s56, v22
  s_mov_b32 s42, 20736
  s_waitcnt lgkmcnt(12)
  v_mfma_f32_16x16x32_bf16 v[148:151], v[156:159], v[228:231], v[148:151]
  ds_read_b64_tr_b16 v[240:241], v27 offset:34816
  v_add_u32 v23, s56, v23
  s_mov_b32 s43, 0x20000
  v_mfma_f32_16x16x32_bf16 v[152:155], v[160:163], v[228:231], v[152:155]
  v_add_u32 v24, s56, v24
  s_mul_i32 s52, s33, 288
  s_lshl_b32 s53, s22, 1
  s_waitcnt lgkmcnt(10)
  v_mfma_f32_16x16x32_bf16 v[92:95], v[164:167], v[220:223], v[92:95]
  ds_read_b64_tr_b16 v[242:243], v27 offset:37120
  s_add_u32 s53, s53, s52
  s_add_u32 s53, s53, 2304
  v_mfma_f32_16x16x32_bf16 v[124:127], v[164:167], v[224:227], v[124:127]
  ds_read_b128 v[196:199], v19 offset:34816
  v_lshlrev_b32 v7, 2, v6
  v_add_u32 v7, s53, v7
  v_mfma_f32_16x16x32_bf16 v[96:99], v[168:171], v[220:223], v[96:99]
  ds_read_b128 v[200:203], v19 offset:36864
  v_add_u32 v8, 2304, v7
  v_bfe_u32 v9, v6, 2, 1
  v_mfma_f32_16x16x32_bf16 v[128:131], v[168:171], v[224:227], v[128:131]
  ds_read_b128 v[204:207], v20 offset:34816
  v_mul_u32_u24 v9, 144, v9
  v_lshrrev_b32 v10, 3, v6
  v_mfma_f32_16x16x32_bf16 v[100:103], v[172:175], v[220:223], v[100:103]
  v_mul_u32_u24 v10, 2304, v10
  v_add_u32 v9, v9, v10
  v_and_b32 v10, 3, v6
  v_mfma_f32_16x16x32_bf16 v[132:135], v[172:175], v[224:227], v[132:135]
  ds_read_b128 v[208:211], v20 offset:36864
  v_lshl_add_u32 v9, v10, 2, v9
  s_add_u32 s52, s52, 2368
  s_waitcnt lgkmcnt(12)
  v_mfma_f32_16x16x32_bf16 v[104:107], v[176:179], v[220:223], v[104:107]
  ds_read_b128 v[212:215], v21 offset:34816
  v_add_u32 v9, s52, v9
  s_movk_i32 s80, 6912
  v_mfma_f32_16x16x32_bf16 v[136:139], v[176:179], v[224:227], v[136:139]
  ds_read_b128 v[216:219], v21 offset:36864
  s_movk_i32 s81, 13824
  v_and_b32 v2, 3, v6
  v_mfma_f32_16x16x32_bf16 v[108:111], v[180:183], v[220:223], v[108:111]
  v_lshrrev_b32 v3, 2, v6
  v_cmp_eq_u32 s[58:59], 1, v2
  v_cmp_eq_u32 s[60:61], 2, v2
  v_mfma_f32_16x16x32_bf16 v[140:143], v[180:183], v[224:227], v[140:143]
  v_cmp_eq_u32 s[62:63], 3, v2
  v_cmp_eq_u32 s[64:65], v3, v5
  v_lshlrev_b32 v246, 2, v6
  v_mfma_f32_16x16x32_bf16 v[112:115], v[184:187], v[220:223], v[112:115]
  v_lshlrev_b32 v247, 5, v5
  v_mfma_f32_16x16x32_bf16 v[144:147], v[184:187], v[224:227], v[144:147]
  s_waitcnt lgkmcnt(8)
  v_mfma_f32_16x16x32_bf16 v[84:87], v[188:191], v[232:235], v[84:87]
  s_waitcnt vmcnt(5)
  s_barrier
  v_mfma_f32_16x16x32_bf16 v[116:119], v[188:191], v[236:239], v[116:119]
  ds_read_b64_tr_b16 v[220:221], v22 offset:0
  v_lshlrev_b32 v248, 4, v5
  v_mov_b32 v46, s55
  v_mfma_f32_16x16x32_bf16 v[64:67], v[188:191], v[188:191], v[64:67]
  ds_read_b64_tr_b16 v[222:223], v22 offset:2304
  v_mov_b32 v50, s54
  s_lshl_b32 s35, s32, 7
  v_mfma_f32_16x16x32_bf16 v[56:59], v[52:55], v[188:191], v[56:59]
  ds_read_b64_tr_b16 v[224:225], v23 offset:0
  v_add_u32 v18, s56, v18
  s_add_u32 s35, s35, 139264
  v_mfma_f32_16x16x32_bf16 v[88:91], v[192:195], v[232:235], v[88:91]
  ds_read_b64_tr_b16 v[226:227], v23 offset:2304
  v_add_u32 v19, s56, v19
  v_add_u32 v28, s35, v246
  v_mfma_f32_16x16x32_bf16 v[120:123], v[192:195], v[236:239], v[120:123]
  v_add_u32 v20, s56, v20
  s_lshl_b32 s35, s28, 7
  s_add_u32 s35, s35, 139264
  v_mfma_f32_16x16x32_bf16 v[68:71], v[192:195], v[192:195], v[68:71]
  ds_read_b128 v[156:159], v14 offset:0
  v_add_u32 v21, s56, v21
  v_add_u32 v29, s35, v248
  v_mfma_f32_16x16x32_bf16 v[60:63], v[52:55], v[192:195], v[60:63]
  ds_read_b128 v[160:163], v14 offset:2048
  v_add_u32 v25, s56, v25
  s_lshl_b32 s35, s29, 7
  s_waitcnt lgkmcnt(12)
  v_mfma_f32_16x16x32_bf16 v[148:151], v[188:191], v[240:243], v[148:151]
  ds_read_b64_tr_b16 v[228:229], v24 offset:0
  v_add_u32 v26, s56, v26
  s_add_u32 s35, s35, 139264
  v_mfma_f32_16x16x32_bf16 v[152:155], v[192:195], v[240:243], v[152:155]
  v_add_u32 v27, s56, v27
  v_add_u32 v30, s35, v248
  s_lshl_b32 s35, s30, 7
  s_waitcnt lgkmcnt(10)
  v_mfma_f32_16x16x32_bf16 v[92:95], v[196:199], v[232:235], v[92:95]
  ds_read_b64_tr_b16 v[230:231], v24 offset:2304
  s_sub_u32 s56, 0, s56
  s_add_u32 s35, s35, 139264
  v_mfma_f32_16x16x32_bf16 v[124:127], v[196:199], v[236:239], v[124:127]
  ds_read_b128 v[164:167], v15 offset:0
  v_add_u32 v31, s35, v248
  s_lshl_b32 s35, s31, 7
  v_mfma_f32_16x16x32_bf16 v[96:99], v[200:203], v[232:235], v[96:99]
  ds_read_b128 v[168:171], v15 offset:2048
  s_add_u32 s35, s35, 139264
  v_add_u32 v32, s35, v248
  v_mfma_f32_16x16x32_bf16 v[128:131], v[200:203], v[236:239], v[128:131]
  ds_read_b128 v[172:175], v16 offset:0
  s_lshl_b32 s35, s33, 2
  v_mov_b32 v44, s35
  v_mfma_f32_16x16x32_bf16 v[100:103], v[204:207], v[232:235], v[100:103]
  s_lshl_b32 s35, s32, 10
  s_add_u32 s35, s35, 140288
  v_add_u32 v33, s35, v4
  v_mfma_f32_16x16x32_bf16 v[132:135], v[204:207], v[236:239], v[132:135]
  ds_read_b128 v[176:179], v16 offset:2048
  s_lshl_b32 s35, s28, 10
  s_add_u32 s35, s35, 140288
  s_waitcnt lgkmcnt(12)
  v_mfma_f32_16x16x32_bf16 v[104:107], v[208:211], v[232:235], v[104:107]
  ds_read_b128 v[180:183], v17 offset:0
  v_add_u32 v34, s35, v4
  s_lshl_b32 s35, s29, 10
  v_mfma_f32_16x16x32_bf16 v[136:139], v[208:211], v[236:239], v[136:139]
  ds_read_b128 v[184:187], v17 offset:2048
  s_add_u32 s35, s35, 140288
  v_add_u32 v35, s35, v4
  v_mfma_f32_16x16x32_bf16 v[108:111], v[212:215], v[232:235], v[108:111]
  s_lshl_b32 s35, s30, 10
  s_add_u32 s35, s35, 140288
  v_add_u32 v36, s35, v4
  v_mfma_f32_16x16x32_bf16 v[140:143], v[212:215], v[236:239], v[140:143]
  s_lshl_b32 s35, s31, 10
  s_add_u32 s35, s35, 140288
  v_mfma_f32_16x16x32_bf16 v[112:115], v[216:219], v[232:235], v[112:115]
  v_mfma_f32_16x16x32_bf16 v[144:147], v[216:219], v[236:239], v[144:147]
  s_waitcnt lgkmcnt(8)
  v_mfma_f32_16x16x32_bf16 v[84:87], v[156:159], v[220:223], v[84:87]
  v_mfma_f32_16x16x32_bf16 v[116:119], v[156:159], v[224:227], v[116:119]
  ds_read_b64_tr_b16 v[232:233], v25 offset:0
  s_waitcnt vmcnt(0)
  v_readfirstlane_b32 s52, v11
  s_nop 1
  s_cmp_ge_u32 s52, 81
  s_cbranch_scc0 L_k1_cw0
  L_k1_ck0:
  buffer_load_dword v72, v7, s[40:43], 0 offen sc1
  v_mfma_f32_16x16x32_bf16 v[64:67], v[156:159], v[156:159], v[64:67]
  ds_read_b64_tr_b16 v[234:235], v25 offset:2304
  buffer_load_dword v73, v7, s[40:43], s80 offen sc1
  buffer_load_dword v74, v7, s[40:43], s81 offen sc1
  v_mfma_f32_16x16x32_bf16 v[56:59], v[52:55], v[156:159], v[56:59]
  ds_read_b64_tr_b16 v[236:237], v26 offset:0
  buffer_load_dword v76, v8, s[40:43], 0 offen sc1
  buffer_load_dword v77, v8, s[40:43], s80 offen sc1
  v_mfma_f32_16x16x32_bf16 v[88:91], v[160:163], v[220:223], v[88:91]
  ds_read_b64_tr_b16 v[238:239], v26 offset:2304
  buffer_load_dword v78, v8, s[40:43], s81 offen sc1
  buffer_load_dword v80, v9, s[40:43], 0 offen sc1
  v_mfma_f32_16x16x32_bf16 v[120:123], v[160:163], v[224:227], v[120:123]
  buffer_load_dword v81, v9, s[40:43], s80 offen sc1
  buffer_load_dword v82, v9, s[40:43], s81 offen sc1
  v_add_u32 v37, s35, v4
  v_mfma_f32_16x16x32_bf16 v[68:71], v[160:163], v[160:163], v[68:71]
  ds_read_b128 v[188:191], v18 offset:0
  v_cmp_gt_u32 s[66:67], 8, v6
  v_mov_b32 v47, 0
  v_mfma_f32_16x16x32_bf16 v[60:63], v[52:55], v[160:163], v[60:63]
  ds_read_b128 v[192:195], v18 offset:2048
  v_mov_b32 v251, 2147483632
  v_cndmask_b32 v48, v47, v46, s[66:67]
  s_waitcnt lgkmcnt(12)
  v_mfma_f32_16x16x32_bf16 v[148:151], v[156:159], v[228:231], v[148:151]
  ds_read_b64_tr_b16 v[240:241], v27 offset:0
  s_lshl_b32 s35, s33, 2
  s_add_u32 s35, s35, s32
  v_mfma_f32_16x16x32_bf16 v[152:155], v[160:163], v[228:231], v[152:155]
  s_mul_i32 s35, s35, 1408
  s_add_u32 s16, s6, s35
  s_addc_u32 s17, s7, 0
  s_waitcnt lgkmcnt(10)
  v_mfma_f32_16x16x32_bf16 v[92:95], v[164:167], v[220:223], v[92:95]
  ds_read_b64_tr_b16 v[242:243], v27 offset:2304
  s_add_u32 s16, s16, 11513856
  s_addc_u32 s17, s17, 0
  v_mfma_f32_16x16x32_bf16 v[124:127], v[164:167], v[224:227], v[124:127]
  ds_read_b128 v[196:199], v19 offset:0
  s_and_b32 s17, s17, 0xffff
  s_mov_b32 s18, 1408
  v_mfma_f32_16x16x32_bf16 v[96:99], v[168:171], v[220:223], v[96:99]
  ds_read_b128 v[200:203], v19 offset:2048
  s_mov_b32 s19, 0x20000
  s_movk_i32 s78, 1216
  v_mfma_f32_16x16x32_bf16 v[128:131], v[168:171], v[224:227], v[128:131]
  ds_read_b128 v[204:207], v20 offset:0
  v_lshrrev_b32 v244, 1, v6
  v_cmp_eq_u32 vcc, s32, v244
  v_mfma_f32_16x16x32_bf16 v[100:103], v[172:175], v[220:223], v[100:103]
  v_and_b32 v245, 1, v6
  v_lshlrev_b32 v245, 2, v245
  v_cndmask_b32 v245, v251, v245, vcc
  v_mfma_f32_16x16x32_bf16 v[132:135], v[172:175], v[224:227], v[132:135]
  ds_read_b128 v[208:211], v20 offset:2048
  v_and_b32 v249, 2, v5
  v_lshlrev_b32 v249, 4, v249
  s_waitcnt lgkmcnt(12)
  v_mfma_f32_16x16x32_bf16 v[104:107], v[176:179], v[220:223], v[104:107]
  ds_read_b128 v[212:215], v21 offset:0
  v_xor_b32 v249, v249, v246
  v_lshl_add_u32 v38, v5, 8, v249
  v_mfma_f32_16x16x32_bf16 v[136:139], v[176:179], v[224:227], v[136:139]
  ds_read_b128 v[216:219], v21 offset:2048
  v_subrev_u32 v249, s32, v244
  v_and_b32 v249, 7, v249
  v_mfma_f32_16x16x32_bf16 v[108:111], v[180:183], v[220:223], v[108:111]
  v_and_b32 v250, 1, v6
  v_lshlrev_b32 v250, 2, v250
  v_lshl_add_u32 v250, v249, 3, v250
  v_mfma_f32_16x16x32_bf16 v[140:143], v[180:183], v[224:227], v[140:143]
  v_mfma_f32_16x16x32_bf16 v[112:115], v[184:187], v[220:223], v[112:115]
  v_mfma_f32_16x16x32_bf16 v[144:147], v[184:187], v[224:227], v[144:147]
  s_waitcnt lgkmcnt(8)
  v_mfma_f32_16x16x32_bf16 v[84:87], v[188:191], v[232:235], v[84:87]
  v_mfma_f32_16x16x32_bf16 v[116:119], v[188:191], v[236:239], v[116:119]
  v_cmp_gt_u32 vcc, 4, v249
  v_add3_u32 v250, v250, v247, s78
  s_nop 0
  v_cndmask_b32 v39, v251, v250, vcc
  v_mfma_f32_16x16x32_bf16 v[64:67], v[188:191], v[188:191], v[64:67]
  v_cmp_eq_u32 s[72:73], 1, v249
  v_cmp_eq_u32 s[74:75], 2, v249
  v_cmp_eq_u32 s[76:77], 3, v249
  v_mfma_f32_16x16x32_bf16 v[56:59], v[52:55], v[188:191], v[56:59]
  s_lshr_b32 s35, s32, 1
  s_add_u32 s35, s35, 2
  v_cmp_eq_u32 s[70:71], s35, v5
  v_mfma_f32_16x16x32_bf16 v[88:91], v[192:195], v[232:235], v[88:91]
  v_cmp_eq_u32 vcc, 0, v5
  v_add_u32 v249, 1024, v246
  v_add_u32 v250, 1088, v246
  v_mfma_f32_16x16x32_bf16 v[120:123], v[192:195], v[236:239], v[120:123]
  v_add_u32 v252, 1152, v246
  v_cndmask_b32 v40, v251, v249, vcc
  v_cndmask_b32 v40, v40, v250, s[70:71]
  v_mfma_f32_16x16x32_bf16 v[68:71], v[192:195], v[192:195], v[68:71]
  v_cndmask_b32 v41, v251, v252, s[70:71]
  v_add_u32 v249, 1344, v245
  v_add_u32 v250, 1352, v245
  v_mfma_f32_16x16x32_bf16 v[60:63], v[52:55], v[192:195], v[60:63]
  v_add_u32 v252, 1360, v245
  v_cndmask_b32 v42, v251, v249, vcc
  v_cndmask_b32 v42, v42, v250, s[70:71]
  s_waitcnt lgkmcnt(6)
  v_mfma_f32_16x16x32_bf16 v[148:151], v[188:191], v[240:243], v[148:151]
  v_cndmask_b32 v43, v251, v252, s[70:71]
  s_and_b32 s35, s32, 1
  s_cmp_eq_u32 s35, 1
  v_mfma_f32_16x16x32_bf16 v[152:155], v[192:195], v[240:243], v[152:155]
  s_cselect_b64 s[70:71], -1, 0
  buffer_load_dword v45, v44, s[24:27], 0 offen sc0 sc1
  v_add_u32 v3, 64, v28
  s_mov_b32 s52, 0x3ae38e39
  s_mov_b32 s53, 0x3727c5ac
  s_waitcnt lgkmcnt(3)
  v_mfma_f32_16x16x32_bf16 v[92:95], v[196:199], v[232:235], v[92:95]
  v_cndmask_b32 v64, v64, v65, s[58:59]
  v_cndmask_b32 v64, v64, v66, s[60:61]
  v_mfma_f32_16x16x32_bf16 v[124:127], v[196:199], v[236:239], v[124:127]
  v_cndmask_b32 v64, v64, v67, s[62:63]
  v_cndmask_b32 v68, v68, v69, s[58:59]
  v_mfma_f32_16x16x32_bf16 v[96:99], v[200:203], v[232:235], v[96:99]
  v_cndmask_b32 v68, v68, v70, s[60:61]
  v_cndmask_b32 v68, v68, v71, s[62:63]
  v_mfma_f32_16x16x32_bf16 v[128:131], v[200:203], v[236:239], v[128:131]
  v_mul_f32 v65, s52, v56
  v_mul_f32 v64, s52, v64
  v_mfma_f32_16x16x32_bf16 v[100:103], v[204:207], v[232:235], v[100:103]
  v_fma_f32 v64, -v65, v65, v64
  v_max_f32 v64, 0, v64
  v_mfma_f32_16x16x32_bf16 v[132:135], v[204:207], v[236:239], v[132:135]
  v_add_f32 v64, s53, v64
  v_rsq_f32 v64, v64
  s_waitcnt lgkmcnt(0)
  v_mfma_f32_16x16x32_bf16 v[104:107], v[208:211], v[232:235], v[104:107]
  v_mul_f32 v69, s52, v60
  v_mul_f32 v68, s52, v68
  v_mfma_f32_16x16x32_bf16 v[136:139], v[208:211], v[236:239], v[136:139]
  v_fma_f32 v68, -v69, v69, v68
  v_max_f32 v68, 0, v68
  v_mfma_f32_16x16x32_bf16 v[108:111], v[212:215], v[232:235], v[108:111]
  v_add_f32 v68, s53, v68
  v_rsq_f32 v68, v68
  v_mfma_f32_16x16x32_bf16 v[140:143], v[212:215], v[236:239], v[140:143]
  v_mul_f32 v65, -v65, v64
  v_mul_f32 v69, -v69, v68
  v_mfma_f32_16x16x32_bf16 v[112:115], v[216:219], v[232:235], v[112:115]
  s_mov_b64 exec, s[64:65]
  ds_write2st64_b32 v28, v64, v65 offset0:0 offset1:2
  ds_write2st64_b32 v3, v68, v69 offset0:0 offset1:2
  s_mov_b64 exec, -1
  v_mfma_f32_16x16x32_bf16 v[144:147], v[216:219], v[236:239], v[144:147]
  s_waitcnt lgkmcnt(0)
  s_barrier
  ds_read_b128 v[156:159], v29 offset:0
  ds_read_b128 v[160:163], v29 offset:512
  ds_read_b128 v[164:167], v29 offset:64
  ds_read_b128 v[168:171], v29 offset:576
  ds_read_b128 v[172:175], v30 offset:0
  ds_read_b128 v[176:179], v30 offset:512
  ds_read_b128 v[180:183], v30 offset:64
  ds_read_b128 v[184:187], v30 offset:576
  ds_read_b128 v[188:191], v31 offset:0
  ds_read_b128 v[192:195], v31 offset:512
  ds_read_b128 v[196:199], v31 offset:64
  ds_read_b128 v[200:203], v31 offset:576
  ds_read_b128 v[204:207], v32 offset:0
  ds_read_b128 v[208:211], v32 offset:512
  ds_read_b128 v[212:215], v32 offset:64
  ds_read_b128 v[216:219], v32 offset:576
  s_waitcnt vmcnt(2)
  v_add_f32 v254, v80, v81
  v_add_f32 v252, v72, v73
  v_add_f32 v253, v76, v77
  s_waitcnt vmcnt(1)
  v_add_f32 v254, v254, v82
  v_add_f32 v252, v252, v74
  v_add_f32 v253, v253, v78
  s_waitcnt lgkmcnt(14)
  v_pk_fma_f32 v[244:245], v[160:161], v[254:255], v[48:49] op_sel:[0,0,0] op_sel_hi:[1,0,0]
  s_waitcnt lgkmcnt(12)
  v_pk_fma_f32 v[248:249], v[168:169], v[254:255], v[48:49] op_sel:[0,0,0] op_sel_hi:[1,0,0]
  v_pk_fma_f32 v[246:247], v[162:163], v[254:255], v[48:49] op_sel:[0,0,0] op_sel_hi:[1,0,0]
  v_pk_fma_f32 v[250:251], v[170:171], v[254:255], v[48:49] op_sel:[0,0,0] op_sel_hi:[1,0,0]
  v_pk_fma_f32 v[148:149], v[148:149], v[156:157], v[244:245]
  v_pk_fma_f32 v[152:153], v[152:153], v[164:165], v[248:249]
  v_pk_fma_f32 v[150:151], v[150:151], v[158:159], v[246:247]
  v_pk_fma_f32 v[154:155], v[154:155], v[166:167], v[250:251]
  v_pk_mul_f32 v[244:245], v[148:149], v[50:51] op_sel_hi:[1,0]
  v_pk_mul_f32 v[248:249], v[152:153], v[50:51] op_sel_hi:[1,0]
  v_pk_mul_f32 v[246:247], v[150:151], v[50:51] op_sel_hi:[1,0]
  v_pk_mul_f32 v[250:251], v[154:155], v[50:51] op_sel_hi:[1,0]
  v_exp_f32 v244, v244 clamp
  v_exp_f32 v248, v248 clamp
  v_exp_f32 v245, v245 clamp
  v_exp_f32 v249, v249 clamp
  v_exp_f32 v246, v246 clamp
  v_exp_f32 v250, v250 clamp
  v_exp_f32 v247, v247 clamp
  v_exp_f32 v251, v251 clamp
  v_max_f32 v220, s55, v148
  v_max_f32 v224, s55, v152
  v_max_f32 v221, s55, v149
  v_max_f32 v225, s55, v153
  v_max_f32 v222, s55, v150
  v_max_f32 v226, s55, v154
  v_max_f32 v223, s55, v151
  v_max_f32 v227, s55, v155
  v_pk_add_f32 v[220:221], v[220:221], v[244:245]
  v_pk_add_f32 v[224:225], v[224:225], v[248:249]
  v_pk_add_f32 v[222:223], v[222:223], v[246:247]
  v_pk_add_f32 v[226:227], v[226:227], v[250:251]
  v_cndmask_b32 v148, v148, v220, s[66:67]
  v_cndmask_b32 v152, v152, v224, s[66:67]
  v_cndmask_b32 v149, v149, v221, s[66:67]
  v_cndmask_b32 v153, v153, v225, s[66:67]
  v_cndmask_b32 v150, v150, v222, s[66:67]
  v_cndmask_b32 v154, v154, v226, s[66:67]
  v_cndmask_b32 v151, v151, v223, s[66:67]
  v_cndmask_b32 v155, v155, v227, s[66:67]
  v_cvt_pk_bf16_f32 v236, v148, v149
  v_cvt_pk_bf16_f32 v238, v152, v153
  v_cvt_pk_bf16_f32 v237, v150, v151
  v_cvt_pk_bf16_f32 v239, v154, v155
  ds_write_b128 v33, v[236:239]
  v_pk_fma_f32 v[244:245], v[160:161], v[252:253], v[46:47] op_sel:[0,0,0] op_sel_hi:[1,0,0]
  v_pk_fma_f32 v[248:249], v[168:169], v[252:253], v[46:47] op_sel:[0,0,0] op_sel_hi:[1,0,0]
  v_pk_fma_f32 v[246:247], v[162:163], v[252:253], v[46:47] op_sel:[0,0,0] op_sel_hi:[1,0,0]
  v_pk_fma_f32 v[250:251], v[170:171], v[252:253], v[46:47] op_sel:[0,0,0] op_sel_hi:[1,0,0]
  v_pk_fma_f32 v[84:85], v[84:85], v[156:157], v[244:245]
  v_pk_fma_f32 v[88:89], v[88:89], v[164:165], v[248:249]
  v_pk_fma_f32 v[86:87], v[86:87], v[158:159], v[246:247]
  v_pk_fma_f32 v[90:91], v[90:91], v[166:167], v[250:251]
  v_pk_mul_f32 v[244:245], v[84:85], v[50:51] op_sel_hi:[1,0]
  v_pk_mul_f32 v[248:249], v[88:89], v[50:51] op_sel_hi:[1,0]
  v_pk_mul_f32 v[246:247], v[86:87], v[50:51] op_sel_hi:[1,0]
  v_pk_mul_f32 v[250:251], v[90:91], v[50:51] op_sel_hi:[1,0]
  v_exp_f32 v244, v244 clamp
  v_exp_f32 v248, v248 clamp
  v_exp_f32 v245, v245 clamp
  v_exp_f32 v249, v249 clamp
  v_exp_f32 v246, v246 clamp
  v_exp_f32 v250, v250 clamp
  v_exp_f32 v247, v247 clamp
  v_exp_f32 v251, v251 clamp
  v_max_f32 v84, s55, v84
  v_max_f32 v88, s55, v88
  v_max_f32 v85, s55, v85
  v_max_f32 v89, s55, v89
  v_max_f32 v86, s55, v86
  v_max_f32 v90, s55, v90
  v_max_f32 v87, s55, v87
  v_max_f32 v91, s55, v91
  v_pk_add_f32 v[84:85], v[84:85], v[244:245]
  v_pk_add_f32 v[88:89], v[88:89], v[248:249]
  v_pk_add_f32 v[86:87], v[86:87], v[246:247]
  v_pk_add_f32 v[90:91], v[90:91], v[250:251]
  v_cvt_pk_bf16_f32 v220, v84, v85
  v_cvt_pk_bf16_f32 v222, v88, v89
  v_cvt_pk_bf16_f32 v221, v86, v87
  v_cvt_pk_bf16_f32 v223, v90, v91
  s_waitcnt lgkmcnt(11)
  v_pk_fma_f32 v[244:245], v[176:177], v[252:253], v[46:47] op_sel:[0,0,0] op_sel_hi:[1,0,0]
  s_waitcnt lgkmcnt(9)
  v_pk_fma_f32 v[248:249], v[184:185], v[252:253], v[46:47] op_sel:[0,0,0] op_sel_hi:[1,0,0]
  v_pk_fma_f32 v[246:247], v[178:179], v[252:253], v[46:47] op_sel:[0,0,0] op_sel_hi:[1,0,0]
  v_pk_fma_f32 v[250:251], v[186:187], v[252:253], v[46:47] op_sel:[0,0,0] op_sel_hi:[1,0,0]
  v_pk_fma_f32 v[92:93], v[92:93], v[172:173], v[244:245]
  v_pk_fma_f32 v[96:97], v[96:97], v[180:181], v[248:249]
  v_pk_fma_f32 v[94:95], v[94:95], v[174:175], v[246:247]
  v_pk_fma_f32 v[98:99], v[98:99], v[182:183], v[250:251]
  v_pk_mul_f32 v[244:245], v[92:93], v[50:51] op_sel_hi:[1,0]
  v_pk_mul_f32 v[248:249], v[96:97], v[50:51] op_sel_hi:[1,0]
  v_pk_mul_f32 v[246:247], v[94:95], v[50:51] op_sel_hi:[1,0]
  v_pk_mul_f32 v[250:251], v[98:99], v[50:51] op_sel_hi:[1,0]
  v_exp_f32 v244, v244 clamp
  v_exp_f32 v248, v248 clamp
  v_exp_f32 v245, v245 clamp
  v_exp_f32 v249, v249 clamp
  v_exp_f32 v246, v246 clamp
  v_exp_f32 v250, v250 clamp
  v_exp_f32 v247, v247 clamp
  v_exp_f32 v251, v251 clamp
  v_max_f32 v92, s55, v92
  v_max_f32 v96, s55, v96
  v_max_f32 v93, s55, v93
  v_max_f32 v97, s55, v97
  v_max_f32 v94, s55, v94
  v_max_f32 v98, s55, v98
  v_max_f32 v95, s55, v95
  v_max_f32 v99, s55, v99
  v_pk_add_f32 v[92:93], v[92:93], v[244:245]
  v_pk_add_f32 v[96:97], v[96:97], v[248:249]
  v_pk_add_f32 v[94:95], v[94:95], v[246:247]
  v_pk_add_f32 v[98:99], v[98:99], v[250:251]
  v_cvt_pk_bf16_f32 v224, v92, v93
  v_cvt_pk_bf16_f32 v226, v96, v97
  v_cvt_pk_bf16_f32 v225, v94, v95
  v_cvt_pk_bf16_f32 v227, v98, v99
  s_waitcnt lgkmcnt(0)
  s_barrier
  ds_read_b128 v[84:87], v34
  ds_read_b128 v[88:91], v35
  ds_read_b128 v[92:95], v36
  ds_read_b128 v[96:99], v37
  v_pk_fma_f32 v[244:245], v[192:193], v[252:253], v[46:47] op_sel:[0,0,0] op_sel_hi:[1,0,0]
  v_pk_fma_f32 v[248:249], v[200:201], v[252:253], v[46:47] op_sel:[0,0,0] op_sel_hi:[1,0,0]
  v_pk_fma_f32 v[246:247], v[194:195], v[252:253], v[46:47] op_sel:[0,0,0] op_sel_hi:[1,0,0]
  v_pk_fma_f32 v[250:251], v[202:203], v[252:253], v[46:47] op_sel:[0,0,0] op_sel_hi:[1,0,0]
  v_pk_fma_f32 v[100:101], v[100:101], v[188:189], v[244:245]
  v_pk_fma_f32 v[104:105], v[104:105], v[196:197], v[248:249]
  v_pk_fma_f32 v[102:103], v[102:103], v[190:191], v[246:247]
  v_pk_fma_f32 v[106:107], v[106:107], v[198:199], v[250:251]
  v_pk_mul_f32 v[244:245], v[100:101], v[50:51] op_sel_hi:[1,0]
  v_pk_mul_f32 v[248:249], v[104:105], v[50:51] op_sel_hi:[1,0]
  v_pk_mul_f32 v[246:247], v[102:103], v[50:51] op_sel_hi:[1,0]
  v_pk_mul_f32 v[250:251], v[106:107], v[50:51] op_sel_hi:[1,0]
  v_exp_f32 v244, v244 clamp
  v_exp_f32 v248, v248 clamp
  v_exp_f32 v245, v245 clamp
  v_exp_f32 v249, v249 clamp
  v_exp_f32 v246, v246 clamp
  v_exp_f32 v250, v250 clamp
  v_exp_f32 v247, v247 clamp
  v_exp_f32 v251, v251 clamp
  v_max_f32 v100, s55, v100
  v_max_f32 v104, s55, v104
  v_max_f32 v101, s55, v101
  v_max_f32 v105, s55, v105
  v_max_f32 v102, s55, v102
  v_max_f32 v106, s55, v106
  v_max_f32 v103, s55, v103
  v_max_f32 v107, s55, v107
  v_pk_add_f32 v[100:101], v[100:101], v[244:245]
  v_pk_add_f32 v[104:105], v[104:105], v[248:249]
  v_pk_add_f32 v[102:103], v[102:103], v[246:247]
  v_pk_add_f32 v[106:107], v[106:107], v[250:251]
  v_cvt_pk_bf16_f32 v228, v100, v101
  v_cvt_pk_bf16_f32 v230, v104, v105
  v_cvt_pk_bf16_f32 v229, v102, v103
  v_cvt_pk_bf16_f32 v231, v106, v107
  v_pk_fma_f32 v[244:245], v[208:209], v[252:253], v[46:47] op_sel:[0,0,0] op_sel_hi:[1,0,0]
  v_pk_fma_f32 v[248:249], v[216:217], v[252:253], v[46:47] op_sel:[0,0,0] op_sel_hi:[1,0,0]
  v_pk_fma_f32 v[246:247], v[210:211], v[252:253], v[46:47] op_sel:[0,0,0] op_sel_hi:[1,0,0]
  v_pk_fma_f32 v[250:251], v[218:219], v[252:253], v[46:47] op_sel:[0,0,0] op_sel_hi:[1,0,0]
  v_pk_fma_f32 v[108:109], v[108:109], v[204:205], v[244:245]
  v_pk_fma_f32 v[112:113], v[112:113], v[212:213], v[248:249]
  v_pk_fma_f32 v[110:111], v[110:111], v[206:207], v[246:247]
  v_pk_fma_f32 v[114:115], v[114:115], v[214:215], v[250:251]
  v_pk_mul_f32 v[244:245], v[108:109], v[50:51] op_sel_hi:[1,0]
  v_pk_mul_f32 v[248:249], v[112:113], v[50:51] op_sel_hi:[1,0]
  v_pk_mul_f32 v[246:247], v[110:111], v[50:51] op_sel_hi:[1,0]
  v_pk_mul_f32 v[250:251], v[114:115], v[50:51] op_sel_hi:[1,0]
  v_exp_f32 v244, v244 clamp
  v_exp_f32 v248, v248 clamp
  v_exp_f32 v245, v245 clamp
  v_exp_f32 v249, v249 clamp
  v_exp_f32 v246, v246 clamp
  v_exp_f32 v250, v250 clamp
  v_exp_f32 v247, v247 clamp
  v_exp_f32 v251, v251 clamp
  v_max_f32 v108, s55, v108
  v_max_f32 v112, s55, v112
  v_max_f32 v109, s55, v109
  v_max_f32 v113, s55, v113
  v_max_f32 v110, s55, v110
  v_max_f32 v114, s55, v114
  v_max_f32 v111, s55, v111
  v_max_f32 v115, s55, v115
  v_pk_add_f32 v[108:109], v[108:109], v[244:245]
  v_pk_add_f32 v[112:113], v[112:113], v[248:249]
  v_pk_add_f32 v[110:111], v[110:111], v[246:247]
  v_pk_add_f32 v[114:115], v[114:115], v[250:251]
  v_cvt_pk_bf16_f32 v232, v108, v109
  v_cvt_pk_bf16_f32 v234, v112, v113
  v_cvt_pk_bf16_f32 v233, v110, v111
  v_cvt_pk_bf16_f32 v235, v114, v115
  s_waitcnt lgkmcnt(3)
  v_cndmask_b32 v100, v84, v52, s[66:67]
  v_cndmask_b32 v101, v85, v52, s[66:67]
  v_cndmask_b32 v102, v86, v52, s[66:67]
  v_cndmask_b32 v103, v87, v52, s[66:67]
  s_waitcnt lgkmcnt(2)
  v_cndmask_b32 v104, v88, v52, s[66:67]
  v_cndmask_b32 v105, v89, v52, s[66:67]
  v_cndmask_b32 v106, v90, v52, s[66:67]
  v_cndmask_b32 v107, v91, v52, s[66:67]
  s_waitcnt lgkmcnt(1)
  v_cndmask_b32 v108, v92, v52, s[66:67]
  v_cndmask_b32 v109, v93, v52, s[66:67]
  v_cndmask_b32 v110, v94, v52, s[66:67]
  v_cndmask_b32 v111, v95, v52, s[66:67]
  s_waitcnt lgkmcnt(0)
  v_cndmask_b32 v112, v96, v52, s[66:67]
  v_cndmask_b32 v113, v97, v52, s[66:67]
  v_cndmask_b32 v114, v98, v52, s[66:67]
  v_cndmask_b32 v115, v99, v52, s[66:67]
  v_mfma_f32_16x16x32_bf16 v[148:151], v[100:103], v[220:223], 0
  v_mfma_f32_16x16x32_bf16 v[152:155], v[100:103], v[84:87], 0
  v_mfma_f32_16x16x32_bf16 v[148:151], v[104:107], v[224:227], v[148:151]
  v_mfma_f32_16x16x32_bf16 v[152:155], v[104:107], v[88:91], v[152:155]
  v_mfma_f32_16x16x32_bf16 v[148:151], v[108:111], v[228:231], v[148:151]
  v_mfma_f32_16x16x32_bf16 v[152:155], v[108:111], v[92:95], v[152:155]
  v_mfma_f32_16x16x32_bf16 v[148:151], v[112:115], v[232:235], v[148:151]
  v_mfma_f32_16x16x32_bf16 v[152:155], v[112:115], v[96:99], v[152:155]
  v_pk_fma_f32 v[244:245], v[160:161], v[252:253], v[46:47] op_sel:[0,1,1] op_sel_hi:[1,1,1]
  v_pk_fma_f32 v[248:249], v[168:169], v[252:253], v[46:47] op_sel:[0,1,1] op_sel_hi:[1,1,1]
  v_pk_fma_f32 v[246:247], v[162:163], v[252:253], v[46:47] op_sel:[0,1,1] op_sel_hi:[1,1,1]
  v_pk_fma_f32 v[250:251], v[170:171], v[252:253], v[46:47] op_sel:[0,1,1] op_sel_hi:[1,1,1]
  v_pk_fma_f32 v[116:117], v[116:117], v[156:157], v[244:245]
  v_pk_fma_f32 v[120:121], v[120:121], v[164:165], v[248:249]
  v_pk_fma_f32 v[118:119], v[118:119], v[158:159], v[246:247]
  v_pk_fma_f32 v[122:123], v[122:123], v[166:167], v[250:251]
  v_cvt_pk_bf16_f32 v56, v116, v117
  v_cvt_pk_bf16_f32 v58, v120, v121
  v_cvt_pk_bf16_f32 v57, v118, v119
  v_cvt_pk_bf16_f32 v59, v122, v123
  s_waitcnt vmcnt(0)
  v_readfirstlane_b32 s35, v45
  s_nop 1
  s_cmp_lg_u32 s35, 0
  s_cbranch_scc0 L_k1_poll
  L_k1_go:
  v_cndmask_b32 v148, v148, v150, s[70:71]
  v_cndmask_b32 v149, v149, v151, s[70:71]
  buffer_atomic_add_f32 v148, v40, s[16:19], 0 offen
  buffer_atomic_add_f32 v149, v41, s[16:19], 0 offen
  v_cndmask_b32 v152, v152, v154, s[70:71]
  v_cndmask_b32 v153, v153, v155, s[70:71]
  buffer_atomic_add_f32 v152, v42, s[16:19], 0 offen
  buffer_atomic_add_f32 v153, v43, s[16:19], 0 offen
  v_pk_fma_f32 v[244:245], v[176:177], v[252:253], v[46:47] op_sel:[0,1,1] op_sel_hi:[1,1,1]
  v_pk_fma_f32 v[248:249], v[184:185], v[252:253], v[46:47] op_sel:[0,1,1] op_sel_hi:[1,1,1]
  v_pk_fma_f32 v[246:247], v[178:179], v[252:253], v[46:47] op_sel:[0,1,1] op_sel_hi:[1,1,1]
  v_pk_fma_f32 v[250:251], v[186:187], v[252:253], v[46:47] op_sel:[0,1,1] op_sel_hi:[1,1,1]
  v_pk_fma_f32 v[124:125], v[124:125], v[172:173], v[244:245]
  v_pk_fma_f32 v[128:129], v[128:129], v[180:181], v[248:249]
  v_pk_fma_f32 v[126:127], v[126:127], v[174:175], v[246:247]
  v_pk_fma_f32 v[130:131], v[130:131], v[182:183], v[250:251]
  v_cvt_pk_bf16_f32 v60, v124, v125
  v_cvt_pk_bf16_f32 v62, v128, v129
  v_cvt_pk_bf16_f32 v61, v126, v127
  v_cvt_pk_bf16_f32 v63, v130, v131
  v_mfma_f32_16x16x32_bf16 v[100:103], v[56:59], v[220:223], 0
  v_mfma_f32_16x16x32_bf16 v[104:107], v[56:59], v[84:87], 0
  v_pk_fma_f32 v[244:245], v[192:193], v[252:253], v[46:47] op_sel:[0,1,1] op_sel_hi:[1,1,1]
  v_pk_fma_f32 v[248:249], v[200:201], v[252:253], v[46:47] op_sel:[0,1,1] op_sel_hi:[1,1,1]
  v_pk_fma_f32 v[246:247], v[194:195], v[252:253], v[46:47] op_sel:[0,1,1] op_sel_hi:[1,1,1]
  v_pk_fma_f32 v[250:251], v[202:203], v[252:253], v[46:47] op_sel:[0,1,1] op_sel_hi:[1,1,1]
  v_pk_fma_f32 v[132:133], v[132:133], v[188:189], v[244:245]
  v_pk_fma_f32 v[136:137], v[136:137], v[196:197], v[248:249]
  v_pk_fma_f32 v[134:135], v[134:135], v[190:191], v[246:247]
  v_pk_fma_f32 v[138:139], v[138:139], v[198:199], v[250:251]
  v_cvt_pk_bf16_f32 v64, v132, v133
  v_cvt_pk_bf16_f32 v66, v136, v137
  v_cvt_pk_bf16_f32 v65, v134, v135
  v_cvt_pk_bf16_f32 v67, v138, v139
  v_mfma_f32_16x16x32_bf16 v[100:103], v[60:63], v[224:227], v[100:103]
  v_mfma_f32_16x16x32_bf16 v[104:107], v[60:63], v[88:91], v[104:107]
  v_pk_fma_f32 v[244:245], v[208:209], v[252:253], v[46:47] op_sel:[0,1,1] op_sel_hi:[1,1,1]
  v_pk_fma_f32 v[248:249], v[216:217], v[252:253], v[46:47] op_sel:[0,1,1] op_sel_hi:[1,1,1]
  v_pk_fma_f32 v[246:247], v[210:211], v[252:253], v[46:47] op_sel:[0,1,1] op_sel_hi:[1,1,1]
  v_pk_fma_f32 v[250:251], v[218:219], v[252:253], v[46:47] op_sel:[0,1,1] op_sel_hi:[1,1,1]
  v_pk_fma_f32 v[140:141], v[140:141], v[204:205], v[244:245]
  v_pk_fma_f32 v[144:145], v[144:145], v[212:213], v[248:249]
  v_pk_fma_f32 v[142:143], v[142:143], v[206:207], v[246:247]
  v_pk_fma_f32 v[146:147], v[146:147], v[214:215], v[250:251]
  v_cvt_pk_bf16_f32 v68, v140, v141
  v_cvt_pk_bf16_f32 v70, v144, v145
  v_cvt_pk_bf16_f32 v69, v142, v143
  v_cvt_pk_bf16_f32 v71, v146, v147
  v_mfma_f32_16x16x32_bf16 v[100:103], v[64:67], v[228:231], v[100:103]
  v_mfma_f32_16x16x32_bf16 v[104:107], v[64:67], v[92:95], v[104:107]
  v_mfma_f32_16x16x32_bf16 v[100:103], v[68:71], v[232:235], v[100:103]
  v_mfma_f32_16x16x32_bf16 v[104:107], v[68:71], v[96:99], v[104:107]
  s_nop 6
  buffer_atomic_add_f32 v100, v38, s[16:19], 0 offen offset:0
  buffer_atomic_add_f32 v101, v38, s[16:19], 0 offen offset:64
  buffer_atomic_add_f32 v102, v38, s[16:19], 0 offen offset:128
  buffer_atomic_add_f32 v103, v38, s[16:19], 0 offen offset:192
  v_mov_b32_dpp v245, v105 row_ror:2 row_mask:0xf bank_mask:0xf
  v_mov_b32_dpp v246, v106 row_ror:4 row_mask:0xf bank_mask:0xf
  v_mov_b32_dpp v247, v107 row_ror:6 row_mask:0xf bank_mask:0xf
  v_cndmask_b32 v104, v104, v245, s[72:73]
  v_cndmask_b32 v104, v104, v246, s[74:75]
  v_cndmask_b32 v104, v104, v247, s[76:77]
  buffer_atomic_add_f32 v104, v39, s[16:19], 0 offen
  s_endpgm
  L_k1_poll:
  s_mov_b32 s36, 0
  L_k1_poll1:
  s_sleep 4
  buffer_load_dword v45, v44, s[24:27], 0 offen sc0 sc1
  s_waitcnt vmcnt(0)
  v_readfirstlane_b32 s35, v45
  s_add_u32 s36, s36, 1
  s_cmp_lg_u32 s35, 0
  s_cbranch_scc1 L_k1_go
  s_cmp_lt_u32 s36, 4194304
  s_cbranch_scc1 L_k1_poll1
  s_branch L_k1_go
L_k1_q:
  s_waitcnt vmcnt(9)
  s_barrier
  ds_read_b64_tr_b16 v[220:221], v22 offset:0
  ds_read_b64_tr_b16 v[222:223], v22 offset:2304
  ds_read_b64_tr_b16 v[224:225], v23 offset:0
  ds_read_b64_tr_b16 v[226:227], v23 offset:2304
  ds_read_b128 v[156:159], v14 offset:0
  ds_read_b128 v[160:163], v14 offset:2048
  ds_read_b64_tr_b16 v[228:229], v24 offset:0
  ds_read_b64_tr_b16 v[230:231], v24 offset:2304
  ds_read_b128 v[164:167], v15 offset:0
  ds_read_b128 v[168:171], v15 offset:2048
  ds_read_b128 v[172:175], v16 offset:0
  ds_read_b128 v[176:179], v16 offset:2048
  ds_read_b128 v[180:183], v17 offset:0
  ds_read_b128 v[184:187], v17 offset:2048
  s_add_u32 m0, s20, s48
  s_nop 0
  buffer_load_dwordx4 v7, s[8:11], s44 offen offset:0 lds
  buffer_load_dwordx4 v8, s[8:11], s44 offen offset:1024 lds
  s_add_u32 m0, s20, s49
  s_nop 0
  buffer_load_dwordx4 v7, s[8:11], s45 offen offset:0 lds
  buffer_load_dwordx4 v8, s[8:11], s45 offen offset:1024 lds
  s_waitcnt lgkmcnt(8)
  v_mfma_f32_16x16x32_bf16 v[84:87], v[220:223], v[156:159], 0
  v_mfma_f32_16x16x32_bf16 v[116:119], v[224:227], v[156:159], 0
  ds_read_b64_tr_b16 v[232:233], v25 offset:0
  s_add_u32 m0, s20, s50
  v_mfma_f32_16x16x32_bf16 v[64:67], v[156:159], v[156:159], 0
  ds_read_b64_tr_b16 v[234:235], v25 offset:2304
  buffer_load_dwordx4 v9, s[12:15], s46 offen offset:0 lds
  v_mfma_f32_16x16x32_bf16 v[56:59], v[52:55], v[156:159], 0
  ds_read_b64_tr_b16 v[236:237], v26 offset:0
  v_mfma_f32_16x16x32_bf16 v[88:91], v[220:223], v[160:163], 0
  ds_read_b64_tr_b16 v[238:239], v26 offset:2304
  v_mfma_f32_16x16x32_bf16 v[120:123], v[224:227], v[160:163], 0
  buffer_load_dwordx4 v10, s[12:15], s46 offen offset:1024 lds
  v_mfma_f32_16x16x32_bf16 v[68:71], v[160:163], v[160:163], 0
  ds_read_b128 v[188:191], v18 offset:0
  v_mfma_f32_16x16x32_bf16 v[60:63], v[52:55], v[160:163], 0
  ds_read_b128 v[192:195], v18 offset:2048
  s_waitcnt lgkmcnt(12)
  v_mfma_f32_16x16x32_bf16 v[148:151], v[228:231], v[156:159], 0
  ds_read_b64_tr_b16 v[240:241], v27 offset:0
  v_mfma_f32_16x16x32_bf16 v[152:155], v[228:231], v[160:163], 0
  buffer_load_dwordx4 v11, s[12:15], s46 offen offset:2048 lds
  s_waitcnt lgkmcnt(10)
  v_mfma_f32_16x16x32_bf16 v[92:95], v[220:223], v[164:167], 0
  ds_read_b64_tr_b16 v[242:243], v27 offset:2304
  v_mfma_f32_16x16x32_bf16 v[124:127], v[224:227], v[164:167], 0
  ds_read_b128 v[196:199], v19 offset:0
  v_mfma_f32_16x16x32_bf16 v[96:99], v[220:223], v[168:171], 0
  ds_read_b128 v[200:203], v19 offset:2048
  buffer_load_dwordx4 v12, s[12:15], s46 offen offset:3072 lds
  v_mfma_f32_16x16x32_bf16 v[128:131], v[224:227], v[168:171], 0
  ds_read_b128 v[204:207], v20 offset:0
  v_mfma_f32_16x16x32_bf16 v[100:103], v[220:223], v[172:175], 0
  v_mfma_f32_16x16x32_bf16 v[132:135], v[224:227], v[172:175], 0
  ds_read_b128 v[208:211], v20 offset:2048
  s_add_u32 m0, s20, s51
  s_waitcnt lgkmcnt(12)
  v_mfma_f32_16x16x32_bf16 v[104:107], v[220:223], v[176:179], 0
  ds_read_b128 v[212:215], v21 offset:0
  s_mov_b32 exec_hi, 0
  buffer_load_dwordx4 v13, s[12:15], s46 offen lds
  s_mov_b32 exec_hi, -1
  v_mfma_f32_16x16x32_bf16 v[136:139], v[224:227], v[176:179], 0
  ds_read_b128 v[216:219], v21 offset:2048
  s_add_u32 s44, s44, 128
  v_mfma_f32_16x16x32_bf16 v[108:111], v[220:223], v[180:183], 0
  s_cmp_eq_u32 s44, 1152
  s_cselect_b32 s44, 0, s44
  v_mfma_f32_16x16x32_bf16 v[140:143], v[224:227], v[180:183], 0
  s_mul_i32 s46, s44, 1728
  v_mfma_f32_16x16x32_bf16 v[112:115], v[220:223], v[184:187], 0
  s_add_u32 s45, s44, 18432
  v_mfma_f32_16x16x32_bf16 v[144:147], v[224:227], v[184:187], 0
  s_add_u32 s20, s20, 34816
  s_waitcnt lgkmcnt(8)
  v_mfma_f32_16x16x32_bf16 v[84:87], v[232:235], v[188:191], v[84:87]
  s_waitcnt vmcnt(9)
  s_barrier
  v_mfma_f32_16x16x32_bf16 v[116:119], v[236:239], v[188:191], v[116:119]
  ds_read_b64_tr_b16 v[220:221], v22 offset:34816
  s_add_u32 m0, s20, s48
  v_mfma_f32_16x16x32_bf16 v[64:67], v[188:191], v[188:191], v[64:67]
  ds_read_b64_tr_b16 v[222:223], v22 offset:37120
  buffer_load_dwordx4 v7, s[8:11], s44 offen offset:0 lds
  v_mfma_f32_16x16x32_bf16 v[56:59], v[52:55], v[188:191], v[56:59]
  ds_read_b64_tr_b16 v[224:225], v23 offset:34816
  v_mfma_f32_16x16x32_bf16 v[88:91], v[232:235], v[192:195], v[88:91]
  ds_read_b64_tr_b16 v[226:227], v23 offset:37120
  v_mfma_f32_16x16x32_bf16 v[120:123], v[236:239], v[192:195], v[120:123]
  buffer_load_dwordx4 v8, s[8:11], s44 offen offset:1024 lds
  v_mfma_f32_16x16x32_bf16 v[68:71], v[192:195], v[192:195], v[68:71]
  ds_read_b128 v[156:159], v14 offset:34816
  v_mfma_f32_16x16x32_bf16 v[60:63], v[52:55], v[192:195], v[60:63]
  ds_read_b128 v[160:163], v14 offset:36864
  s_waitcnt lgkmcnt(12)
  v_mfma_f32_16x16x32_bf16 v[148:151], v[240:243], v[188:191], v[148:151]
  ds_read_b64_tr_b16 v[228:229], v24 offset:34816
  s_add_u32 m0, s20, s49
  v_mfma_f32_16x16x32_bf16 v[152:155], v[240:243], v[192:195], v[152:155]
  buffer_load_dwordx4 v7, s[8:11], s45 offen offset:0 lds
  s_waitcnt lgkmcnt(10)
  v_mfma_f32_16x16x32_bf16 v[92:95], v[232:235], v[196:199], v[92:95]
  ds_read_b64_tr_b16 v[230:231], v24 offset:37120
  v_mfma_f32_16x16x32_bf16 v[124:127], v[236:239], v[196:199], v[124:127]
  ds_read_b128 v[164:167], v15 offset:34816
  v_mfma_f32_16x16x32_bf16 v[96:99], v[232:235], v[200:203], v[96:99]
  ds_read_b128 v[168:171], v15 offset:36864
  buffer_load_dwordx4 v8, s[8:11], s45 offen offset:1024 lds
  v_mfma_f32_16x16x32_bf16 v[128:131], v[236:239], v[200:203], v[128:131]
  ds_read_b128 v[172:175], v16 offset:34816
  v_mfma_f32_16x16x32_bf16 v[100:103], v[232:235], v[204:207], v[100:103]
  v_mfma_f32_16x16x32_bf16 v[132:135], v[236:239], v[204:207], v[132:135]
  ds_read_b128 v[176:179], v16 offset:36864
  s_waitcnt lgkmcnt(12)
  v_mfma_f32_16x16x32_bf16 v[104:107], v[232:235], v[208:211], v[104:107]
  ds_read_b128 v[180:183], v17 offset:34816
  v_mfma_f32_16x16x32_bf16 v[136:139], v[236:239], v[208:211], v[136:139]
  ds_read_b128 v[184:187], v17 offset:36864
  v_mfma_f32_16x16x32_bf16 v[108:111], v[232:235], v[212:215], v[108:111]
  v_mfma_f32_16x16x32_bf16 v[140:143], v[236:239], v[212:215], v[140:143]
  v_mfma_f32_16x16x32_bf16 v[112:115], v[232:235], v[216:219], v[112:115]
  v_mfma_f32_16x16x32_bf16 v[144:147], v[236:239], v[216:219], v[144:147]
L_k1_loop1:
  s_waitcnt lgkmcnt(8)
  v_mfma_f32_16x16x32_bf16 v[84:87], v[220:223], v[156:159], v[84:87]
  v_mfma_f32_16x16x32_bf16 v[116:119], v[224:227], v[156:159], v[116:119]
  ds_read_b64_tr_b16 v[232:233], v25 offset:34816
  s_add_u32 m0, s20, s50
  v_mfma_f32_16x16x32_bf16 v[64:67], v[156:159], v[156:159], v[64:67]
  ds_read_b64_tr_b16 v[234:235], v25 offset:37120
  buffer_load_dwordx4 v9, s[12:15], s46 offen offset:0 lds
  v_mfma_f32_16x16x32_bf16 v[56:59], v[52:55], v[156:159], v[56:59]
  ds_read_b64_tr_b16 v[236:237], v26 offset:34816
  v_add_u32 v14, s56, v14
  v_mfma_f32_16x16x32_bf16 v[88:91], v[220:223], v[160:163], v[88:91]
  ds_read_b64_tr_b16 v[238:239], v26 offset:37120
  v_add_u32 v15, s56, v15
  v_mfma_f32_16x16x32_bf16 v[120:123], v[224:227], v[160:163], v[120:123]
  buffer_load_dwordx4 v10, s[12:15], s46 offen offset:1024 lds
  v_add_u32 v16, s56, v16
  v_mfma_f32_16x16x32_bf16 v[68:71], v[160:163], v[160:163], v[68:71]
  ds_read_b128 v[188:191], v18 offset:34816
  v_add_u32 v17, s56, v17
  v_mfma_f32_16x16x32_bf16 v[60:63], v[52:55], v[160:163], v[60:63]
  ds_read_b128 v[192:195], v18 offset:36864
  v_add_u32 v22, s56, v22
  s_waitcnt lgkmcnt(12)
  v_mfma_f32_16x16x32_bf16 v[148:151], v[228:231], v[156:159], v[148:151]
  ds_read_b64_tr_b16 v[240:241], v27 offset:34816
  v_add_u32 v23, s56, v23
  v_mfma_f32_16x16x32_bf16 v[152:155], v[228:231], v[160:163], v[152:155]
  buffer_load_dwordx4 v11, s[12:15], s46 offen offset:2048 lds
  v_add_u32 v24, s56, v24
  s_waitcnt lgkmcnt(10)
  v_mfma_f32_16x16x32_bf16 v[92:95], v[220:223], v[164:167], v[92:95]
  ds_read_b64_tr_b16 v[242:243], v27 offset:37120
  v_mfma_f32_16x16x32_bf16 v[124:127], v[224:227], v[164:167], v[124:127]
  ds_read_b128 v[196:199], v19 offset:34816
  v_mfma_f32_16x16x32_bf16 v[96:99], v[220:223], v[168:171], v[96:99]
  ds_read_b128 v[200:203], v19 offset:36864
  buffer_load_dwordx4 v12, s[12:15], s46 offen offset:3072 lds
  v_mfma_f32_16x16x32_bf16 v[128:131], v[224:227], v[168:171], v[128:131]
  ds_read_b128 v[204:207], v20 offset:34816
  v_mfma_f32_16x16x32_bf16 v[100:103], v[220:223], v[172:175], v[100:103]
  v_mfma_f32_16x16x32_bf16 v[132:135], v[224:227], v[172:175], v[132:135]
  ds_read_b128 v[208:211], v20 offset:36864
  s_add_u32 m0, s20, s51
  s_waitcnt lgkmcnt(12)
  v_mfma_f32_16x16x32_bf16 v[104:107], v[220:223], v[176:179], v[104:107]
  ds_read_b128 v[212:215], v21 offset:34816
  s_mov_b32 exec_hi, 0
  buffer_load_dwordx4 v13, s[12:15], s46 offen lds
  s_mov_b32 exec_hi, -1
  v_mfma_f32_16x16x32_bf16 v[136:139], v[224:227], v[176:179], v[136:139]
  ds_read_b128 v[216:219], v21 offset:36864
  s_add_u32 s44, s44, 128
  v_mfma_f32_16x16x32_bf16 v[108:111], v[220:223], v[180:183], v[108:111]
  s_cmp_eq_u32 s44, 1152
  s_cselect_b32 s44, 0, s44
  v_mfma_f32_16x16x32_bf16 v[140:143], v[224:227], v[180:183], v[140:143]
  s_mul_i32 s46, s44, 1728
  v_mfma_f32_16x16x32_bf16 v[112:115], v[220:223], v[184:187], v[112:115]
  s_add_u32 s45, s44, 18432
  v_mfma_f32_16x16x32_bf16 v[144:147], v[224:227], v[184:187], v[144:147]
  s_add_u32 s20, s20, 34816
  s_cmp_eq_u32 s20, 139264
  s_cselect_b32 s20, 0, s20
  s_waitcnt lgkmcnt(8)
  v_mfma_f32_16x16x32_bf16 v[84:87], v[232:235], v[188:191], v[84:87]
  s_waitcnt vmcnt(9)
  s_barrier
  v_mfma_f32_16x16x32_bf16 v[116:119], v[236:239], v[188:191], v[116:119]
  ds_read_b64_tr_b16 v[220:221], v22 offset:0
  s_add_u32 m0, s20, s48
  v_mfma_f32_16x16x32_bf16 v[64:67], v[188:191], v[188:191], v[64:67]
  ds_read_b64_tr_b16 v[222:223], v22 offset:2304
  buffer_load_dwordx4 v7, s[8:11], s44 offen offset:0 lds
  v_mfma_f32_16x16x32_bf16 v[56:59], v[52:55], v[188:191], v[56:59]
  ds_read_b64_tr_b16 v[224:225], v23 offset:0
  v_add_u32 v18, s56, v18
  v_mfma_f32_16x16x32_bf16 v[88:91], v[232:235], v[192:195], v[88:91]
  ds_read_b64_tr_b16 v[226:227], v23 offset:2304
  v_add_u32 v19, s56, v19
  v_mfma_f32_16x16x32_bf16 v[120:123], v[236:239], v[192:195], v[120:123]
  buffer_load_dwordx4 v8, s[8:11], s44 offen offset:1024 lds
  v_add_u32 v20, s56, v20
  v_mfma_f32_16x16x32_bf16 v[68:71], v[192:195], v[192:195], v[68:71]
  ds_read_b128 v[156:159], v14 offset:0
  v_add_u32 v21, s56, v21
  v_mfma_f32_16x16x32_bf16 v[60:63], v[52:55], v[192:195], v[60:63]
  ds_read_b128 v[160:163], v14 offset:2048
  v_add_u32 v25, s56, v25
  s_waitcnt lgkmcnt(12)
  v_mfma_f32_16x16x32_bf16 v[148:151], v[240:243], v[188:191], v[148:151]
  ds_read_b64_tr_b16 v[228:229], v24 offset:0
  s_add_u32 m0, s20, s49
  v_mfma_f32_16x16x32_bf16 v[152:155], v[240:243], v[192:195], v[152:155]
  buffer_load_dwordx4 v7, s[8:11], s45 offen offset:0 lds
  v_add_u32 v26, s56, v26
  s_waitcnt lgkmcnt(10)
  v_mfma_f32_16x16x32_bf16 v[92:95], v[232:235], v[196:199], v[92:95]
  ds_read_b64_tr_b16 v[230:231], v24 offset:2304
  v_add_u32 v27, s56, v27
  v_mfma_f32_16x16x32_bf16 v[124:127], v[236:239], v[196:199], v[124:127]
  ds_read_b128 v[164:167], v15 offset:0
  s_sub_u32 s56, 0, s56
  v_mfma_f32_16x16x32_bf16 v[96:99], v[232:235], v[200:203], v[96:99]
  ds_read_b128 v[168:171], v15 offset:2048
  buffer_load_dwordx4 v8, s[8:11], s45 offen offset:1024 lds
  v_mfma_f32_16x16x32_bf16 v[128:131], v[236:239], v[200:203], v[128:131]
  ds_read_b128 v[172:175], v16 offset:0
  v_mfma_f32_16x16x32_bf16 v[100:103], v[232:235], v[204:207], v[100:103]
  v_mfma_f32_16x16x32_bf16 v[132:135], v[236:239], v[204:207], v[132:135]
  ds_read_b128 v[176:179], v16 offset:2048
  s_waitcnt lgkmcnt(12)
  v_mfma_f32_16x16x32_bf16 v[104:107], v[232:235], v[208:211], v[104:107]
  ds_read_b128 v[180:183], v17 offset:0
  v_mfma_f32_16x16x32_bf16 v[136:139], v[236:239], v[208:211], v[136:139]
  ds_read_b128 v[184:187], v17 offset:2048
  v_mfma_f32_16x16x32_bf16 v[108:111], v[232:235], v[212:215], v[108:111]
  v_mfma_f32_16x16x32_bf16 v[140:143], v[236:239], v[212:215], v[140:143]
  v_mfma_f32_16x16x32_bf16 v[112:115], v[232:235], v[216:219], v[112:115]
  v_mfma_f32_16x16x32_bf16 v[144:147], v[236:239], v[216:219], v[144:147]
  s_waitcnt lgkmcnt(8)
  v_mfma_f32_16x16x32_bf16 v[84:87], v[220:223], v[156:159], v[84:87]
  v_mfma_f32_16x16x32_bf16 v[116:119], v[224:227], v[156:159], v[116:119]
  ds_read_b64_tr_b16 v[232:233], v25 offset:0
  s_add_u32 m0, s20, s50
  v_mfma_f32_16x16x32_bf16 v[64:67], v[156:159], v[156:159], v[64:67]
  ds_read_b64_tr_b16 v[234:235], v25 offset:2304
  buffer_load_dwordx4 v9, s[12:15], s46 offen offset:0 lds
  v_mfma_f32_16x16x32_bf16 v[56:59], v[52:55], v[156:159], v[56:59]
  ds_read_b64_tr_b16 v[236:237], v26 offset:0
  v_mfma_f32_16x16x32_bf16 v[88:91], v[220:223], v[160:163], v[88:91]
  ds_read_b64_tr_b16 v[238:239], v26 offset:2304
  v_mfma_f32_16x16x32_bf16 v[120:123], v[224:227], v[160:163], v[120:123]
  buffer_load_dwordx4 v10, s[12:15], s46 offen offset:1024 lds
  v_mfma_f32_16x16x32_bf16 v[68:71], v[160:163], v[160:163], v[68:71]
  ds_read_b128 v[188:191], v18 offset:0
  v_mfma_f32_16x16x32_bf16 v[60:63], v[52:55], v[160:163], v[60:63]
  ds_read_b128 v[192:195], v18 offset:2048
  s_waitcnt lgkmcnt(12)
  v_mfma_f32_16x16x32_bf16 v[148:151], v[228:231], v[156:159], v[148:151]
  ds_read_b64_tr_b16 v[240:241], v27 offset:0
  v_mfma_f32_16x16x32_bf16 v[152:155], v[228:231], v[160:163], v[152:155]
  buffer_load_dwordx4 v11, s[12:15], s46 offen offset:2048 lds
  s_waitcnt lgkmcnt(10)
  v_mfma_f32_16x16x32_bf16 v[92:95], v[220:223], v[164:167], v[92:95]
  ds_read_b64_tr_b16 v[242:243], v27 offset:2304
  v_mfma_f32_16x16x32_bf16 v[124:127], v[224:227], v[164:167], v[124:127]
  ds_read_b128 v[196:199], v19 offset:0
  v_mfma_f32_16x16x32_bf16 v[96:99], v[220:223], v[168:171], v[96:99]
  ds_read_b128 v[200:203], v19 offset:2048
  buffer_load_dwordx4 v12, s[12:15], s46 offen offset:3072 lds
  v_mfma_f32_16x16x32_bf16 v[128:131], v[224:227], v[168:171], v[128:131]
  ds_read_b128 v[204:207], v20 offset:0
  v_mfma_f32_16x16x32_bf16 v[100:103], v[220:223], v[172:175], v[100:103]
  v_mfma_f32_16x16x32_bf16 v[132:135], v[224:227], v[172:175], v[132:135]
  ds_read_b128 v[208:211], v20 offset:2048
  s_add_u32 m0, s20, s51
  s_waitcnt lgkmcnt(12)
  v_mfma_f32_16x16x32_bf16 v[104:107], v[220:223], v[176:179], v[104:107]
  ds_read_b128 v[212:215], v21 offset:0
  s_mov_b32 exec_hi, 0
  buffer_load_dwordx4 v13, s[12:15], s46 offen lds
  s_mov_b32 exec_hi, -1
  v_mfma_f32_16x16x32_bf16 v[136:139], v[224:227], v[176:179], v[136:139]
  ds_read_b128 v[216:219], v21 offset:2048
  s_add_u32 s44, s44, 128
  v_mfma_f32_16x16x32_bf16 v[108:111], v[220:223], v[180:183], v[108:111]
  s_cmp_eq_u32 s44, 1152
  s_cselect_b32 s44, 0, s44
  v_mfma_f32_16x16x32_bf16 v[140:143], v[224:227], v[180:183], v[140:143]
  s_mul_i32 s46, s44, 1728
  v_mfma_f32_16x16x32_bf16 v[112:115], v[220:223], v[184:187], v[112:115]
  s_add_u32 s45, s44, 18432
  v_mfma_f32_16x16x32_bf16 v[144:147], v[224:227], v[184:187], v[144:147]
  s_add_u32 s20, s20, 34816
  s_cmp_eq_u32 s21, 2
  s_cselect_b32 s10, 0, s10
  s_cselect_b32 s14, 0, s14
  s_waitcnt lgkmcnt(8)
  v_mfma_f32_16x16x32_bf16 v[84:87], v[232:235], v[188:191], v[84:87]
  s_waitcnt vmcnt(9)
  s_barrier
  v_mfma_f32_16x16x32_bf16 v[116:119], v[236:239], v[188:191], v[116:119]
  ds_read_b64_tr_b16 v[220:221], v22 offset:34816
  s_add_u32 m0, s20, s48
  v_mfma_f32_16x16x32_bf16 v[64:67], v[188:191], v[188:191], v[64:67]
  ds_read_b64_tr_b16 v[222:223], v22 offset:37120
  buffer_load_dwordx4 v7, s[8:11], s44 offen offset:0 lds
  v_mfma_f32_16x16x32_bf16 v[56:59], v[52:55], v[188:191], v[56:59]
  ds_read_b64_tr_b16 v[224:225], v23 offset:34816
  v_mfma_f32_16x16x32_bf16 v[88:91], v[232:235], v[192:195], v[88:91]
  ds_read_b64_tr_b16 v[226:227], v23 offset:37120
  v_mfma_f32_16x16x32_bf16 v[120:123], v[236:239], v[192:195], v[120:123]
  buffer_load_dwordx4 v8, s[8:11], s44 offen offset:1024 lds
  v_mfma_f32_16x16x32_bf16 v[68:71], v[192:195], v[192:195], v[68:71]
  ds_read_b128 v[156:159], v14 offset:34816
  v_mfma_f32_16x16x32_bf16 v[60:63], v[52:55], v[192:195], v[60:63]
  ds_read_b128 v[160:163], v14 offset:36864
  s_waitcnt lgkmcnt(12)
  v_mfma_f32_16x16x32_bf16 v[148:151], v[240:243], v[188:191], v[148:151]
  ds_read_b64_tr_b16 v[228:229], v24 offset:34816
  s_add_u32 m0, s20, s49
  v_mfma_f32_16x16x32_bf16 v[152:155], v[240:243], v[192:195], v[152:155]
  buffer_load_dwordx4 v7, s[8:11], s45 offen offset:0 lds
  s_waitcnt lgkmcnt(10)
  v_mfma_f32_16x16x32_bf16 v[92:95], v[232:235], v[196:199], v[92:95]
  ds_read_b64_tr_b16 v[230:231], v24 offset:37120
  v_mfma_f32_16x16x32_bf16 v[124:127], v[236:239], v[196:199], v[124:127]
  ds_read_b128 v[164:167], v15 offset:34816
  v_mfma_f32_16x16x32_bf16 v[96:99], v[232:235], v[200:203], v[96:99]
  ds_read_b128 v[168:171], v15 offset:36864
  buffer_load_dwordx4 v8, s[8:11], s45 offen offset:1024 lds
  v_mfma_f32_16x16x32_bf16 v[128:131], v[236:239], v[200:203], v[128:131]
  ds_read_b128 v[172:175], v16 offset:34816
  v_mfma_f32_16x16x32_bf16 v[100:103], v[232:235], v[204:207], v[100:103]
  v_mfma_f32_16x16x32_bf16 v[132:135], v[236:239], v[204:207], v[132:135]
  ds_read_b128 v[176:179], v16 offset:36864
  s_waitcnt lgkmcnt(12)
  v_mfma_f32_16x16x32_bf16 v[104:107], v[232:235], v[208:211], v[104:107]
  ds_read_b128 v[180:183], v17 offset:34816
  v_mfma_f32_16x16x32_bf16 v[136:139], v[236:239], v[208:211], v[136:139]
  ds_read_b128 v[184:187], v17 offset:36864
  v_mfma_f32_16x16x32_bf16 v[108:111], v[232:235], v[212:215], v[108:111]
  v_mfma_f32_16x16x32_bf16 v[140:143], v[236:239], v[212:215], v[140:143]
  v_mfma_f32_16x16x32_bf16 v[112:115], v[232:235], v[216:219], v[112:115]
  v_mfma_f32_16x16x32_bf16 v[144:147], v[236:239], v[216:219], v[144:147]
  s_add_u32 s21, s21, 1
  s_cmp_lt_u32 s21, 3
  s_cbranch_scc1 L_k1_loop1
  s_waitcnt lgkmcnt(8)
  v_mfma_f32_16x16x32_bf16 v[84:87], v[220:223], v[156:159], v[84:87]
  v_mfma_f32_16x16x32_bf16 v[116:119], v[224:227], v[156:159], v[116:119]
  ds_read_b64_tr_b16 v[232:233], v25 offset:34816
  s_mov_b32 s24, s4
  s_mov_b32 s25, s5
  v_mfma_f32_16x16x32_bf16 v[64:67], v[156:159], v[156:159], v[64:67]
  ds_read_b64_tr_b16 v[234:235], v25 offset:37120
  s_and_b32 s25, s25, 0xffff
  s_mov_b32 s26, 256
  v_mfma_f32_16x16x32_bf16 v[56:59], v[52:55], v[156:159], v[56:59]
  ds_read_b64_tr_b16 v[236:237], v26 offset:34816
  v_add_u32 v14, s56, v14
  s_mov_b32 s27, 0x20000
  v_mfma_f32_16x16x32_bf16 v[88:91], v[220:223], v[160:163], v[88:91]
  ds_read_b64_tr_b16 v[238:239], v26 offset:37120
  v_add_u32 v15, s56, v15
  buffer_load_dword v11, off, s[24:27], 0 offset:128 sc1
  v_mfma_f32_16x16x32_bf16 v[120:123], v[224:227], v[160:163], v[120:123]
  v_add_u32 v16, s56, v16
  s_add_u32 s40, s6, 11491328
  s_addc_u32 s41, s7, 0
  v_mfma_f32_16x16x32_bf16 v[68:71], v[160:163], v[160:163], v[68:71]
  ds_read_b128 v[188:191], v18 offset:34816
  v_add_u32 v17, s56, v17
  s_and_b32 s41, s41, 0xffff
  v_mfma_f32_16x16x32_bf16 v[60:63], v[52:55], v[160:163], v[60:63]
  ds_read_b128 v[192:195], v18 offset:36864
  v_add_u32 v22, s56, v22
  s_mov_b32 s42, 20736
  s_waitcnt lgkmcnt(12)
  v_mfma_f32_16x16x32_bf16 v[148:151], v[228:231], v[156:159], v[148:151]
  ds_read_b64_tr_b16 v[240:241], v27 offset:34816
  v_add_u32 v23, s56, v23
  s_mov_b32 s43, 0x20000
  v_mfma_f32_16x16x32_bf16 v[152:155], v[228:231], v[160:163], v[152:155]
  v_add_u32 v24, s56, v24
  s_mul_i32 s52, s33, 576
  v_lshlrev_b32 v10, 4, v5
  s_waitcnt lgkmcnt(10)
  v_mfma_f32_16x16x32_bf16 v[92:95], v[220:223], v[164:167], v[92:95]
  ds_read_b64_tr_b16 v[242:243], v27 offset:37120
  s_lshl_b32 s53, s22, 1
  s_add_u32 s53, s53, s52
  v_mfma_f32_16x16x32_bf16 v[124:127], v[224:227], v[164:167], v[124:127]
  ds_read_b128 v[196:199], v19 offset:34816
  v_add_u32 v7, s53, v10
  s_lshl_b32 s53, s23, 1
  v_mfma_f32_16x16x32_bf16 v[96:99], v[220:223], v[168:171], v[96:99]
  ds_read_b128 v[200:203], v19 offset:36864
  s_add_u32 s53, s53, s52
  v_add_u32 v8, s53, v10
  v_mfma_f32_16x16x32_bf16 v[128:131], v[224:227], v[168:171], v[128:131]
  ds_read_b128 v[204:207], v20 offset:34816
  v_mul_u32_u24 v9, 144, v5
  s_add_u32 s52, s52, 64
  v_mfma_f32_16x16x32_bf16 v[100:103], v[220:223], v[172:175], v[100:103]
  v_add_u32 v9, s52, v9
  s_movk_i32 s80, 6912
  s_movk_i32 s81, 13824
  v_mfma_f32_16x16x32_bf16 v[132:135], v[224:227], v[172:175], v[132:135]
  ds_read_b128 v[208:211], v20 offset:36864
  v_and_b32 v2, 3, v6
  v_lshrrev_b32 v3, 2, v6
  s_waitcnt lgkmcnt(12)
  v_mfma_f32_16x16x32_bf16 v[104:107], v[220:223], v[176:179], v[104:107]
  ds_read_b128 v[212:215], v21 offset:34816
  v_cmp_eq_u32 s[58:59], 1, v2
  v_cmp_eq_u32 s[60:61], 2, v2
  v_mfma_f32_16x16x32_bf16 v[136:139], v[224:227], v[176:179], v[136:139]
  ds_read_b128 v[216:219], v21 offset:36864
  v_cmp_eq_u32 s[62:63], 3, v2
  v_cmp_eq_u32 s[64:65], v3, v5
  v_mfma_f32_16x16x32_bf16 v[108:111], v[220:223], v[180:183], v[108:111]
  v_lshlrev_b32 v246, 2, v6
  v_lshlrev_b32 v247, 5, v5
  v_mfma_f32_16x16x32_bf16 v[140:143], v[224:227], v[180:183], v[140:143]
  v_mfma_f32_16x16x32_bf16 v[112:115], v[220:223], v[184:187], v[112:115]
  v_mfma_f32_16x16x32_bf16 v[144:147], v[224:227], v[184:187], v[144:147]
  s_waitcnt lgkmcnt(8)
  v_mfma_f32_16x16x32_bf16 v[84:87], v[232:235], v[188:191], v[84:87]
  s_waitcnt vmcnt(5)
  s_barrier
  v_mfma_f32_16x16x32_bf16 v[116:119], v[236:239], v[188:191], v[116:119]
  ds_read_b64_tr_b16 v[220:221], v22 offset:0
  v_lshlrev_b32 v248, 4, v5
  v_mov_b32 v46, s55
  v_mfma_f32_16x16x32_bf16 v[64:67], v[188:191], v[188:191], v[64:67]
  ds_read_b64_tr_b16 v[222:223], v22 offset:2304
  v_mov_b32 v50, s54
  s_lshl_b32 s35, s32, 7
  v_mfma_f32_16x16x32_bf16 v[56:59], v[52:55], v[188:191], v[56:59]
  ds_read_b64_tr_b16 v[224:225], v23 offset:0
  v_add_u32 v18, s56, v18
  s_add_u32 s35, s35, 139264
  v_mfma_f32_16x16x32_bf16 v[88:91], v[232:235], v[192:195], v[88:91]
  ds_read_b64_tr_b16 v[226:227], v23 offset:2304
  v_add_u32 v19, s56, v19
  v_add_u32 v28, s35, v246
  v_mfma_f32_16x16x32_bf16 v[120:123], v[236:239], v[192:195], v[120:123]
  v_add_u32 v20, s56, v20
  s_lshl_b32 s35, s28, 7
  s_add_u32 s35, s35, 139264
  v_mfma_f32_16x16x32_bf16 v[68:71], v[192:195], v[192:195], v[68:71]
  ds_read_b128 v[156:159], v14 offset:0
  v_add_u32 v21, s56, v21
  v_add_u32 v29, s35, v246
  v_mfma_f32_16x16x32_bf16 v[60:63], v[52:55], v[192:195], v[60:63]
  ds_read_b128 v[160:163], v14 offset:2048
  v_add_u32 v25, s56, v25
  s_lshl_b32 s35, s29, 7
  s_waitcnt lgkmcnt(12)
  v_mfma_f32_16x16x32_bf16 v[148:151], v[240:243], v[188:191], v[148:151]
  ds_read_b64_tr_b16 v[228:229], v24 offset:0
  v_add_u32 v26, s56, v26
  s_add_u32 s35, s35, 139264
  v_mfma_f32_16x16x32_bf16 v[152:155], v[240:243], v[192:195], v[152:155]
  v_add_u32 v27, s56, v27
  v_add_u32 v30, s35, v246
  s_lshl_b32 s35, s30, 7
  s_waitcnt lgkmcnt(10)
  v_mfma_f32_16x16x32_bf16 v[92:95], v[232:235], v[196:199], v[92:95]
  ds_read_b64_tr_b16 v[230:231], v24 offset:2304
  s_sub_u32 s56, 0, s56
  s_add_u32 s35, s35, 139264
  v_mfma_f32_16x16x32_bf16 v[124:127], v[236:239], v[196:199], v[124:127]
  ds_read_b128 v[164:167], v15 offset:0
  v_add_u32 v31, s35, v246
  s_lshl_b32 s35, s31, 7
  v_mfma_f32_16x16x32_bf16 v[96:99], v[232:235], v[200:203], v[96:99]
  ds_read_b128 v[168:171], v15 offset:2048
  s_add_u32 s35, s35, 139264
  v_add_u32 v32, s35, v246
  v_mfma_f32_16x16x32_bf16 v[128:131], v[236:239], v[200:203], v[128:131]
  ds_read_b128 v[172:175], v16 offset:0
  s_lshl_b32 s35, s34, 5
  s_add_u32 s35, s35, s33
  v_mfma_f32_16x16x32_bf16 v[100:103], v[232:235], v[204:207], v[100:103]
  s_mul_i32 s35, s35, 4608
  s_add_u32 s16, s6, s35
  s_addc_u32 s17, s7, 0
  v_mfma_f32_16x16x32_bf16 v[132:135], v[236:239], v[204:207], v[132:135]
  ds_read_b128 v[176:179], v16 offset:2048
  s_add_u32 s16, s16, 11558912
  s_addc_u32 s17, s17, 0
  s_waitcnt lgkmcnt(12)
  v_mfma_f32_16x16x32_bf16 v[104:107], v[232:235], v[208:211], v[104:107]
  ds_read_b128 v[180:183], v17 offset:0
  s_and_b32 s17, s17, 0xffff
  s_mov_b32 s18, 147456
  v_mfma_f32_16x16x32_bf16 v[136:139], v[236:239], v[208:211], v[136:139]
  ds_read_b128 v[184:187], v17 offset:2048
  s_mov_b32 s19, 0x20000
  s_lshl_b32 s36, s32, 10
  v_mfma_f32_16x16x32_bf16 v[108:111], v[232:235], v[212:215], v[108:111]
  s_mul_i32 s72, s28, 36864
  s_add_u32 s72, s72, s36
  s_mul_i32 s73, s29, 36864
  v_mfma_f32_16x16x32_bf16 v[140:143], v[236:239], v[212:215], v[140:143]
  s_add_u32 s73, s73, s36
  s_mul_i32 s74, s30, 36864
  v_mfma_f32_16x16x32_bf16 v[112:115], v[232:235], v[216:219], v[112:115]
  v_mfma_f32_16x16x32_bf16 v[144:147], v[236:239], v[216:219], v[144:147]
  s_waitcnt lgkmcnt(8)
  v_mfma_f32_16x16x32_bf16 v[84:87], v[220:223], v[156:159], v[84:87]
  v_mfma_f32_16x16x32_bf16 v[116:119], v[224:227], v[156:159], v[116:119]
  ds_read_b64_tr_b16 v[232:233], v25 offset:0
  s_waitcnt vmcnt(0)
  v_readfirstlane_b32 s52, v11
  s_nop 1
  s_cmp_ge_u32 s52, 81
  s_cbranch_scc0 L_k1_cw1
  L_k1_ck1:
  v_mfma_f32_16x16x32_bf16 v[64:67], v[156:159], v[156:159], v[64:67]
  ds_read_b64_tr_b16 v[234:235], v25 offset:2304
  s_add_u32 s74, s74, s36
  v_mfma_f32_16x16x32_bf16 v[56:59], v[52:55], v[156:159], v[56:59]
  ds_read_b64_tr_b16 v[236:237], v26 offset:0
  s_mul_i32 s75, s31, 36864
  v_mfma_f32_16x16x32_bf16 v[88:91], v[220:223], v[160:163], v[88:91]
  ds_read_b64_tr_b16 v[238:239], v26 offset:2304
  s_add_u32 s75, s75, s36
  v_mfma_f32_16x16x32_bf16 v[120:123], v[224:227], v[160:163], v[120:123]
  s_mul_i32 s76, s32, 36864
  s_add_u32 s76, s76, 4096
  v_mfma_f32_16x16x32_bf16 v[68:71], v[160:163], v[160:163], v[68:71]
  ds_read_b128 v[188:191], v18 offset:0
  v_lshlrev_b32 v38, 3, v1
  v_mfma_f32_16x16x32_bf16 v[60:63], v[52:55], v[160:163], v[60:63]
  ds_read_b128 v[192:195], v18 offset:2048
  v_add_u32 v39, 18432, v38
  s_waitcnt lgkmcnt(12)
  v_mfma_f32_16x16x32_bf16 v[148:151], v[228:231], v[156:159], v[148:151]
  ds_read_b64_tr_b16 v[240:241], v27 offset:0
  v_add_u32 v40, 18432, v4
  v_mfma_f32_16x16x32_bf16 v[152:155], v[228:231], v[160:163], v[152:155]
  v_add_u32 v3, 64, v28
  s_waitcnt lgkmcnt(10)
  v_mfma_f32_16x16x32_bf16 v[92:95], v[220:223], v[164:167], v[92:95]
  ds_read_b64_tr_b16 v[242:243], v27 offset:2304
  v_mfma_f32_16x16x32_bf16 v[124:127], v[224:227], v[164:167], v[124:127]
  ds_read_b128 v[196:199], v19 offset:0
  v_mfma_f32_16x16x32_bf16 v[96:99], v[220:223], v[168:171], v[96:99]
  ds_read_b128 v[200:203], v19 offset:2048
  v_mfma_f32_16x16x32_bf16 v[128:131], v[224:227], v[168:171], v[128:131]
  ds_read_b128 v[204:207], v20 offset:0
  v_mfma_f32_16x16x32_bf16 v[100:103], v[220:223], v[172:175], v[100:103]
  v_mfma_f32_16x16x32_bf16 v[132:135], v[224:227], v[172:175], v[132:135]
  ds_read_b128 v[208:211], v20 offset:2048
  s_waitcnt lgkmcnt(12)
  v_mfma_f32_16x16x32_bf16 v[104:107], v[220:223], v[176:179], v[104:107]
  ds_read_b128 v[212:215], v21 offset:0
  v_mfma_f32_16x16x32_bf16 v[136:139], v[224:227], v[176:179], v[136:139]
  ds_read_b128 v[216:219], v21 offset:2048
  v_mfma_f32_16x16x32_bf16 v[108:111], v[220:223], v[180:183], v[108:111]
  v_mfma_f32_16x16x32_bf16 v[140:143], v[224:227], v[180:183], v[140:143]
  v_mfma_f32_16x16x32_bf16 v[112:115], v[220:223], v[184:187], v[112:115]
  v_mfma_f32_16x16x32_bf16 v[144:147], v[224:227], v[184:187], v[144:147]
  s_waitcnt lgkmcnt(8)
  v_mfma_f32_16x16x32_bf16 v[84:87], v[232:235], v[188:191], v[84:87]
  v_mfma_f32_16x16x32_bf16 v[116:119], v[236:239], v[188:191], v[116:119]
  buffer_load_dwordx4 v[72:75], v7, s[40:43], 0 offen sc1
  buffer_load_dwordx4 v[220:223], v7, s[40:43], s80 offen sc1
  v_mfma_f32_16x16x32_bf16 v[64:67], v[188:191], v[188:191], v[64:67]
  buffer_load_dwordx4 v[176:179], v7, s[40:43], s81 offen sc1
  buffer_load_dwordx4 v[76:79], v8, s[40:43], 0 offen sc1
  v_mfma_f32_16x16x32_bf16 v[56:59], v[52:55], v[188:191], v[56:59]
  buffer_load_dwordx4 v[224:227], v8, s[40:43], s80 offen sc1
  buffer_load_dwordx4 v[180:183], v8, s[40:43], s81 offen sc1
  v_mfma_f32_16x16x32_bf16 v[88:91], v[232:235], v[192:195], v[88:91]
  buffer_load_dwordx4 v[80:83], v9, s[40:43], 0 offen sc1
  buffer_load_dwordx4 v[228:231], v9, s[40:43], s80 offen sc1
  v_mfma_f32_16x16x32_bf16 v[120:123], v[236:239], v[192:195], v[120:123]
  buffer_load_dwordx4 v[184:187], v9, s[40:43], s81 offen sc1
  v_mfma_f32_16x16x32_bf16 v[68:71], v[192:195], v[192:195], v[68:71]
  v_mfma_f32_16x16x32_bf16 v[60:63], v[52:55], v[192:195], v[60:63]
  s_waitcnt lgkmcnt(6)
  v_mfma_f32_16x16x32_bf16 v[148:151], v[240:243], v[188:191], v[148:151]
  v_mfma_f32_16x16x32_bf16 v[152:155], v[240:243], v[192:195], v[152:155]
  s_mov_b32 s52, 0x3ae38e39
  s_mov_b32 s53, 0x3727c5ac
  s_waitcnt lgkmcnt(3)
  v_mfma_f32_16x16x32_bf16 v[92:95], v[232:235], v[196:199], v[92:95]
  v_cndmask_b32 v64, v64, v65, s[58:59]
  v_cndmask_b32 v64, v64, v66, s[60:61]
  v_mfma_f32_16x16x32_bf16 v[124:127], v[236:239], v[196:199], v[124:127]
  v_cndmask_b32 v64, v64, v67, s[62:63]
  v_cndmask_b32 v68, v68, v69, s[58:59]
  v_mfma_f32_16x16x32_bf16 v[96:99], v[232:235], v[200:203], v[96:99]
  v_cndmask_b32 v68, v68, v70, s[60:61]
  v_cndmask_b32 v68, v68, v71, s[62:63]
  v_mfma_f32_16x16x32_bf16 v[128:131], v[236:239], v[200:203], v[128:131]
  v_mul_f32 v65, s52, v56
  v_mul_f32 v64, s52, v64
  v_mfma_f32_16x16x32_bf16 v[100:103], v[232:235], v[204:207], v[100:103]
  v_fma_f32 v64, -v65, v65, v64
  v_max_f32 v64, 0, v64
  v_mfma_f32_16x16x32_bf16 v[132:135], v[236:239], v[204:207], v[132:135]
  v_add_f32 v64, s53, v64
  v_rsq_f32 v64, v64
  s_waitcnt lgkmcnt(0)
  v_mfma_f32_16x16x32_bf16 v[104:107], v[232:235], v[208:211], v[104:107]
  v_mul_f32 v69, s52, v60
  v_mul_f32 v68, s52, v68
  v_mfma_f32_16x16x32_bf16 v[136:139], v[236:239], v[208:211], v[136:139]
  v_fma_f32 v68, -v69, v69, v68
  v_max_f32 v68, 0, v68
  v_mfma_f32_16x16x32_bf16 v[108:111], v[232:235], v[212:215], v[108:111]
  v_add_f32 v68, s53, v68
  v_rsq_f32 v68, v68
  v_mfma_f32_16x16x32_bf16 v[140:143], v[236:239], v[212:215], v[140:143]
  v_mul_f32 v65, -v65, v64
  v_mul_f32 v69, -v69, v68
  v_mfma_f32_16x16x32_bf16 v[112:115], v[232:235], v[216:219], v[112:115]
  s_mov_b64 exec, s[64:65]
  ds_write2st64_b32 v28, v64, v65 offset0:0 offset1:2
  ds_write2st64_b32 v3, v68, v69 offset0:0 offset1:2
  s_mov_b64 exec, -1
  v_mfma_f32_16x16x32_bf16 v[144:147], v[236:239], v[216:219], v[144:147]
  s_waitcnt lgkmcnt(0)
  s_barrier
  ds_read2_b32 v[156:157], v29 offset0:0 offset1:128
  ds_read2_b32 v[158:159], v29 offset0:16 offset1:144
  ds_read2_b32 v[160:161], v30 offset0:0 offset1:128
  ds_read2_b32 v[162:163], v30 offset0:16 offset1:144
  ds_read2_b32 v[164:165], v31 offset0:0 offset1:128
  ds_read2_b32 v[166:167], v31 offset0:16 offset1:144
  ds_read2_b32 v[168:169], v32 offset0:0 offset1:128
  ds_read2_b32 v[170:171], v32 offset0:16 offset1:144
  s_waitcnt vmcnt(7)
  v_pk_add_f32 v[72:73], v[72:73], v[220:221]
  v_pk_add_f32 v[74:75], v[74:75], v[222:223]
  s_waitcnt vmcnt(4)
  v_pk_add_f32 v[76:77], v[76:77], v[224:225]
  v_pk_add_f32 v[78:79], v[78:79], v[226:227]
  s_waitcnt vmcnt(1)
  v_pk_add_f32 v[80:81], v[80:81], v[228:229]
  v_pk_add_f32 v[82:83], v[82:83], v[230:231]
  v_pk_add_f32 v[72:73], v[72:73], v[176:177]
  v_pk_add_f32 v[74:75], v[74:75], v[178:179]
  v_pk_add_f32 v[76:77], v[76:77], v[180:181]
  v_pk_add_f32 v[78:79], v[78:79], v[182:183]
  s_waitcnt vmcnt(0)
  v_pk_add_f32 v[80:81], v[80:81], v[184:185]
  v_pk_add_f32 v[82:83], v[82:83], v[186:187]
  s_waitcnt lgkmcnt(7)
  v_pk_fma_f32 v[244:245], v[72:73], v[156:157], v[46:47] op_sel:[0,1,0] op_sel_hi:[1,1,0]
  v_pk_fma_f32 v[248:249], v[76:77], v[156:157], v[46:47] op_sel:[0,1,0] op_sel_hi:[1,1,0]
  v_pk_fma_f32 v[246:247], v[74:75], v[156:157], v[46:47] op_sel:[0,1,0] op_sel_hi:[1,1,0]
  v_pk_fma_f32 v[250:251], v[78:79], v[156:157], v[46:47] op_sel:[0,1,0] op_sel_hi:[1,1,0]
  v_pk_fma_f32 v[84:85], v[84:85], v[156:157], v[244:245] op_sel_hi:[1,0,1]
  v_pk_fma_f32 v[116:117], v[116:117], v[156:157], v[248:249] op_sel_hi:[1,0,1]
  v_pk_fma_f32 v[86:87], v[86:87], v[156:157], v[246:247] op_sel_hi:[1,0,1]
  v_pk_fma_f32 v[118:119], v[118:119], v[156:157], v[250:251] op_sel_hi:[1,0,1]
  v_pk_mul_f32 v[244:245], v[84:85], v[50:51] op_sel_hi:[1,0]
  v_pk_mul_f32 v[248:249], v[116:117], v[50:51] op_sel_hi:[1,0]
  v_pk_mul_f32 v[246:247], v[86:87], v[50:51] op_sel_hi:[1,0]
  v_pk_mul_f32 v[250:251], v[118:119], v[50:51] op_sel_hi:[1,0]
  v_exp_f32 v244, v244 clamp
  v_exp_f32 v248, v248 clamp
  v_exp_f32 v245, v245 clamp
  v_exp_f32 v249, v249 clamp
  v_exp_f32 v246, v246 clamp
  v_exp_f32 v250, v250 clamp
  v_exp_f32 v247, v247 clamp
  v_exp_f32 v251, v251 clamp
  v_max_f32 v84, s55, v84
  v_max_f32 v116, s55, v116
  v_max_f32 v85, s55, v85
  v_max_f32 v117, s55, v117
  v_max_f32 v86, s55, v86
  v_max_f32 v118, s55, v118
  v_max_f32 v87, s55, v87
  v_max_f32 v119, s55, v119
  v_pk_add_f32 v[84:85], v[84:85], v[244:245]
  v_pk_add_f32 v[116:117], v[116:117], v[248:249]
  v_pk_add_f32 v[86:87], v[86:87], v[246:247]
  v_pk_add_f32 v[118:119], v[118:119], v[250:251]
  v_cvt_pk_bf16_f32 v172, v84, v85
  v_cvt_pk_bf16_f32 v174, v116, v117
  v_cvt_pk_bf16_f32 v173, v86, v87
  v_cvt_pk_bf16_f32 v175, v118, v119
  buffer_store_dwordx4 v[172:175], v4, s[16:19], s72 offen sc1
  s_waitcnt lgkmcnt(6)
  v_pk_fma_f32 v[244:245], v[72:73], v[158:159], v[46:47] op_sel:[0,1,0] op_sel_hi:[1,1,0]
  v_pk_fma_f32 v[248:249], v[76:77], v[158:159], v[46:47] op_sel:[0,1,0] op_sel_hi:[1,1,0]
  v_pk_fma_f32 v[246:247], v[74:75], v[158:159], v[46:47] op_sel:[0,1,0] op_sel_hi:[1,1,0]
  v_pk_fma_f32 v[250:251], v[78:79], v[158:159], v[46:47] op_sel:[0,1,0] op_sel_hi:[1,1,0]
  v_pk_fma_f32 v[88:89], v[88:89], v[158:159], v[244:245] op_sel_hi:[1,0,1]
  v_pk_fma_f32 v[120:121], v[120:121], v[158:159], v[248:249] op_sel_hi:[1,0,1]
  v_pk_fma_f32 v[90:91], v[90:91], v[158:159], v[246:247] op_sel_hi:[1,0,1]
  v_pk_fma_f32 v[122:123], v[122:123], v[158:159], v[250:251] op_sel_hi:[1,0,1]
  v_pk_mul_f32 v[244:245], v[88:89], v[50:51] op_sel_hi:[1,0]
  v_pk_mul_f32 v[248:249], v[120:121], v[50:51] op_sel_hi:[1,0]
  v_pk_mul_f32 v[246:247], v[90:91], v[50:51] op_sel_hi:[1,0]
  v_pk_mul_f32 v[250:251], v[122:123], v[50:51] op_sel_hi:[1,0]
  v_exp_f32 v244, v244 clamp
  v_exp_f32 v248, v248 clamp
  v_exp_f32 v245, v245 clamp
  v_exp_f32 v249, v249 clamp
  v_exp_f32 v246, v246 clamp
  v_exp_f32 v250, v250 clamp
  v_exp_f32 v247, v247 clamp
  v_exp_f32 v251, v251 clamp
  v_max_f32 v88, s55, v88
  v_max_f32 v120, s55, v120
  v_max_f32 v89, s55, v89
  v_max_f32 v121, s55, v121
  v_max_f32 v90, s55, v90
  v_max_f32 v122, s55, v122
  v_max_f32 v91, s55, v91
  v_max_f32 v123, s55, v123
  v_pk_add_f32 v[88:89], v[88:89], v[244:245]
  v_pk_add_f32 v[120:121], v[120:121], v[248:249]
  v_pk_add_f32 v[90:91], v[90:91], v[246:247]
  v_pk_add_f32 v[122:123], v[122:123], v[250:251]
  v_cvt_pk_bf16_f32 v176, v88, v89
  v_cvt_pk_bf16_f32 v178, v120, v121
  v_cvt_pk_bf16_f32 v177, v90, v91
  v_cvt_pk_bf16_f32 v179, v122, v123
  buffer_store_dwordx4 v[176:179], v40, s[16:19], s72 offen sc1
  v_pk_fma_f32 v[244:245], v[80:81], v[156:157], v[46:47] op_sel:[0,1,0] op_sel_hi:[1,1,0]
  v_pk_fma_f32 v[248:249], v[80:81], v[158:159], v[46:47] op_sel:[0,1,0] op_sel_hi:[1,1,0]
  v_pk_fma_f32 v[246:247], v[82:83], v[156:157], v[46:47] op_sel:[0,1,0] op_sel_hi:[1,1,0]
  v_pk_fma_f32 v[250:251], v[82:83], v[158:159], v[46:47] op_sel:[0,1,0] op_sel_hi:[1,1,0]
  v_pk_fma_f32 v[148:149], v[148:149], v[156:157], v[244:245] op_sel_hi:[1,0,1]
  v_pk_fma_f32 v[152:153], v[152:153], v[158:159], v[248:249] op_sel_hi:[1,0,1]
  v_pk_fma_f32 v[150:151], v[150:151], v[156:157], v[246:247] op_sel_hi:[1,0,1]
  v_pk_fma_f32 v[154:155], v[154:155], v[158:159], v[250:251] op_sel_hi:[1,0,1]
  v_pk_mul_f32 v[244:245], v[148:149], v[50:51] op_sel_hi:[1,0]
  v_pk_mul_f32 v[248:249], v[152:153], v[50:51] op_sel_hi:[1,0]
  v_pk_mul_f32 v[246:247], v[150:151], v[50:51] op_sel_hi:[1,0]
  v_pk_mul_f32 v[250:251], v[154:155], v[50:51] op_sel_hi:[1,0]
  v_exp_f32 v244, v244 clamp
  v_exp_f32 v248, v248 clamp
  v_exp_f32 v245, v245 clamp
  v_exp_f32 v249, v249 clamp
  v_exp_f32 v246, v246 clamp
  v_exp_f32 v250, v250 clamp
  v_exp_f32 v247, v247 clamp
  v_exp_f32 v251, v251 clamp
  v_max_f32 v148, s55, v148
  v_max_f32 v152, s55, v152
  v_max_f32 v149, s55, v149
  v_max_f32 v153, s55, v153
  v_max_f32 v150, s55, v150
  v_max_f32 v154, s55, v154
  v_max_f32 v151, s55, v151
  v_max_f32 v155, s55, v155
  v_pk_add_f32 v[148:149], v[148:149], v[244:245]
  v_pk_add_f32 v[152:153], v[152:153], v[248:249]
  v_pk_add_f32 v[150:151], v[150:151], v[246:247]
  v_pk_add_f32 v[154:155], v[154:155], v[250:251]
  v_cvt_pk_bf16_f32 v204, v148, v149
  v_cvt_pk_bf16_f32 v206, v152, v153
  v_cvt_pk_bf16_f32 v205, v150, v151
  v_cvt_pk_bf16_f32 v207, v154, v155
  buffer_store_dwordx2 v[204:205], v38, s[16:19], s76 offen sc1
  buffer_store_dwordx2 v[206:207], v39, s[16:19], s76 offen sc1
  s_waitcnt lgkmcnt(5)
  v_pk_fma_f32 v[244:245], v[72:73], v[160:161], v[46:47] op_sel:[0,1,0] op_sel_hi:[1,1,0]
  v_pk_fma_f32 v[248:249], v[76:77], v[160:161], v[46:47] op_sel:[0,1,0] op_sel_hi:[1,1,0]
  v_pk_fma_f32 v[246:247], v[74:75], v[160:161], v[46:47] op_sel:[0,1,0] op_sel_hi:[1,1,0]
  v_pk_fma_f32 v[250:251], v[78:79], v[160:161], v[46:47] op_sel:[0,1,0] op_sel_hi:[1,1,0]
  v_pk_fma_f32 v[92:93], v[92:93], v[160:161], v[244:245] op_sel_hi:[1,0,1]
  v_pk_fma_f32 v[124:125], v[124:125], v[160:161], v[248:249] op_sel_hi:[1,0,1]
  v_pk_fma_f32 v[94:95], v[94:95], v[160:161], v[246:247] op_sel_hi:[1,0,1]
  v_pk_fma_f32 v[126:127], v[126:127], v[160:161], v[250:251] op_sel_hi:[1,0,1]
  v_pk_mul_f32 v[244:245], v[92:93], v[50:51] op_sel_hi:[1,0]
  v_pk_mul_f32 v[248:249], v[124:125], v[50:51] op_sel_hi:[1,0]
  v_pk_mul_f32 v[246:247], v[94:95], v[50:51] op_sel_hi:[1,0]
  v_pk_mul_f32 v[250:251], v[126:127], v[50:51] op_sel_hi:[1,0]
  v_exp_f32 v244, v244 clamp
  v_exp_f32 v248, v248 clamp
  v_exp_f32 v245, v245 clamp
  v_exp_f32 v249, v249 clamp
  v_exp_f32 v246, v246 clamp
  v_exp_f32 v250, v250 clamp
  v_exp_f32 v247, v247 clamp
  v_exp_f32 v251, v251 clamp
  v_max_f32 v92, s55, v92
  v_max_f32 v124, s55, v124
  v_max_f32 v93, s55, v93
  v_max_f32 v125, s55, v125
  v_max_f32 v94, s55, v94
  v_max_f32 v126, s55, v126
  v_max_f32 v95, s55, v95
  v_max_f32 v127, s55, v127
  v_pk_add_f32 v[92:93], v[92:93], v[244:245]
  v_pk_add_f32 v[124:125], v[124:125], v[248:249]
  v_pk_add_f32 v[94:95], v[94:95], v[246:247]
  v_pk_add_f32 v[126:127], v[126:127], v[250:251]
  v_cvt_pk_bf16_f32 v180, v92, v93
  v_cvt_pk_bf16_f32 v182, v124, v125
  v_cvt_pk_bf16_f32 v181, v94, v95
  v_cvt_pk_bf16_f32 v183, v126, v127
  buffer_store_dwordx4 v[180:183], v4, s[16:19], s73 offen sc1
  s_waitcnt lgkmcnt(4)
  v_pk_fma_f32 v[244:245], v[72:73], v[162:163], v[46:47] op_sel:[0,1,0] op_sel_hi:[1,1,0]
  v_pk_fma_f32 v[248:249], v[76:77], v[162:163], v[46:47] op_sel:[0,1,0] op_sel_hi:[1,1,0]
  v_pk_fma_f32 v[246:247], v[74:75], v[162:163], v[46:47] op_sel:[0,1,0] op_sel_hi:[1,1,0]
  v_pk_fma_f32 v[250:251], v[78:79], v[162:163], v[46:47] op_sel:[0,1,0] op_sel_hi:[1,1,0]
  v_pk_fma_f32 v[96:97], v[96:97], v[162:163], v[244:245] op_sel_hi:[1,0,1]
  v_pk_fma_f32 v[128:129], v[128:129], v[162:163], v[248:249] op_sel_hi:[1,0,1]
  v_pk_fma_f32 v[98:99], v[98:99], v[162:163], v[246:247] op_sel_hi:[1,0,1]
  v_pk_fma_f32 v[130:131], v[130:131], v[162:163], v[250:251] op_sel_hi:[1,0,1]
  v_pk_mul_f32 v[244:245], v[96:97], v[50:51] op_sel_hi:[1,0]
  v_pk_mul_f32 v[248:249], v[128:129], v[50:51] op_sel_hi:[1,0]
  v_pk_mul_f32 v[246:247], v[98:99], v[50:51] op_sel_hi:[1,0]
  v_pk_mul_f32 v[250:251], v[130:131], v[50:51] op_sel_hi:[1,0]
  v_exp_f32 v244, v244 clamp
  v_exp_f32 v248, v248 clamp
  v_exp_f32 v245, v245 clamp
  v_exp_f32 v249, v249 clamp
  v_exp_f32 v246, v246 clamp
  v_exp_f32 v250, v250 clamp
  v_exp_f32 v247, v247 clamp
  v_exp_f32 v251, v251 clamp
  v_max_f32 v96, s55, v96
  v_max_f32 v128, s55, v128
  v_max_f32 v97, s55, v97
  v_max_f32 v129, s55, v129
  v_max_f32 v98, s55, v98
  v_max_f32 v130, s55, v130
  v_max_f32 v99, s55, v99
  v_max_f32 v131, s55, v131
  v_pk_add_f32 v[96:97], v[96:97], v[244:245]
  v_pk_add_f32 v[128:129], v[128:129], v[248:249]
  v_pk_add_f32 v[98:99], v[98:99], v[246:247]
  v_pk_add_f32 v[130:131], v[130:131], v[250:251]
  v_cvt_pk_bf16_f32 v184, v96, v97
  v_cvt_pk_bf16_f32 v186, v128, v129
  v_cvt_pk_bf16_f32 v185, v98, v99
  v_cvt_pk_bf16_f32 v187, v130, v131
  buffer_store_dwordx4 v[184:187], v40, s[16:19], s73 offen sc1
  s_waitcnt lgkmcnt(3)
  v_pk_fma_f32 v[244:245], v[72:73], v[164:165], v[46:47] op_sel:[0,1,0] op_sel_hi:[1,1,0]
  v_pk_fma_f32 v[248:249], v[76:77], v[164:165], v[46:47] op_sel:[0,1,0] op_sel_hi:[1,1,0]
  v_pk_fma_f32 v[246:247], v[74:75], v[164:165], v[46:47] op_sel:[0,1,0] op_sel_hi:[1,1,0]
  v_pk_fma_f32 v[250:251], v[78:79], v[164:165], v[46:47] op_sel:[0,1,0] op_sel_hi:[1,1,0]
  v_pk_fma_f32 v[100:101], v[100:101], v[164:165], v[244:245] op_sel_hi:[1,0,1]
  v_pk_fma_f32 v[132:133], v[132:133], v[164:165], v[248:249] op_sel_hi:[1,0,1]
  v_pk_fma_f32 v[102:103], v[102:103], v[164:165], v[246:247] op_sel_hi:[1,0,1]
  v_pk_fma_f32 v[134:135], v[134:135], v[164:165], v[250:251] op_sel_hi:[1,0,1]
  v_pk_mul_f32 v[244:245], v[100:101], v[50:51] op_sel_hi:[1,0]
  v_pk_mul_f32 v[248:249], v[132:133], v[50:51] op_sel_hi:[1,0]
  v_pk_mul_f32 v[246:247], v[102:103], v[50:51] op_sel_hi:[1,0]
  v_pk_mul_f32 v[250:251], v[134:135], v[50:51] op_sel_hi:[1,0]
  v_exp_f32 v244, v244 clamp
  v_exp_f32 v248, v248 clamp
  v_exp_f32 v245, v245 clamp
  v_exp_f32 v249, v249 clamp
  v_exp_f32 v246, v246 clamp
  v_exp_f32 v250, v250 clamp
  v_exp_f32 v247, v247 clamp
  v_exp_f32 v251, v251 clamp
  v_max_f32 v100, s55, v100
  v_max_f32 v132, s55, v132
  v_max_f32 v101, s55, v101
  v_max_f32 v133, s55, v133
  v_max_f32 v102, s55, v102
  v_max_f32 v134, s55, v134
  v_max_f32 v103, s55, v103
  v_max_f32 v135, s55, v135
  v_pk_add_f32 v[100:101], v[100:101], v[244:245]
  v_pk_add_f32 v[132:133], v[132:133], v[248:249]
  v_pk_add_f32 v[102:103], v[102:103], v[246:247]
  v_pk_add_f32 v[134:135], v[134:135], v[250:251]
  v_cvt_pk_bf16_f32 v188, v100, v101
  v_cvt_pk_bf16_f32 v190, v132, v133
  v_cvt_pk_bf16_f32 v189, v102, v103
  v_cvt_pk_bf16_f32 v191, v134, v135
  buffer_store_dwordx4 v[188:191], v4, s[16:19], s74 offen sc1
  s_waitcnt lgkmcnt(2)
  v_pk_fma_f32 v[244:245], v[72:73], v[166:167], v[46:47] op_sel:[0,1,0] op_sel_hi:[1,1,0]
  v_pk_fma_f32 v[248:249], v[76:77], v[166:167], v[46:47] op_sel:[0,1,0] op_sel_hi:[1,1,0]
  v_pk_fma_f32 v[246:247], v[74:75], v[166:167], v[46:47] op_sel:[0,1,0] op_sel_hi:[1,1,0]
  v_pk_fma_f32 v[250:251], v[78:79], v[166:167], v[46:47] op_sel:[0,1,0] op_sel_hi:[1,1,0]
  v_pk_fma_f32 v[104:105], v[104:105], v[166:167], v[244:245] op_sel_hi:[1,0,1]
  v_pk_fma_f32 v[136:137], v[136:137], v[166:167], v[248:249] op_sel_hi:[1,0,1]
  v_pk_fma_f32 v[106:107], v[106:107], v[166:167], v[246:247] op_sel_hi:[1,0,1]
  v_pk_fma_f32 v[138:139], v[138:139], v[166:167], v[250:251] op_sel_hi:[1,0,1]
  v_pk_mul_f32 v[244:245], v[104:105], v[50:51] op_sel_hi:[1,0]
  v_pk_mul_f32 v[248:249], v[136:137], v[50:51] op_sel_hi:[1,0]
  v_pk_mul_f32 v[246:247], v[106:107], v[50:51] op_sel_hi:[1,0]
  v_pk_mul_f32 v[250:251], v[138:139], v[50:51] op_sel_hi:[1,0]
  v_exp_f32 v244, v244 clamp
  v_exp_f32 v248, v248 clamp
  v_exp_f32 v245, v245 clamp
  v_exp_f32 v249, v249 clamp
  v_exp_f32 v246, v246 clamp
  v_exp_f32 v250, v250 clamp
  v_exp_f32 v247, v247 clamp
  v_exp_f32 v251, v251 clamp
  v_max_f32 v104, s55, v104
  v_max_f32 v136, s55, v136
  v_max_f32 v105, s55, v105
  v_max_f32 v137, s55, v137
  v_max_f32 v106, s55, v106
  v_max_f32 v138, s55, v138
  v_max_f32 v107, s55, v107
  v_max_f32 v139, s55, v139
  v_pk_add_f32 v[104:105], v[104:105], v[244:245]
  v_pk_add_f32 v[136:137], v[136:137], v[248:249]
  v_pk_add_f32 v[106:107], v[106:107], v[246:247]
  v_pk_add_f32 v[138:139], v[138:139], v[250:251]
  v_cvt_pk_bf16_f32 v192, v104, v105
  v_cvt_pk_bf16_f32 v194, v136, v137
  v_cvt_pk_bf16_f32 v193, v106, v107
  v_cvt_pk_bf16_f32 v195, v138, v139
  buffer_store_dwordx4 v[192:195], v40, s[16:19], s74 offen sc1
  s_waitcnt lgkmcnt(1)
  v_pk_fma_f32 v[244:245], v[72:73], v[168:169], v[46:47] op_sel:[0,1,0] op_sel_hi:[1,1,0]
  v_pk_fma_f32 v[248:249], v[76:77], v[168:169], v[46:47] op_sel:[0,1,0] op_sel_hi:[1,1,0]
  v_pk_fma_f32 v[246:247], v[74:75], v[168:169], v[46:47] op_sel:[0,1,0] op_sel_hi:[1,1,0]
  v_pk_fma_f32 v[250:251], v[78:79], v[168:169], v[46:47] op_sel:[0,1,0] op_sel_hi:[1,1,0]
  v_pk_fma_f32 v[108:109], v[108:109], v[168:169], v[244:245] op_sel_hi:[1,0,1]
  v_pk_fma_f32 v[140:141], v[140:141], v[168:169], v[248:249] op_sel_hi:[1,0,1]
  v_pk_fma_f32 v[110:111], v[110:111], v[168:169], v[246:247] op_sel_hi:[1,0,1]
  v_pk_fma_f32 v[142:143], v[142:143], v[168:169], v[250:251] op_sel_hi:[1,0,1]
  v_pk_mul_f32 v[244:245], v[108:109], v[50:51] op_sel_hi:[1,0]
  v_pk_mul_f32 v[248:249], v[140:141], v[50:51] op_sel_hi:[1,0]
  v_pk_mul_f32 v[246:247], v[110:111], v[50:51] op_sel_hi:[1,0]
  v_pk_mul_f32 v[250:251], v[142:143], v[50:51] op_sel_hi:[1,0]
  v_exp_f32 v244, v244 clamp
  v_exp_f32 v248, v248 clamp
  v_exp_f32 v245, v245 clamp
  v_exp_f32 v249, v249 clamp
  v_exp_f32 v246, v246 clamp
  v_exp_f32 v250, v250 clamp
  v_exp_f32 v247, v247 clamp
  v_exp_f32 v251, v251 clamp
  v_max_f32 v108, s55, v108
  v_max_f32 v140, s55, v140
  v_max_f32 v109, s55, v109
  v_max_f32 v141, s55, v141
  v_max_f32 v110, s55, v110
  v_max_f32 v142, s55, v142
  v_max_f32 v111, s55, v111
  v_max_f32 v143, s55, v143
  v_pk_add_f32 v[108:109], v[108:109], v[244:245]
  v_pk_add_f32 v[140:141], v[140:141], v[248:249]
  v_pk_add_f32 v[110:111], v[110:111], v[246:247]
  v_pk_add_f32 v[142:143], v[142:143], v[250:251]
  v_cvt_pk_bf16_f32 v196, v108, v109
  v_cvt_pk_bf16_f32 v198, v140, v141
  v_cvt_pk_bf16_f32 v197, v110, v111
  v_cvt_pk_bf16_f32 v199, v142, v143
  buffer_store_dwordx4 v[196:199], v4, s[16:19], s75 offen sc1
  s_waitcnt lgkmcnt(0)
  v_pk_fma_f32 v[244:245], v[72:73], v[170:171], v[46:47] op_sel:[0,1,0] op_sel_hi:[1,1,0]
  v_pk_fma_f32 v[248:249], v[76:77], v[170:171], v[46:47] op_sel:[0,1,0] op_sel_hi:[1,1,0]
  v_pk_fma_f32 v[246:247], v[74:75], v[170:171], v[46:47] op_sel:[0,1,0] op_sel_hi:[1,1,0]
  v_pk_fma_f32 v[250:251], v[78:79], v[170:171], v[46:47] op_sel:[0,1,0] op_sel_hi:[1,1,0]
  v_pk_fma_f32 v[112:113], v[112:113], v[170:171], v[244:245] op_sel_hi:[1,0,1]
  v_pk_fma_f32 v[144:145], v[144:145], v[170:171], v[248:249] op_sel_hi:[1,0,1]
  v_pk_fma_f32 v[114:115], v[114:115], v[170:171], v[246:247] op_sel_hi:[1,0,1]
  v_pk_fma_f32 v[146:147], v[146:147], v[170:171], v[250:251] op_sel_hi:[1,0,1]
  v_pk_mul_f32 v[244:245], v[112:113], v[50:51] op_sel_hi:[1,0]
  v_pk_mul_f32 v[248:249], v[144:145], v[50:51] op_sel_hi:[1,0]
  v_pk_mul_f32 v[246:247], v[114:115], v[50:51] op_sel_hi:[1,0]
  v_pk_mul_f32 v[250:251], v[146:147], v[50:51] op_sel_hi:[1,0]
  v_exp_f32 v244, v244 clamp
  v_exp_f32 v248, v248 clamp
  v_exp_f32 v245, v245 clamp
  v_exp_f32 v249, v249 clamp
  v_exp_f32 v246, v246 clamp
  v_exp_f32 v250, v250 clamp
  v_exp_f32 v247, v247 clamp
  v_exp_f32 v251, v251 clamp
  v_max_f32 v112, s55, v112
  v_max_f32 v144, s55, v144
  v_max_f32 v113, s55, v113
  v_max_f32 v145, s55, v145
  v_max_f32 v114, s55, v114
  v_max_f32 v146, s55, v146
  v_max_f32 v115, s55, v115
  v_max_f32 v147, s55, v147
  v_pk_add_f32 v[112:113], v[112:113], v[244:245]
  v_pk_add_f32 v[144:145], v[144:145], v[248:249]
  v_pk_add_f32 v[114:115], v[114:115], v[246:247]
  v_pk_add_f32 v[146:147], v[146:147], v[250:251]
  v_cvt_pk_bf16_f32 v200, v112, v113
  v_cvt_pk_bf16_f32 v202, v144, v145
  v_cvt_pk_bf16_f32 v201, v114, v115
  v_cvt_pk_bf16_f32 v203, v146, v147
  buffer_store_dwordx4 v[200:203], v40, s[16:19], s75 offen sc1
  s_endpgm
  L_k1_cw0:
  s_mov_b32 s53, 0
  L_k1_cw0a:
  s_sleep 4
  buffer_load_dword v11, off, s[24:27], 0 offset:128 sc1
  s_waitcnt vmcnt(0)
  v_readfirstlane_b32 s52, v11
  s_add_u32 s53, s53, 1
  s_cmp_ge_u32 s52, 81
  s_cbranch_scc1 L_k1_ck0
  s_cmp_lt_u32 s53, 4194304
  s_cbranch_scc1 L_k1_cw0a
  s_branch L_k1_ck0
  L_k1_cw1:
  s_mov_b32 s53, 0
  L_k1_cw1a:
  s_sleep 4
  buffer_load_dword v11, off, s[24:27], 0 offset:128 sc1
  s_waitcnt vmcnt(0)
  v_readfirstlane_b32 s52, v11
  s_add_u32 s53, s53, 1
  s_cmp_ge_u32 s52, 81
  s_cbranch_scc1 L_k1_ck1
  s_cmp_lt_u32 s53, 4194304
  s_cbranch_scc1 L_k1_cw1a
  s_branch L_k1_ck1
L_k1_sw:
  s_load_dwordx2 s[4:5], s[0:1], 80
  s_load_dwordx4 s[20:23], s[0:1], 32
  s_load_dwordx2 s[24:25], s[0:1], 48
  s_load_dwordx2 s[26:27], s[0:1], 16
  s_load_dwordx2 s[28:29], s[0:1], 72
  s_load_dwordx4 s[52:55], s[0:1], 0
  v_lshrrev_b32 v8, 6, v0
  s_nop 0
  v_readfirstlane_b32 s48, v8
  s_and_b32 s32, s2, 7
  s_bfe_u32 s34, s2, 0x30003
  s_lshl_b32 s33, s48, 3
  s_add_u32 s33, s33, s34
  s_mul_i32 s38, s48, 40960
  v_and_b32 v1, 63, v0
  v_lshlrev_b32 v10, 4, v1
  s_waitcnt lgkmcnt(0)
  s_cmp_eq_u32 s33, 24
  s_cbranch_scc1 L_sw_zero
  s_cmp_ge_u32 s33, 25
  s_cselect_b32 s34, 20, 18
  s_sub_u32 s34, s33, s34
  s_cmp_eq_u32 s33, 25
  s_cselect_b32 s34, 16, s34
  s_lshl_b32 s34, s34, 3
  s_add_u32 s34, s34, s32
  s_cmp_ge_u32 s34, 81
  s_cbranch_scc1 L_sw_nocs
  s_mul_i32 s36, s34, 86
  s_lshr_b32 s36, s36, 8
  s_mul_i32 s35, s36, 3
  s_sub_u32 s37, s34, s35
  s_mov_b32 s8, s54
  s_mov_b32 s9, s55
  s_and_b32 s9, s9, 0xffff
  s_mov_b32 s10, 1990656
  s_mov_b32 s11, 0x20000
  s_mul_i32 s34, s37, 663552
  s_lshl_b32 s35, s36, 7
  s_add_u32 s34, s34, s35
  v_lshrrev_b32 v8, 3, v1
  v_mul_u32_u24 v8, 3456, v8
  v_and_b32 v9, 7, v1
  v_lshl_add_u32 v8, v9, 4, v8
  buffer_load_dwordx4 v[64:67], v8, s[8:11], s34 offen
  s_add_u32 s34, s34, 27648
  buffer_load_dwordx4 v[68:71], v8, s[8:11], s34 offen
  s_add_u32 s34, s34, 27648
  buffer_load_dwordx4 v[72:75], v8, s[8:11], s34 offen
  s_add_u32 s34, s34, 27648
  buffer_load_dwordx4 v[76:79], v8, s[8:11], s34 offen
  s_add_u32 s34, s34, 27648
  buffer_load_dwordx4 v[80:83], v8, s[8:11], s34 offen
  s_add_u32 s34, s34, 27648
  buffer_load_dwordx4 v[84:87], v8, s[8:11], s34 offen
  s_add_u32 s34, s34, 27648
  buffer_load_dwordx4 v[88:91], v8, s[8:11], s34 offen
  s_add_u32 s34, s34, 27648
  buffer_load_dwordx4 v[92:95], v8, s[8:11], s34 offen
  s_add_u32 s34, s34, 27648
  buffer_load_dwordx4 v[96:99], v8, s[8:11], s34 offen
  s_add_u32 s34, s34, 27648
  buffer_load_dwordx4 v[100:103], v8, s[8:11], s34 offen
  s_add_u32 s34, s34, 27648
  buffer_load_dwordx4 v[104:107], v8, s[8:11], s34 offen
  s_add_u32 s34, s34, 27648
  buffer_load_dwordx4 v[108:111], v8, s[8:11], s34 offen
  s_add_u32 s34, s34, 27648
  buffer_load_dwordx4 v[112:115], v8, s[8:11], s34 offen
  s_add_u32 s34, s34, 27648
  buffer_load_dwordx4 v[116:119], v8, s[8:11], s34 offen
  s_add_u32 s34, s34, 27648
  buffer_load_dwordx4 v[120:123], v8, s[8:11], s34 offen
  s_add_u32 s34, s34, 27648
  buffer_load_dwordx4 v[124:127], v8, s[8:11], s34 offen
  s_add_u32 s34, s34, 27648
  buffer_load_dwordx4 v[128:131], v8, s[8:11], s34 offen
  s_add_u32 s34, s34, 27648
  buffer_load_dwordx4 v[132:135], v8, s[8:11], s34 offen
  s_add_u32 s34, s34, 27648
  buffer_load_dwordx4 v[136:139], v8, s[8:11], s34 offen
  s_add_u32 s34, s34, 27648
  buffer_load_dwordx4 v[140:143], v8, s[8:11], s34 offen
  s_add_u32 s34, s34, 27648
  buffer_load_dwordx4 v[144:147], v8, s[8:11], s34 offen
  s_add_u32 s34, s34, 27648
  buffer_load_dwordx4 v[148:151], v8, s[8:11], s34 offen
  s_add_u32 s34, s34, 27648
  buffer_load_dwordx4 v[152:155], v8, s[8:11], s34 offen
  s_add_u32 s34, s34, 27648
  buffer_load_dwordx4 v[156:159], v8, s[8:11], s34 offen
  s_add_u32 s34, s34, 27648
  s_barrier
  s_add_u32 s16, s4, 11491328
  s_addc_u32 s17, s5, 0
  s_and_b32 s17, s17, 0xffff
  s_mov_b32 s18, 20736
  s_mov_b32 s19, 0x20000
  s_mov_b32 s12, s28
  s_mov_b32 s13, s29
  s_and_b32 s13, s13, 0xffff
  s_mov_b32 s14, 256
  s_mov_b32 s15, 0x20000
  s_movk_i32 s44, 0x3f80
  s_mov_b32 s45, 0x3f800000
  s_mul_i32 s34, s37, 6912
  s_lshl_b32 s35, s36, 8
  s_add_u32 s34, s34, s35
  v_mov_b32 v16, 0
  v_mov_b32 v17, 0
  v_mov_b32 v18, 0
  v_mov_b32 v19, 0
  v_mov_b32 v20, 0
  v_mov_b32 v21, 0
  v_mov_b32 v22, 0
  v_mov_b32 v23, 0
  s_waitcnt vmcnt(23)
  v_dot2_f32_bf16 v16, v64, s44, v16
  v_dot2_f32_bf16 v17, v64, s45, v17
  v_dot2_f32_bf16 v18, v65, s44, v18
  v_dot2_f32_bf16 v19, v65, s45, v19
  v_dot2_f32_bf16 v20, v66, s44, v20
  v_dot2_f32_bf16 v21, v66, s45, v21
  v_dot2_f32_bf16 v22, v67, s44, v22
  v_dot2_f32_bf16 v23, v67, s45, v23
  s_waitcnt vmcnt(22)
  v_dot2_f32_bf16 v16, v68, s44, v16
  v_dot2_f32_bf16 v17, v68, s45, v17
  v_dot2_f32_bf16 v18, v69, s44, v18
  v_dot2_f32_bf16 v19, v69, s45, v19
  v_dot2_f32_bf16 v20, v70, s44, v20
  v_dot2_f32_bf16 v21, v70, s45, v21
  v_dot2_f32_bf16 v22, v71, s44, v22
  v_dot2_f32_bf16 v23, v71, s45, v23
  s_waitcnt vmcnt(21)
  v_dot2_f32_bf16 v16, v72, s44, v16
  v_dot2_f32_bf16 v17, v72, s45, v17
  v_dot2_f32_bf16 v18, v73, s44, v18
  v_dot2_f32_bf16 v19, v73, s45, v19
  v_dot2_f32_bf16 v20, v74, s44, v20
  v_dot2_f32_bf16 v21, v74, s45, v21
  v_dot2_f32_bf16 v22, v75, s44, v22
  v_dot2_f32_bf16 v23, v75, s45, v23
  s_waitcnt vmcnt(20)
  v_dot2_f32_bf16 v16, v76, s44, v16
  v_dot2_f32_bf16 v17, v76, s45, v17
  v_dot2_f32_bf16 v18, v77, s44, v18
  v_dot2_f32_bf16 v19, v77, s45, v19
  v_dot2_f32_bf16 v20, v78, s44, v20
  v_dot2_f32_bf16 v21, v78, s45, v21
  v_dot2_f32_bf16 v22, v79, s44, v22
  v_dot2_f32_bf16 v23, v79, s45, v23
  s_waitcnt vmcnt(19)
  v_dot2_f32_bf16 v16, v80, s44, v16
  v_dot2_f32_bf16 v17, v80, s45, v17
  v_dot2_f32_bf16 v18, v81, s44, v18
  v_dot2_f32_bf16 v19, v81, s45, v19
  v_dot2_f32_bf16 v20, v82, s44, v20
  v_dot2_f32_bf16 v21, v82, s45, v21
  v_dot2_f32_bf16 v22, v83, s44, v22
  v_dot2_f32_bf16 v23, v83, s45, v23
  s_waitcnt vmcnt(18)
  v_dot2_f32_bf16 v16, v84, s44, v16
  v_dot2_f32_bf16 v17, v84, s45, v17
  v_dot2_f32_bf16 v18, v85, s44, v18
  v_dot2_f32_bf16 v19, v85, s45, v19
  v_dot2_f32_bf16 v20, v86, s44, v20
  v_dot2_f32_bf16 v21, v86, s45, v21
  v_dot2_f32_bf16 v22, v87, s44, v22
  v_dot2_f32_bf16 v23, v87, s45, v23
  s_waitcnt vmcnt(17)
  v_dot2_f32_bf16 v16, v88, s44, v16
  v_dot2_f32_bf16 v17, v88, s45, v17
  v_dot2_f32_bf16 v18, v89, s44, v18
  v_dot2_f32_bf16 v19, v89, s45, v19
  v_dot2_f32_bf16 v20, v90, s44, v20
  v_dot2_f32_bf16 v21, v90, s45, v21
  v_dot2_f32_bf16 v22, v91, s44, v22
  v_dot2_f32_bf16 v23, v91, s45, v23
  s_waitcnt vmcnt(16)
  v_dot2_f32_bf16 v16, v92, s44, v16
  v_dot2_f32_bf16 v17, v92, s45, v17
  v_dot2_f32_bf16 v18, v93, s44, v18
  v_dot2_f32_bf16 v19, v93, s45, v19
  v_dot2_f32_bf16 v20, v94, s44, v20
  v_dot2_f32_bf16 v21, v94, s45, v21
  v_dot2_f32_bf16 v22, v95, s44, v22
  v_dot2_f32_bf16 v23, v95, s45, v23
  s_waitcnt vmcnt(15)
  v_dot2_f32_bf16 v16, v96, s44, v16
  v_dot2_f32_bf16 v17, v96, s45, v17
  v_dot2_f32_bf16 v18, v97, s44, v18
  v_dot2_f32_bf16 v19, v97, s45, v19
  v_dot2_f32_bf16 v20, v98, s44, v20
  v_dot2_f32_bf16 v21, v98, s45, v21
  v_dot2_f32_bf16 v22, v99, s44, v22
  v_dot2_f32_bf16 v23, v99, s45, v23
  s_waitcnt vmcnt(14)
  v_dot2_f32_bf16 v16, v100, s44, v16
  v_dot2_f32_bf16 v17, v100, s45, v17
  v_dot2_f32_bf16 v18, v101, s44, v18
  v_dot2_f32_bf16 v19, v101, s45, v19
  v_dot2_f32_bf16 v20, v102, s44, v20
  v_dot2_f32_bf16 v21, v102, s45, v21
  v_dot2_f32_bf16 v22, v103, s44, v22
  v_dot2_f32_bf16 v23, v103, s45, v23
  s_waitcnt vmcnt(13)
  v_dot2_f32_bf16 v16, v104, s44, v16
  v_dot2_f32_bf16 v17, v104, s45, v17
  v_dot2_f32_bf16 v18, v105, s44, v18
  v_dot2_f32_bf16 v19, v105, s45, v19
  v_dot2_f32_bf16 v20, v106, s44, v20
  v_dot2_f32_bf16 v21, v106, s45, v21
  v_dot2_f32_bf16 v22, v107, s44, v22
  v_dot2_f32_bf16 v23, v107, s45, v23
  s_waitcnt vmcnt(12)
  v_dot2_f32_bf16 v16, v108, s44, v16
  v_dot2_f32_bf16 v17, v108, s45, v17
  v_dot2_f32_bf16 v18, v109, s44, v18
  v_dot2_f32_bf16 v19, v109, s45, v19
  v_dot2_f32_bf16 v20, v110, s44, v20
  v_dot2_f32_bf16 v21, v110, s45, v21
  v_dot2_f32_bf16 v22, v111, s44, v22
  v_dot2_f32_bf16 v23, v111, s45, v23
  s_waitcnt vmcnt(11)
  v_dot2_f32_bf16 v16, v112, s44, v16
  v_dot2_f32_bf16 v17, v112, s45, v17
  v_dot2_f32_bf16 v18, v113, s44, v18
  v_dot2_f32_bf16 v19, v113, s45, v19
  v_dot2_f32_bf16 v20, v114, s44, v20
  v_dot2_f32_bf16 v21, v114, s45, v21
  v_dot2_f32_bf16 v22, v115, s44, v22
  v_dot2_f32_bf16 v23, v115, s45, v23
  s_waitcnt vmcnt(10)
  v_dot2_f32_bf16 v16, v116, s44, v16
  v_dot2_f32_bf16 v17, v116, s45, v17
  v_dot2_f32_bf16 v18, v117, s44, v18
  v_dot2_f32_bf16 v19, v117, s45, v19
  v_dot2_f32_bf16 v20, v118, s44, v20
  v_dot2_f32_bf16 v21, v118, s45, v21
  v_dot2_f32_bf16 v22, v119, s44, v22
  v_dot2_f32_bf16 v23, v119, s45, v23
  s_waitcnt vmcnt(9)
  v_dot2_f32_bf16 v16, v120, s44, v16
  v_dot2_f32_bf16 v17, v120, s45, v17
  v_dot2_f32_bf16 v18, v121, s44, v18
  v_dot2_f32_bf16 v19, v121, s45, v19
  v_dot2_f32_bf16 v20, v122, s44, v20
  v_dot2_f32_bf16 v21, v122, s45, v21
  v_dot2_f32_bf16 v22, v123, s44, v22
  v_dot2_f32_bf16 v23, v123, s45, v23
  s_waitcnt vmcnt(8)
  v_dot2_f32_bf16 v16, v124, s44, v16
  v_dot2_f32_bf16 v17, v124, s45, v17
  v_dot2_f32_bf16 v18, v125, s44, v18
  v_dot2_f32_bf16 v19, v125, s45, v19
  v_dot2_f32_bf16 v20, v126, s44, v20
  v_dot2_f32_bf16 v21, v126, s45, v21
  v_dot2_f32_bf16 v22, v127, s44, v22
  v_dot2_f32_bf16 v23, v127, s45, v23
  s_waitcnt vmcnt(7)
  v_dot2_f32_bf16 v16, v128, s44, v16
  v_dot2_f32_bf16 v17, v128, s45, v17
  v_dot2_f32_bf16 v18, v129, s44, v18
  v_dot2_f32_bf16 v19, v129, s45, v19
  v_dot2_f32_bf16 v20, v130, s44, v20
  v_dot2_f32_bf16 v21, v130, s45, v21
  v_dot2_f32_bf16 v22, v131, s44, v22
  v_dot2_f32_bf16 v23, v131, s45, v23
  s_waitcnt vmcnt(6)
  v_dot2_f32_bf16 v16, v132, s44, v16
  v_dot2_f32_bf16 v17, v132, s45, v17
  v_dot2_f32_bf16 v18, v133, s44, v18
  v_dot2_f32_bf16 v19, v133, s45, v19
  v_dot2_f32_bf16 v20, v134, s44, v20
  v_dot2_f32_bf16 v21, v134, s45, v21
  v_dot2_f32_bf16 v22, v135, s44, v22
  v_dot2_f32_bf16 v23, v135, s45, v23
  s_waitcnt vmcnt(5)
  v_dot2_f32_bf16 v16, v136, s44, v16
  v_dot2_f32_bf16 v17, v136, s45, v17
  v_dot2_f32_bf16 v18, v137, s44, v18
  v_dot2_f32_bf16 v19, v137, s45, v19
  v_dot2_f32_bf16 v20, v138, s44, v20
  v_dot2_f32_bf16 v21, v138, s45, v21
  v_dot2_f32_bf16 v22, v139, s44, v22
  v_dot2_f32_bf16 v23, v139, s45, v23
  s_waitcnt vmcnt(4)
  v_dot2_f32_bf16 v16, v140, s44, v16
  v_dot2_f32_bf16 v17, v140, s45, v17
  v_dot2_f32_bf16 v18, v141, s44, v18
  v_dot2_f32_bf16 v19, v141, s45, v19
  v_dot2_f32_bf16 v20, v142, s44, v20
  v_dot2_f32_bf16 v21, v142, s45, v21
  v_dot2_f32_bf16 v22, v143, s44, v22
  v_dot2_f32_bf16 v23, v143, s45, v23
  s_waitcnt vmcnt(3)
  v_dot2_f32_bf16 v16, v144, s44, v16
  v_dot2_f32_bf16 v17, v144, s45, v17
  v_dot2_f32_bf16 v18, v145, s44, v18
  v_dot2_f32_bf16 v19, v145, s45, v19
  v_dot2_f32_bf16 v20, v146, s44, v20
  v_dot2_f32_bf16 v21, v146, s45, v21
  v_dot2_f32_bf16 v22, v147, s44, v22
  v_dot2_f32_bf16 v23, v147, s45, v23
  s_waitcnt vmcnt(2)
  v_dot2_f32_bf16 v16, v148, s44, v16
  v_dot2_f32_bf16 v17, v148, s45, v17
  v_dot2_f32_bf16 v18, v149, s44, v18
  v_dot2_f32_bf16 v19, v149, s45, v19
  v_dot2_f32_bf16 v20, v150, s44, v20
  v_dot2_f32_bf16 v21, v150, s45, v21
  v_dot2_f32_bf16 v22, v151, s44, v22
  v_dot2_f32_bf16 v23, v151, s45, v23
  s_waitcnt vmcnt(1)
  v_dot2_f32_bf16 v16, v152, s44, v16
  v_dot2_f32_bf16 v17, v152, s45, v17
  v_dot2_f32_bf16 v18, v153, s44, v18
  v_dot2_f32_bf16 v19, v153, s45, v19
  v_dot2_f32_bf16 v20, v154, s44, v20
  v_dot2_f32_bf16 v21, v154, s45, v21
  v_dot2_f32_bf16 v22, v155, s44, v22
  v_dot2_f32_bf16 v23, v155, s45, v23
  s_waitcnt vmcnt(0)
  v_dot2_f32_bf16 v16, v156, s44, v16
  v_dot2_f32_bf16 v17, v156, s45, v17
  v_dot2_f32_bf16 v18, v157, s44, v18
  v_dot2_f32_bf16 v19, v157, s45, v19
  v_dot2_f32_bf16 v20, v158, s44, v20
  v_dot2_f32_bf16 v21, v158, s45, v21
  v_dot2_f32_bf16 v22, v159, s44, v22
  v_dot2_f32_bf16 v23, v159, s45, v23
  v_add_f32_dpp v16, v16, v16 row_ror:8 row_mask:0xf bank_mask:0xf
  v_add_f32_dpp v17, v17, v17 row_ror:8 row_mask:0xf bank_mask:0xf
  v_add_f32_dpp v18, v18, v18 row_ror:8 row_mask:0xf bank_mask:0xf
  v_add_f32_dpp v19, v19, v19 row_ror:8 row_mask:0xf bank_mask:0xf
  v_add_f32_dpp v20, v20, v20 row_ror:8 row_mask:0xf bank_mask:0xf
  v_add_f32_dpp v21, v21, v21 row_ror:8 row_mask:0xf bank_mask:0xf
  v_add_f32_dpp v22, v22, v22 row_ror:8 row_mask:0xf bank_mask:0xf
  v_add_f32_dpp v23, v23, v23 row_ror:8 row_mask:0xf bank_mask:0xf
  v_mov_b32 v24, v16
  v_mov_b32 v25, v17
  v_mov_b32 v26, v18
  v_mov_b32 v27, v19
  v_mov_b32 v28, v20
  v_mov_b32 v29, v21
  v_mov_b32 v30, v22
  v_mov_b32 v31, v23
  v_permlane16_swap_b32 v16, v24
  v_permlane16_swap_b32 v17, v25
  v_permlane16_swap_b32 v18, v26
  v_permlane16_swap_b32 v19, v27
  v_permlane16_swap_b32 v20, v28
  v_permlane16_swap_b32 v21, v29
  v_permlane16_swap_b32 v22, v30
  v_permlane16_swap_b32 v23, v31
  v_add_f32 v16, v16, v24
  v_add_f32 v17, v17, v25
  v_add_f32 v18, v18, v26
  v_add_f32 v19, v19, v27
  v_add_f32 v20, v20, v28
  v_add_f32 v21, v21, v29
  v_add_f32 v22, v22, v30
  v_add_f32 v23, v23, v31
  v_mov_b32 v24, v16
  v_mov_b32 v25, v17
  v_mov_b32 v26, v18
  v_mov_b32 v27, v19
  v_mov_b32 v28, v20
  v_mov_b32 v29, v21
  v_mov_b32 v30, v22
  v_mov_b32 v31, v23
  v_permlane32_swap_b32 v16, v24
  v_permlane32_swap_b32 v17, v25
  v_permlane32_swap_b32 v18, v26
  v_permlane32_swap_b32 v19, v27
  v_permlane32_swap_b32 v20, v28
  v_permlane32_swap_b32 v21, v29
  v_permlane32_swap_b32 v22, v30
  v_permlane32_swap_b32 v23, v31
  v_add_f32 v16, v16, v24
  v_add_f32 v17, v17, v25
  v_add_f32 v18, v18, v26
  v_add_f32 v19, v19, v27
  v_add_f32 v20, v20, v28
  v_add_f32 v21, v21, v29
  v_add_f32 v22, v22, v30
  v_add_f32 v23, v23, v31
  v_lshlrev_b32 v8, 5, v1
  v_mov_b32 v9, 1
  s_mov_b64 exec, 0xff
  buffer_store_dwordx4 v[16:19], v8, s[16:19], s34 offen sc1
  buffer_store_dwordx4 v[20:23], v8, s[16:19], s34 offen offset:16 sc1
  s_mov_b64 exec, 1
  s_waitcnt vmcnt(0)
  buffer_atomic_add v9, off, s[12:15], 0 offset:128
  s_mov_b64 exec, -1
  s_branch L_sw_jobs
  L_sw_nocs:
  s_barrier
  L_sw_jobs:
  s_cmp_eq_u32 s33, 31
  s_cselect_b32 s33, 24, s33
  s_cmp_ge_u32 s33, 27
  s_cbranch_scc1 L_sw_misc
  s_mov_b32 s12, s4
  s_mov_b32 s13, s5
  s_and_b32 s13, s13, 0xffff
  s_mov_b32 s14, 10616832
  s_mov_b32 s15, 0x20000
  s_cmp_ge_u32 s33, 18
  s_cbranch_scc1 L_sw_w2
  s_lshr_b32 s36, s33, 1
  s_and_b32 s37, s33, 1
  s_mul_i32 s34, s37, 2654208
  s_mul_i32 s35, s32, 1152
  s_add_u32 s34, s34, s35
  s_lshl_b32 s35, s36, 7
  s_add_u32 s34, s34, s35
  s_sub_u32 s47, 5308416, s34
  s_add_u32 s8, s20, s34
  s_addc_u32 s9, s21, 0
  s_and_b32 s9, s9, 0xffff
  s_mov_b32 s10, 0
  s_mov_b32 s11, 0x20000
  s_mov_b32 s10, s47
  v_lshrrev_b32 v8, 3, v1
  v_mul_u32_u24 v2, 9216, v8
  v_bfe_u32 v8, v1, 4, 1
  v_lshlrev_b32 v8, 1, v8
  v_and_b32 v9, 7, v1
  v_xor_b32 v8, v8, v9
  v_xor_b32 v9, 4, v8
  v_lshl_add_u32 v7, v9, 4, v2
  v_lshl_add_u32 v2, v8, 4, v2
  s_add_u32 m0, s38, 0
  s_mov_b32 s34, 0
  buffer_load_dwordx4 v2, s[8:11], s34 offen nt lds
  s_add_u32 m0, s38, 1024
  s_mov_b32 s34, 73728
  buffer_load_dwordx4 v7, s[8:11], s34 offen nt lds
  s_add_u32 m0, s38, 2048
  s_mov_b32 s34, 147456
  buffer_load_dwordx4 v2, s[8:11], s34 offen nt lds
  s_add_u32 m0, s38, 3072
  s_mov_b32 s34, 221184
  buffer_load_dwordx4 v7, s[8:11], s34 offen nt lds
  s_add_u32 m0, s38, 4096
  s_mov_b32 s34, 294912
  buffer_load_dwordx4 v2, s[8:11], s34 offen nt lds
  s_add_u32 m0, s38, 5120
  s_mov_b32 s34, 368640
  buffer_load_dwordx4 v7, s[8:11], s34 offen nt lds
  s_add_u32 m0, s38, 6144
  s_mov_b32 s34, 442368
  buffer_load_dwordx4 v2, s[8:11], s34 offen nt lds
  s_add_u32 m0, s38, 7168
  s_mov_b32 s34, 516096
  buffer_load_dwordx4 v7, s[8:11], s34 offen nt lds
  s_add_u32 m0, s38, 8192
  s_mov_b32 s34, 589824
  buffer_load_dwordx4 v2, s[8:11], s34 offen nt lds
  s_add_u32 m0, s38, 9216
  s_mov_b32 s34, 663552
  buffer_load_dwordx4 v7, s[8:11], s34 offen nt lds
  s_add_u32 m0, s38, 10240
  s_mov_b32 s34, 737280
  buffer_load_dwordx4 v2, s[8:11], s34 offen nt lds
  s_add_u32 m0, s38, 11264
  s_mov_b32 s34, 811008
  buffer_load_dwordx4 v7, s[8:11], s34 offen nt lds
  s_add_u32 m0, s38, 12288
  s_mov_b32 s34, 884736
  buffer_load_dwordx4 v2, s[8:11], s34 offen nt lds
  s_add_u32 m0, s38, 13312
  s_mov_b32 s34, 958464
  buffer_load_dwordx4 v7, s[8:11], s34 offen nt lds
  s_add_u32 m0, s38, 14336
  s_mov_b32 s34, 1032192
  buffer_load_dwordx4 v2, s[8:11], s34 offen nt lds
  s_add_u32 m0, s38, 15360
  s_mov_b32 s34, 1105920
  buffer_load_dwordx4 v7, s[8:11], s34 offen nt lds
  s_add_u32 m0, s38, 16384
  s_mov_b32 s34, 1179648
  buffer_load_dwordx4 v2, s[8:11], s34 offen nt lds
  s_add_u32 m0, s38, 17408
  s_mov_b32 s34, 1253376
  buffer_load_dwordx4 v7, s[8:11], s34 offen nt lds
  s_add_u32 m0, s38, 18432
  s_mov_b32 s34, 1327104
  buffer_load_dwordx4 v2, s[8:11], s34 offen nt lds
  s_add_u32 m0, s38, 19456
  s_mov_b32 s34, 1400832
  buffer_load_dwordx4 v7, s[8:11], s34 offen nt lds
  s_add_u32 m0, s38, 20480
  s_mov_b32 s34, 1474560
  buffer_load_dwordx4 v2, s[8:11], s34 offen nt lds
  s_add_u32 m0, s38, 21504
  s_mov_b32 s34, 1548288
  buffer_load_dwordx4 v7, s[8:11], s34 offen nt lds
  s_add_u32 m0, s38, 22528
  s_mov_b32 s34, 1622016
  buffer_load_dwordx4 v2, s[8:11], s34 offen nt lds
  s_add_u32 m0, s38, 23552
  s_mov_b32 s34, 1695744
  buffer_load_dwordx4 v7, s[8:11], s34 offen nt lds
  s_add_u32 m0, s38, 24576
  s_mov_b32 s34, 1769472
  buffer_load_dwordx4 v2, s[8:11], s34 offen nt lds
  s_add_u32 m0, s38, 25600
  s_mov_b32 s34, 1843200
  buffer_load_dwordx4 v7, s[8:11], s34 offen nt lds
  s_add_u32 m0, s38, 26624
  s_mov_b32 s34, 1916928
  buffer_load_dwordx4 v2, s[8:11], s34 offen nt lds
  s_add_u32 m0, s38, 27648
  s_mov_b32 s34, 1990656
  buffer_load_dwordx4 v7, s[8:11], s34 offen nt lds
  s_add_u32 m0, s38, 28672
  s_mov_b32 s34, 2064384
  buffer_load_dwordx4 v2, s[8:11], s34 offen nt lds
  s_add_u32 m0, s38, 29696
  s_mov_b32 s34, 2138112
  buffer_load_dwordx4 v7, s[8:11], s34 offen nt lds
  s_add_u32 m0, s38, 30720
  s_mov_b32 s34, 2211840
  buffer_load_dwordx4 v2, s[8:11], s34 offen nt lds
  s_add_u32 m0, s38, 31744
  s_mov_b32 s34, 2285568
  buffer_load_dwordx4 v7, s[8:11], s34 offen nt lds
  s_add_u32 m0, s38, 32768
  s_mov_b32 s34, 2359296
  buffer_load_dwordx4 v2, s[8:11], s34 offen nt lds
  s_add_u32 m0, s38, 33792
  s_mov_b32 s34, 2433024
  buffer_load_dwordx4 v7, s[8:11], s34 offen nt lds
  s_add_u32 m0, s38, 34816
  s_mov_b32 s34, 2506752
  buffer_load_dwordx4 v2, s[8:11], s34 offen nt lds
  s_add_u32 m0, s38, 35840
  s_mov_b32 s34, 2580480
  buffer_load_dwordx4 v7, s[8:11], s34 offen nt lds
  s_mul_i32 s49, s37, 9
  s_lshl_b32 s34, s36, 2
  s_add_u32 s34, s34, 0
  s_mul_i32 s35, s34, 57
  s_lshr_b32 s35, s35, 9
  s_mul_i32 s45, s35, 9
  s_sub_u32 s34, s34, s45
  s_mul_i32 s34, s34, 18
  s_add_u32 s34, s34, s49
  s_lshl_b32 s34, s34, 12
  s_lshl_b32 s35, s35, 7
  s_add_u32 s34, s34, s35
  s_mul_i32 s35, s32, 1327104
  s_add_u32 s40, s34, s35
  s_lshl_b32 s34, s36, 2
  s_add_u32 s34, s34, 1
  s_mul_i32 s35, s34, 57
  s_lshr_b32 s35, s35, 9
  s_mul_i32 s45, s35, 9
  s_sub_u32 s34, s34, s45
  s_mul_i32 s34, s34, 18
  s_add_u32 s34, s34, s49
  s_lshl_b32 s34, s34, 12
  s_lshl_b32 s35, s35, 7
  s_add_u32 s34, s34, s35
  s_mul_i32 s35, s32, 1327104
  s_add_u32 s41, s34, s35
  s_lshl_b32 s34, s36, 2
  s_add_u32 s34, s34, 2
  s_mul_i32 s35, s34, 57
  s_lshr_b32 s35, s35, 9
  s_mul_i32 s45, s35, 9
  s_sub_u32 s34, s34, s45
  s_mul_i32 s34, s34, 18
  s_add_u32 s34, s34, s49
  s_lshl_b32 s34, s34, 12
  s_lshl_b32 s35, s35, 7
  s_add_u32 s34, s34, s35
  s_mul_i32 s35, s32, 1327104
  s_add_u32 s42, s34, s35
  s_lshl_b32 s34, s36, 2
  s_add_u32 s34, s34, 3
  s_mul_i32 s35, s34, 57
  s_lshr_b32 s35, s35, 9
  s_mul_i32 s45, s35, 9
  s_sub_u32 s34, s34, s45
  s_mul_i32 s34, s34, 18
  s_add_u32 s34, s34, s49
  s_lshl_b32 s34, s34, 12
  s_lshl_b32 s35, s35, 7
  s_add_u32 s34, s34, s35
  s_mul_i32 s35, s32, 1327104
  s_add_u32 s43, s34, s35
  s_mov_b32 s39, 0x3f803f80
  v_bfe_u32 v8, v1, 2, 2
  v_lshrrev_b32 v9, 4, v1
  v_lshl_add_u32 v11, v9, 3, v8
  v_lshlrev_b32 v11, 7, v11
  v_lshrrev_b32 v8, 1, v8
  v_and_b32 v9, 1, v9
  v_lshl_or_b32 v8, v9, 1, v8
  v_and_b32 v9, 3, v1
  v_lshl_add_u32 v11, v9, 3, v11
  v_add_u32 v11, s38, v11
  v_xor_b32 v9, 0, v8
  v_lshl_add_u32 v3, v9, 5, v11
  v_xor_b32 v9, 1, v8
  v_lshl_add_u32 v4, v9, 5, v11
  v_xor_b32 v9, 2, v8
  v_lshl_add_u32 v5, v9, 5, v11
  v_xor_b32 v9, 3, v8
  v_lshl_add_u32 v6, v9, 5, v11
  v_mov_b32 v12, 0
  v_mov_b32 v13, 0
  v_mov_b32 v14, 0
  v_mov_b32 v15, 0
  v_lshrrev_b32 v8, 3, v1
  v_lshlrev_b32 v8, 9, v8
  v_and_b32 v48, 7, v1
  v_lshl_add_u32 v48, v48, 4, v8
  s_waitcnt vmcnt(32)
  ds_read_b64_tr_b16 v[16:17], v3 offset:0
  ds_read_b64_tr_b16 v[18:19], v3 offset:512
  ds_read_b64_tr_b16 v[20:21], v4 offset:0
  ds_read_b64_tr_b16 v[22:23], v4 offset:512
  ds_read_b64_tr_b16 v[24:25], v5 offset:0
  ds_read_b64_tr_b16 v[26:27], v5 offset:512
  ds_read_b64_tr_b16 v[28:29], v6 offset:0
  ds_read_b64_tr_b16 v[30:31], v6 offset:512
  s_waitcnt lgkmcnt(6)
  buffer_store_dwordx4 v[16:19], v48, s[12:15], s40 offen sc1
  s_waitcnt lgkmcnt(4)
  buffer_store_dwordx4 v[20:23], v48, s[12:15], s41 offen sc1
  s_waitcnt lgkmcnt(2)
  buffer_store_dwordx4 v[24:27], v48, s[12:15], s42 offen sc1
  s_waitcnt lgkmcnt(0)
  buffer_store_dwordx4 v[28:31], v48, s[12:15], s43 offen sc1
  v_add_u32 v48, 0x1000, v48
  v_dot2_f32_bf16 v12, v16, s39, v12
  v_dot2_f32_bf16 v13, v20, s39, v13
  v_dot2_f32_bf16 v14, v24, s39, v14
  v_dot2_f32_bf16 v15, v28, s39, v15
  v_dot2_f32_bf16 v12, v17, s39, v12
  v_dot2_f32_bf16 v13, v21, s39, v13
  v_dot2_f32_bf16 v14, v25, s39, v14
  v_dot2_f32_bf16 v15, v29, s39, v15
  v_dot2_f32_bf16 v12, v18, s39, v12
  v_dot2_f32_bf16 v13, v22, s39, v13
  v_dot2_f32_bf16 v14, v26, s39, v14
  v_dot2_f32_bf16 v15, v30, s39, v15
  v_dot2_f32_bf16 v12, v19, s39, v12
  v_dot2_f32_bf16 v13, v23, s39, v13
  v_dot2_f32_bf16 v14, v27, s39, v14
  v_dot2_f32_bf16 v15, v31, s39, v15
  s_waitcnt vmcnt(32)
  ds_read_b64_tr_b16 v[32:33], v3 offset:4096
  ds_read_b64_tr_b16 v[34:35], v3 offset:4608
  ds_read_b64_tr_b16 v[36:37], v4 offset:4096
  ds_read_b64_tr_b16 v[38:39], v4 offset:4608
  ds_read_b64_tr_b16 v[40:41], v5 offset:4096
  ds_read_b64_tr_b16 v[42:43], v5 offset:4608
  ds_read_b64_tr_b16 v[44:45], v6 offset:4096
  ds_read_b64_tr_b16 v[46:47], v6 offset:4608
  s_waitcnt lgkmcnt(6)
  buffer_store_dwordx4 v[32:35], v48, s[12:15], s40 offen sc1
  s_waitcnt lgkmcnt(4)
  buffer_store_dwordx4 v[36:39], v48, s[12:15], s41 offen sc1
  s_waitcnt lgkmcnt(2)
  buffer_store_dwordx4 v[40:43], v48, s[12:15], s42 offen sc1
  s_waitcnt lgkmcnt(0)
  buffer_store_dwordx4 v[44:47], v48, s[12:15], s43 offen sc1
  v_add_u32 v48, 0x1000, v48
  v_dot2_f32_bf16 v12, v32, s39, v12
  v_dot2_f32_bf16 v13, v36, s39, v13
  v_dot2_f32_bf16 v14, v40, s39, v14
  v_dot2_f32_bf16 v15, v44, s39, v15
  v_dot2_f32_bf16 v12, v33, s39, v12
  v_dot2_f32_bf16 v13, v37, s39, v13
  v_dot2_f32_bf16 v14, v41, s39, v14
  v_dot2_f32_bf16 v15, v45, s39, v15
  v_dot2_f32_bf16 v12, v34, s39, v12
  v_dot2_f32_bf16 v13, v38, s39, v13
  v_dot2_f32_bf16 v14, v42, s39, v14
  v_dot2_f32_bf16 v15, v46, s39, v15
  v_dot2_f32_bf16 v12, v35, s39, v12
  v_dot2_f32_bf16 v13, v39, s39, v13
  v_dot2_f32_bf16 v14, v43, s39, v14
  v_dot2_f32_bf16 v15, v47, s39, v15
  s_waitcnt vmcnt(32)
  ds_read_b64_tr_b16 v[16:17], v3 offset:8192
  ds_read_b64_tr_b16 v[18:19], v3 offset:8704
  ds_read_b64_tr_b16 v[20:21], v4 offset:8192
  ds_read_b64_tr_b16 v[22:23], v4 offset:8704
  ds_read_b64_tr_b16 v[24:25], v5 offset:8192
  ds_read_b64_tr_b16 v[26:27], v5 offset:8704
  ds_read_b64_tr_b16 v[28:29], v6 offset:8192
  ds_read_b64_tr_b16 v[30:31], v6 offset:8704
  s_waitcnt lgkmcnt(6)
  buffer_store_dwordx4 v[16:19], v48, s[12:15], s40 offen sc1
  s_waitcnt lgkmcnt(4)
  buffer_store_dwordx4 v[20:23], v48, s[12:15], s41 offen sc1
  s_waitcnt lgkmcnt(2)
  buffer_store_dwordx4 v[24:27], v48, s[12:15], s42 offen sc1
  s_waitcnt lgkmcnt(0)
  buffer_store_dwordx4 v[28:31], v48, s[12:15], s43 offen sc1
  v_add_u32 v48, 0x1000, v48
  v_dot2_f32_bf16 v12, v16, s39, v12
  v_dot2_f32_bf16 v13, v20, s39, v13
  v_dot2_f32_bf16 v14, v24, s39, v14
  v_dot2_f32_bf16 v15, v28, s39, v15
  v_dot2_f32_bf16 v12, v17, s39, v12
  v_dot2_f32_bf16 v13, v21, s39, v13
  v_dot2_f32_bf16 v14, v25, s39, v14
  v_dot2_f32_bf16 v15, v29, s39, v15
  v_dot2_f32_bf16 v12, v18, s39, v12
  v_dot2_f32_bf16 v13, v22, s39, v13
  v_dot2_f32_bf16 v14, v26, s39, v14
  v_dot2_f32_bf16 v15, v30, s39, v15
  v_dot2_f32_bf16 v12, v19, s39, v12
  v_dot2_f32_bf16 v13, v23, s39, v13
  v_dot2_f32_bf16 v14, v27, s39, v14
  v_dot2_f32_bf16 v15, v31, s39, v15
  s_waitcnt vmcnt(32)
  ds_read_b64_tr_b16 v[32:33], v3 offset:12288
  ds_read_b64_tr_b16 v[34:35], v3 offset:12800
  ds_read_b64_tr_b16 v[36:37], v4 offset:12288
  ds_read_b64_tr_b16 v[38:39], v4 offset:12800
  ds_read_b64_tr_b16 v[40:41], v5 offset:12288
  ds_read_b64_tr_b16 v[42:43], v5 offset:12800
  ds_read_b64_tr_b16 v[44:45], v6 offset:12288
  ds_read_b64_tr_b16 v[46:47], v6 offset:12800
  s_waitcnt lgkmcnt(6)
  buffer_store_dwordx4 v[32:35], v48, s[12:15], s40 offen sc1
  s_waitcnt lgkmcnt(4)
  buffer_store_dwordx4 v[36:39], v48, s[12:15], s41 offen sc1
  s_waitcnt lgkmcnt(2)
  buffer_store_dwordx4 v[40:43], v48, s[12:15], s42 offen sc1
  s_waitcnt lgkmcnt(0)
  buffer_store_dwordx4 v[44:47], v48, s[12:15], s43 offen sc1
  v_add_u32 v48, 0x1000, v48
  v_dot2_f32_bf16 v12, v32, s39, v12
  v_dot2_f32_bf16 v13, v36, s39, v13
  v_dot2_f32_bf16 v14, v40, s39, v14
  v_dot2_f32_bf16 v15, v44, s39, v15
  v_dot2_f32_bf16 v12, v33, s39, v12
  v_dot2_f32_bf16 v13, v37, s39, v13
  v_dot2_f32_bf16 v14, v41, s39, v14
  v_dot2_f32_bf16 v15, v45, s39, v15
  v_dot2_f32_bf16 v12, v34, s39, v12
  v_dot2_f32_bf16 v13, v38, s39, v13
  v_dot2_f32_bf16 v14, v42, s39, v14
  v_dot2_f32_bf16 v15, v46, s39, v15
  v_dot2_f32_bf16 v12, v35, s39, v12
  v_dot2_f32_bf16 v13, v39, s39, v13
  v_dot2_f32_bf16 v14, v43, s39, v14
  v_dot2_f32_bf16 v15, v47, s39, v15
  s_waitcnt vmcnt(32)
  ds_read_b64_tr_b16 v[16:17], v3 offset:16384
  ds_read_b64_tr_b16 v[18:19], v3 offset:16896
  ds_read_b64_tr_b16 v[20:21], v4 offset:16384
  ds_read_b64_tr_b16 v[22:23], v4 offset:16896
  ds_read_b64_tr_b16 v[24:25], v5 offset:16384
  ds_read_b64_tr_b16 v[26:27], v5 offset:16896
  ds_read_b64_tr_b16 v[28:29], v6 offset:16384
  ds_read_b64_tr_b16 v[30:31], v6 offset:16896
  s_waitcnt lgkmcnt(6)
  buffer_store_dwordx4 v[16:19], v48, s[12:15], s40 offen sc1
  s_waitcnt lgkmcnt(4)
  buffer_store_dwordx4 v[20:23], v48, s[12:15], s41 offen sc1
  s_waitcnt lgkmcnt(2)
  buffer_store_dwordx4 v[24:27], v48, s[12:15], s42 offen sc1
  s_waitcnt lgkmcnt(0)
  buffer_store_dwordx4 v[28:31], v48, s[12:15], s43 offen sc1
  v_add_u32 v48, 0x1000, v48
  v_dot2_f32_bf16 v12, v16, s39, v12
  v_dot2_f32_bf16 v13, v20, s39, v13
  v_dot2_f32_bf16 v14, v24, s39, v14
  v_dot2_f32_bf16 v15, v28, s39, v15
  v_dot2_f32_bf16 v12, v17, s39, v12
  v_dot2_f32_bf16 v13, v21, s39, v13
  v_dot2_f32_bf16 v14, v25, s39, v14
  v_dot2_f32_bf16 v15, v29, s39, v15
  v_dot2_f32_bf16 v12, v18, s39, v12
  v_dot2_f32_bf16 v13, v22, s39, v13
  v_dot2_f32_bf16 v14, v26, s39, v14
  v_dot2_f32_bf16 v15, v30, s39, v15
  v_dot2_f32_bf16 v12, v19, s39, v12
  v_dot2_f32_bf16 v13, v23, s39, v13
  v_dot2_f32_bf16 v14, v27, s39, v14
  v_dot2_f32_bf16 v15, v31, s39, v15
  s_waitcnt vmcnt(32)
  ds_read_b64_tr_b16 v[32:33], v3 offset:20480
  ds_read_b64_tr_b16 v[34:35], v3 offset:20992
  ds_read_b64_tr_b16 v[36:37], v4 offset:20480
  ds_read_b64_tr_b16 v[38:39], v4 offset:20992
  ds_read_b64_tr_b16 v[40:41], v5 offset:20480
  ds_read_b64_tr_b16 v[42:43], v5 offset:20992
  ds_read_b64_tr_b16 v[44:45], v6 offset:20480
  ds_read_b64_tr_b16 v[46:47], v6 offset:20992
  s_waitcnt lgkmcnt(6)
  buffer_store_dwordx4 v[32:35], v48, s[12:15], s40 offen sc1
  s_waitcnt lgkmcnt(4)
  buffer_store_dwordx4 v[36:39], v48, s[12:15], s41 offen sc1
  s_waitcnt lgkmcnt(2)
  buffer_store_dwordx4 v[40:43], v48, s[12:15], s42 offen sc1
  s_waitcnt lgkmcnt(0)
  buffer_store_dwordx4 v[44:47], v48, s[12:15], s43 offen sc1
  v_add_u32 v48, 0x1000, v48
  v_dot2_f32_bf16 v12, v32, s39, v12
  v_dot2_f32_bf16 v13, v36, s39, v13
  v_dot2_f32_bf16 v14, v40, s39, v14
  v_dot2_f32_bf16 v15, v44, s39, v15
  v_dot2_f32_bf16 v12, v33, s39, v12
  v_dot2_f32_bf16 v13, v37, s39, v13
  v_dot2_f32_bf16 v14, v41, s39, v14
  v_dot2_f32_bf16 v15, v45, s39, v15
  v_dot2_f32_bf16 v12, v34, s39, v12
  v_dot2_f32_bf16 v13, v38, s39, v13
  v_dot2_f32_bf16 v14, v42, s39, v14
  v_dot2_f32_bf16 v15, v46, s39, v15
  v_dot2_f32_bf16 v12, v35, s39, v12
  v_dot2_f32_bf16 v13, v39, s39, v13
  v_dot2_f32_bf16 v14, v43, s39, v14
  v_dot2_f32_bf16 v15, v47, s39, v15
  s_waitcnt vmcnt(32)
  ds_read_b64_tr_b16 v[16:17], v3 offset:24576
  ds_read_b64_tr_b16 v[18:19], v3 offset:25088
  ds_read_b64_tr_b16 v[20:21], v4 offset:24576
  ds_read_b64_tr_b16 v[22:23], v4 offset:25088
  ds_read_b64_tr_b16 v[24:25], v5 offset:24576
  ds_read_b64_tr_b16 v[26:27], v5 offset:25088
  ds_read_b64_tr_b16 v[28:29], v6 offset:24576
  ds_read_b64_tr_b16 v[30:31], v6 offset:25088
  s_waitcnt lgkmcnt(6)
  buffer_store_dwordx4 v[16:19], v48, s[12:15], s40 offen sc1
  s_waitcnt lgkmcnt(4)
  buffer_store_dwordx4 v[20:23], v48, s[12:15], s41 offen sc1
  s_waitcnt lgkmcnt(2)
  buffer_store_dwordx4 v[24:27], v48, s[12:15], s42 offen sc1
  s_waitcnt lgkmcnt(0)
  buffer_store_dwordx4 v[28:31], v48, s[12:15], s43 offen sc1
  v_add_u32 v48, 0x1000, v48
  v_dot2_f32_bf16 v12, v16, s39, v12
  v_dot2_f32_bf16 v13, v20, s39, v13
  v_dot2_f32_bf16 v14, v24, s39, v14
  v_dot2_f32_bf16 v15, v28, s39, v15
  v_dot2_f32_bf16 v12, v17, s39, v12
  v_dot2_f32_bf16 v13, v21, s39, v13
  v_dot2_f32_bf16 v14, v25, s39, v14
  v_dot2_f32_bf16 v15, v29, s39, v15
  v_dot2_f32_bf16 v12, v18, s39, v12
  v_dot2_f32_bf16 v13, v22, s39, v13
  v_dot2_f32_bf16 v14, v26, s39, v14
  v_dot2_f32_bf16 v15, v30, s39, v15
  v_dot2_f32_bf16 v12, v19, s39, v12
  v_dot2_f32_bf16 v13, v23, s39, v13
  v_dot2_f32_bf16 v14, v27, s39, v14
  v_dot2_f32_bf16 v15, v31, s39, v15
  s_waitcnt vmcnt(32)
  ds_read_b64_tr_b16 v[32:33], v3 offset:28672
  ds_read_b64_tr_b16 v[34:35], v3 offset:29184
  ds_read_b64_tr_b16 v[36:37], v4 offset:28672
  ds_read_b64_tr_b16 v[38:39], v4 offset:29184
  ds_read_b64_tr_b16 v[40:41], v5 offset:28672
  ds_read_b64_tr_b16 v[42:43], v5 offset:29184
  ds_read_b64_tr_b16 v[44:45], v6 offset:28672
  ds_read_b64_tr_b16 v[46:47], v6 offset:29184
  s_waitcnt lgkmcnt(6)
  buffer_store_dwordx4 v[32:35], v48, s[12:15], s40 offen sc1
  s_waitcnt lgkmcnt(4)
  buffer_store_dwordx4 v[36:39], v48, s[12:15], s41 offen sc1
  s_waitcnt lgkmcnt(2)
  buffer_store_dwordx4 v[40:43], v48, s[12:15], s42 offen sc1
  s_waitcnt lgkmcnt(0)
  buffer_store_dwordx4 v[44:47], v48, s[12:15], s43 offen sc1
  v_add_u32 v48, 0x1000, v48
  v_dot2_f32_bf16 v12, v32, s39, v12
  v_dot2_f32_bf16 v13, v36, s39, v13
  v_dot2_f32_bf16 v14, v40, s39, v14
  v_dot2_f32_bf16 v15, v44, s39, v15
  v_dot2_f32_bf16 v12, v33, s39, v12
  v_dot2_f32_bf16 v13, v37, s39, v13
  v_dot2_f32_bf16 v14, v41, s39, v14
  v_dot2_f32_bf16 v15, v45, s39, v15
  v_dot2_f32_bf16 v12, v34, s39, v12
  v_dot2_f32_bf16 v13, v38, s39, v13
  v_dot2_f32_bf16 v14, v42, s39, v14
  v_dot2_f32_bf16 v15, v46, s39, v15
  v_dot2_f32_bf16 v12, v35, s39, v12
  v_dot2_f32_bf16 v13, v39, s39, v13
  v_dot2_f32_bf16 v14, v43, s39, v14
  v_dot2_f32_bf16 v15, v47, s39, v15
  s_waitcnt vmcnt(32)
  ds_read_b64_tr_b16 v[16:17], v3 offset:32768
  ds_read_b64_tr_b16 v[18:19], v3 offset:33280
  ds_read_b64_tr_b16 v[20:21], v4 offset:32768
  ds_read_b64_tr_b16 v[22:23], v4 offset:33280
  ds_read_b64_tr_b16 v[24:25], v5 offset:32768
  ds_read_b64_tr_b16 v[26:27], v5 offset:33280
  ds_read_b64_tr_b16 v[28:29], v6 offset:32768
  ds_read_b64_tr_b16 v[30:31], v6 offset:33280
  s_waitcnt lgkmcnt(6)
  buffer_store_dwordx4 v[16:19], v48, s[12:15], s40 offen sc1
  s_waitcnt lgkmcnt(4)
  buffer_store_dwordx4 v[20:23], v48, s[12:15], s41 offen sc1
  s_waitcnt lgkmcnt(2)
  buffer_store_dwordx4 v[24:27], v48, s[12:15], s42 offen sc1
  s_waitcnt lgkmcnt(0)
  buffer_store_dwordx4 v[28:31], v48, s[12:15], s43 offen sc1
  v_dot2_f32_bf16 v12, v16, s39, v12
  v_dot2_f32_bf16 v13, v20, s39, v13
  v_dot2_f32_bf16 v14, v24, s39, v14
  v_dot2_f32_bf16 v15, v28, s39, v15
  v_dot2_f32_bf16 v12, v17, s39, v12
  v_dot2_f32_bf16 v13, v21, s39, v13
  v_dot2_f32_bf16 v14, v25, s39, v14
  v_dot2_f32_bf16 v15, v29, s39, v15
  v_dot2_f32_bf16 v12, v18, s39, v12
  v_dot2_f32_bf16 v13, v22, s39, v13
  v_dot2_f32_bf16 v14, v26, s39, v14
  v_dot2_f32_bf16 v15, v30, s39, v15
  v_dot2_f32_bf16 v12, v19, s39, v12
  v_dot2_f32_bf16 v13, v23, s39, v13
  v_dot2_f32_bf16 v14, v27, s39, v14
  v_dot2_f32_bf16 v15, v31, s39, v15
  v_mov_b32 v16, v12
  v_mov_b32 v17, v13
  v_mov_b32 v18, v14
  v_mov_b32 v19, v15
  v_permlane16_swap_b32 v12, v16
  v_permlane16_swap_b32 v13, v17
  v_permlane16_swap_b32 v14, v18
  v_permlane16_swap_b32 v15, v19
  v_add_f32 v12, v12, v16
  v_add_f32 v13, v13, v17
  v_add_f32 v14, v14, v18
  v_add_f32 v15, v15, v19
  v_mov_b32 v16, v12
  v_mov_b32 v17, v13
  v_mov_b32 v18, v14
  v_mov_b32 v19, v15
  v_permlane32_swap_b32 v12, v16
  v_permlane32_swap_b32 v13, v17
  v_permlane32_swap_b32 v14, v18
  v_permlane32_swap_b32 v15, v19
  v_add_f32 v12, v12, v16
  v_add_f32 v13, v13, v17
  v_add_f32 v14, v14, v18
  v_add_f32 v15, v15, v19
  v_lshrrev_b32 v9, 4, v1
  v_cmp_eq_u32 vcc, 1, v9
  s_nop 1
  v_cndmask_b32 v12, v12, v13, vcc
  v_cmp_eq_u32 vcc, 2, v9
  s_nop 1
  v_cndmask_b32 v12, v12, v14, vcc
  v_cmp_eq_u32 vcc, 3, v9
  s_nop 1
  v_cndmask_b32 v12, v12, v15, vcc
  s_add_u32 s16, s4, 11436032
  s_addc_u32 s17, s5, 0
  s_and_b32 s17, s17, 0xffff
  s_mov_b32 s18, 55296
  s_mov_b32 s19, 0x20000
  s_mul_i32 s34, s37, 4608
  s_mul_i32 s35, s32, 576
  s_add_u32 s34, s34, s35
  s_lshl_b32 s35, s36, 6
  s_add_u32 s34, s34, s35
  s_lshl_b32 s34, s34, 2
  v_lshlrev_b32 v8, 2, v1
  buffer_store_dword v12, v8, s[16:19], s34 offen sc1
  s_endpgm
L_sw_w2:
  s_sub_u32 s36, s33, 18
  s_mul_i32 s34, s32, 663552
  s_lshl_b32 s35, s36, 7
  s_add_u32 s34, s34, s35
  s_sub_u32 s47, 5308416, s34
  s_add_u32 s8, s24, s34
  s_addc_u32 s9, s25, 0
  s_and_b32 s9, s9, 0xffff
  s_mov_b32 s10, 0
  s_mov_b32 s11, 0x20000
  s_mov_b32 s10, s47
  v_lshrrev_b32 v8, 3, v1
  v_mul_u32_u24 v2, 1152, v8
  v_bfe_u32 v8, v1, 4, 1
  v_lshlrev_b32 v8, 2, v8
  v_and_b32 v9, 7, v1
  v_xor_b32 v8, v8, v9
  v_lshl_add_u32 v2, v8, 4, v2
  v_bfe_u32 v8, v1, 2, 2
  v_lshrrev_b32 v9, 4, v1
  v_lshl_add_u32 v11, v9, 2, v8
  v_lshlrev_b32 v11, 7, v11
  v_add_u32 v11, s38, v11
  v_lshrrev_b32 v8, 1, v8
  v_lshlrev_b32 v8, 2, v8
  v_and_b32 v9, 3, v1
  v_xor_b32 v8, v8, v9
  v_xor_b32 v9, 0, v8
  v_lshl_add_u32 v3, v9, 4, v11
  v_xor_b32 v9, 0, v8
  v_lshl_add_u32 v4, v9, 4, v11
  v_add_u32 v4, 8, v4
  v_xor_b32 v9, 4, v8
  v_lshl_add_u32 v5, v9, 4, v11
  v_xor_b32 v9, 4, v8
  v_lshl_add_u32 v6, v9, 4, v11
  v_add_u32 v6, 8, v6
  s_add_u32 m0, s38, 0
  s_mov_b32 s34, 0
  buffer_load_dwordx4 v2, s[8:11], s34 offen nt lds
  s_add_u32 m0, s38, 1024
  s_mov_b32 s34, 9216
  buffer_load_dwordx4 v2, s[8:11], s34 offen nt lds
  s_add_u32 m0, s38, 2048
  s_mov_b32 s34, 18432
  buffer_load_dwordx4 v2, s[8:11], s34 offen nt lds
  s_add_u32 m0, s38, 3072
  s_mov_b32 s34, 27648
  buffer_load_dwordx4 v2, s[8:11], s34 offen nt lds
  s_add_u32 m0, s38, 4096
  s_mov_b32 s34, 36864
  buffer_load_dwordx4 v2, s[8:11], s34 offen nt lds
  s_add_u32 m0, s38, 5120
  s_mov_b32 s34, 46080
  buffer_load_dwordx4 v2, s[8:11], s34 offen nt lds
  s_add_u32 m0, s38, 6144
  s_mov_b32 s34, 55296
  buffer_load_dwordx4 v2, s[8:11], s34 offen nt lds
  s_add_u32 m0, s38, 7168
  s_mov_b32 s34, 64512
  buffer_load_dwordx4 v2, s[8:11], s34 offen nt lds
  s_add_u32 m0, s38, 8192
  s_mov_b32 s34, 73728
  buffer_load_dwordx4 v2, s[8:11], s34 offen nt lds
  s_add_u32 m0, s38, 9216
  s_mov_b32 s34, 82944
  buffer_load_dwordx4 v2, s[8:11], s34 offen nt lds
  s_add_u32 m0, s38, 10240
  s_mov_b32 s34, 92160
  buffer_load_dwordx4 v2, s[8:11], s34 offen nt lds
  s_add_u32 m0, s38, 11264
  s_mov_b32 s34, 101376
  buffer_load_dwordx4 v2, s[8:11], s34 offen nt lds
  s_add_u32 m0, s38, 12288
  s_mov_b32 s34, 110592
  buffer_load_dwordx4 v2, s[8:11], s34 offen nt lds
  s_add_u32 m0, s38, 13312
  s_mov_b32 s34, 119808
  buffer_load_dwordx4 v2, s[8:11], s34 offen nt lds
  s_add_u32 m0, s38, 14336
  s_mov_b32 s34, 129024
  buffer_load_dwordx4 v2, s[8:11], s34 offen nt lds
  s_add_u32 m0, s38, 15360
  s_mov_b32 s34, 138240
  buffer_load_dwordx4 v2, s[8:11], s34 offen nt lds
  s_mov_b32 s49, 0
  s_lshl_b32 s34, s36, 2
  s_add_u32 s34, s34, 0
  s_mul_i32 s35, s34, 57
  s_lshr_b32 s35, s35, 9
  s_mul_i32 s45, s35, 9
  s_sub_u32 s34, s34, s45
  s_cmp_eq_u32 s34, 8
  s_cselect_b32 s46, -8, 1
  s_and_b32 s45, s35, 1
  s_cselect_b32 s46, 0, s46
  s_add_u32 s34, s34, s46
  s_mul_i32 s34, s34, 18
  s_add_u32 s34, s34, s49
  s_add_u32 s34, s34, 162
  s_lshl_b32 s34, s34, 12
  s_lshl_b32 s35, s35, 7
  s_add_u32 s34, s34, s35
  s_mul_i32 s35, s32, 1327104
  s_add_u32 s40, s34, s35
  s_lshl_b32 s34, s36, 2
  s_add_u32 s34, s34, 1
  s_mul_i32 s35, s34, 57
  s_lshr_b32 s35, s35, 9
  s_mul_i32 s45, s35, 9
  s_sub_u32 s34, s34, s45
  s_cmp_eq_u32 s34, 8
  s_cselect_b32 s46, -8, 1
  s_and_b32 s45, s35, 1
  s_cselect_b32 s46, 0, s46
  s_add_u32 s34, s34, s46
  s_mul_i32 s34, s34, 18
  s_add_u32 s34, s34, s49
  s_add_u32 s34, s34, 162
  s_lshl_b32 s34, s34, 12
  s_lshl_b32 s35, s35, 7
  s_add_u32 s34, s34, s35
  s_mul_i32 s35, s32, 1327104
  s_add_u32 s41, s34, s35
  s_lshl_b32 s34, s36, 2
  s_add_u32 s34, s34, 2
  s_mul_i32 s35, s34, 57
  s_lshr_b32 s35, s35, 9
  s_mul_i32 s45, s35, 9
  s_sub_u32 s34, s34, s45
  s_cmp_eq_u32 s34, 8
  s_cselect_b32 s46, -8, 1
  s_and_b32 s45, s35, 1
  s_cselect_b32 s46, 0, s46
  s_add_u32 s34, s34, s46
  s_mul_i32 s34, s34, 18
  s_add_u32 s34, s34, s49
  s_add_u32 s34, s34, 162
  s_lshl_b32 s34, s34, 12
  s_lshl_b32 s35, s35, 7
  s_add_u32 s34, s34, s35
  s_mul_i32 s35, s32, 1327104
  s_add_u32 s42, s34, s35
  s_lshl_b32 s34, s36, 2
  s_add_u32 s34, s34, 3
  s_mul_i32 s35, s34, 57
  s_lshr_b32 s35, s35, 9
  s_mul_i32 s45, s35, 9
  s_sub_u32 s34, s34, s45
  s_cmp_eq_u32 s34, 8
  s_cselect_b32 s46, -8, 1
  s_and_b32 s45, s35, 1
  s_cselect_b32 s46, 0, s46
  s_add_u32 s34, s34, s46
  s_mul_i32 s34, s34, 18
  s_add_u32 s34, s34, s49
  s_add_u32 s34, s34, 162
  s_lshl_b32 s34, s34, 12
  s_lshl_b32 s35, s35, 7
  s_add_u32 s34, s34, s35
  s_mul_i32 s35, s32, 1327104
  s_add_u32 s43, s34, s35
  v_lshrrev_b32 v8, 3, v1
  v_lshlrev_b32 v8, 9, v8
  v_and_b32 v48, 7, v1
  v_lshl_add_u32 v48, v48, 4, v8
  s_waitcnt vmcnt(12)
  ds_read_b64_tr_b16 v[16:17], v3 offset:0
  ds_read_b64_tr_b16 v[18:19], v3 offset:2048
  ds_read_b64_tr_b16 v[20:21], v4 offset:0
  ds_read_b64_tr_b16 v[22:23], v4 offset:2048
  ds_read_b64_tr_b16 v[24:25], v5 offset:0
  ds_read_b64_tr_b16 v[26:27], v5 offset:2048
  ds_read_b64_tr_b16 v[28:29], v6 offset:0
  ds_read_b64_tr_b16 v[30:31], v6 offset:2048
  s_waitcnt lgkmcnt(6)
  buffer_store_dwordx4 v[16:19], v48, s[12:15], s40 offen sc1
  s_waitcnt lgkmcnt(4)
  buffer_store_dwordx4 v[20:23], v48, s[12:15], s41 offen sc1
  s_waitcnt lgkmcnt(2)
  buffer_store_dwordx4 v[24:27], v48, s[12:15], s42 offen sc1
  s_waitcnt lgkmcnt(0)
  buffer_store_dwordx4 v[28:31], v48, s[12:15], s43 offen sc1
  v_add_u32 v48, 0x1000, v48
  s_waitcnt vmcnt(12)
  ds_read_b64_tr_b16 v[32:33], v3 offset:4096
  ds_read_b64_tr_b16 v[34:35], v3 offset:6144
  ds_read_b64_tr_b16 v[36:37], v4 offset:4096
  ds_read_b64_tr_b16 v[38:39], v4 offset:6144
  ds_read_b64_tr_b16 v[40:41], v5 offset:4096
  ds_read_b64_tr_b16 v[42:43], v5 offset:6144
  ds_read_b64_tr_b16 v[44:45], v6 offset:4096
  ds_read_b64_tr_b16 v[46:47], v6 offset:6144
  s_waitcnt lgkmcnt(6)
  buffer_store_dwordx4 v[32:35], v48, s[12:15], s40 offen sc1
  s_waitcnt lgkmcnt(4)
  buffer_store_dwordx4 v[36:39], v48, s[12:15], s41 offen sc1
  s_waitcnt lgkmcnt(2)
  buffer_store_dwordx4 v[40:43], v48, s[12:15], s42 offen sc1
  s_waitcnt lgkmcnt(0)
  buffer_store_dwordx4 v[44:47], v48, s[12:15], s43 offen sc1
  v_add_u32 v48, 0x1000, v48
  s_waitcnt vmcnt(12)
  ds_read_b64_tr_b16 v[16:17], v3 offset:8192
  ds_read_b64_tr_b16 v[18:19], v3 offset:10240
  ds_read_b64_tr_b16 v[20:21], v4 offset:8192
  ds_read_b64_tr_b16 v[22:23], v4 offset:10240
  ds_read_b64_tr_b16 v[24:25], v5 offset:8192
  ds_read_b64_tr_b16 v[26:27], v5 offset:10240
  ds_read_b64_tr_b16 v[28:29], v6 offset:8192
  ds_read_b64_tr_b16 v[30:31], v6 offset:10240
  s_waitcnt lgkmcnt(6)
  buffer_store_dwordx4 v[16:19], v48, s[12:15], s40 offen sc1
  s_waitcnt lgkmcnt(4)
  buffer_store_dwordx4 v[20:23], v48, s[12:15], s41 offen sc1
  s_waitcnt lgkmcnt(2)
  buffer_store_dwordx4 v[24:27], v48, s[12:15], s42 offen sc1
  s_waitcnt lgkmcnt(0)
  buffer_store_dwordx4 v[28:31], v48, s[12:15], s43 offen sc1
  v_add_u32 v48, 0x1000, v48
  s_waitcnt vmcnt(12)
  ds_read_b64_tr_b16 v[32:33], v3 offset:12288
  ds_read_b64_tr_b16 v[34:35], v3 offset:14336
  ds_read_b64_tr_b16 v[36:37], v4 offset:12288
  ds_read_b64_tr_b16 v[38:39], v4 offset:14336
  ds_read_b64_tr_b16 v[40:41], v5 offset:12288
  ds_read_b64_tr_b16 v[42:43], v5 offset:14336
  ds_read_b64_tr_b16 v[44:45], v6 offset:12288
  ds_read_b64_tr_b16 v[46:47], v6 offset:14336
  s_waitcnt lgkmcnt(6)
  buffer_store_dwordx4 v[32:35], v48, s[12:15], s40 offen sc1
  s_waitcnt lgkmcnt(4)
  buffer_store_dwordx4 v[36:39], v48, s[12:15], s41 offen sc1
  s_waitcnt lgkmcnt(2)
  buffer_store_dwordx4 v[40:43], v48, s[12:15], s42 offen sc1
  s_waitcnt lgkmcnt(0)
  buffer_store_dwordx4 v[44:47], v48, s[12:15], s43 offen sc1
  s_endpgm
L_sw_misc:
  s_sub_u32 s36, s33, 27
  s_mul_i32 s34, s36, 165888
  s_mul_i32 s35, s32, 144
  s_add_u32 s34, s34, s35
  s_sub_u32 s47, 663552, s34
  s_min_u32 s47, s47, 165888
  s_add_u32 s8, s26, s34
  s_addc_u32 s9, s27, 0
  s_and_b32 s9, s9, 0xffff
  s_mov_b32 s10, 0
  s_mov_b32 s11, 0x20000
  s_mov_b32 s10, s47
  s_lshl_b32 s34, s32, 2
  s_add_u32 s34, s34, s36
  s_mul_i32 s34, s34, 25600
  s_add_u32 s12, s4, s34
  s_addc_u32 s13, s5, 0
  s_add_u32 s12, s12, 10616832
  s_addc_u32 s13, s13, 0
  s_and_b32 s13, s13, 0xffff
  s_mov_b32 s14, 25600
  s_mov_b32 s15, 0x20000
  v_mul_u32_u24 v8, 57, v1
  v_lshrrev_b32 v8, 9, v8
  v_mul_u32_u24 v9, 9, v8
  v_sub_u32 v7, v1, v9
  v_mul_u32_u24 v2, 1152, v8
  v_lshl_add_u32 v2, v7, 4, v2
  v_mov_b32 v11, 8080
  v_mov_b32 v12, 9088
  s_add_u32 m0, s38, 0
  s_nop 0
  buffer_load_dwordx4 v2, s[8:11], 0 offen lds
  v_cmp_eq_u32 vcc, 8, v7
  v_add_u32 v7, 1, v7
  s_nop 0
  v_cndmask_b32 v8, v11, v12, vcc
  v_cndmask_b32 v7, v7, 0, vcc
  v_add_u32 v2, v2, v8
  s_add_u32 m0, s38, 1024
  s_nop 0
  buffer_load_dwordx4 v2, s[8:11], 0 offen lds
  v_cmp_eq_u32 vcc, 8, v7
  v_add_u32 v7, 1, v7
  s_nop 0
  v_cndmask_b32 v8, v11, v12, vcc
  v_cndmask_b32 v7, v7, 0, vcc
  v_add_u32 v2, v2, v8
  s_add_u32 m0, s38, 2048
  s_nop 0
  buffer_load_dwordx4 v2, s[8:11], 0 offen lds
  v_cmp_eq_u32 vcc, 8, v7
  v_add_u32 v7, 1, v7
  s_nop 0
  v_cndmask_b32 v8, v11, v12, vcc
  v_cndmask_b32 v7, v7, 0, vcc
  v_add_u32 v2, v2, v8
  s_add_u32 m0, s38, 3072
  s_nop 0
  buffer_load_dwordx4 v2, s[8:11], 0 offen lds
  v_cmp_eq_u32 vcc, 8, v7
  v_add_u32 v7, 1, v7
  s_nop 0
  v_cndmask_b32 v8, v11, v12, vcc
  v_cndmask_b32 v7, v7, 0, vcc
  v_add_u32 v2, v2, v8
  s_add_u32 m0, s38, 4096
  s_nop 0
  buffer_load_dwordx4 v2, s[8:11], 0 offen lds
  v_cmp_eq_u32 vcc, 8, v7
  v_add_u32 v7, 1, v7
  s_nop 0
  v_cndmask_b32 v8, v11, v12, vcc
  v_cndmask_b32 v7, v7, 0, vcc
  v_add_u32 v2, v2, v8
  s_add_u32 m0, s38, 5120
  s_nop 0
  buffer_load_dwordx4 v2, s[8:11], 0 offen lds
  v_cmp_eq_u32 vcc, 8, v7
  v_add_u32 v7, 1, v7
  s_nop 0
  v_cndmask_b32 v8, v11, v12, vcc
  v_cndmask_b32 v7, v7, 0, vcc
  v_add_u32 v2, v2, v8
  s_add_u32 m0, s38, 6144
  s_nop 0
  buffer_load_dwordx4 v2, s[8:11], 0 offen lds
  v_cmp_eq_u32 vcc, 8, v7
  v_add_u32 v7, 1, v7
  s_nop 0
  v_cndmask_b32 v8, v11, v12, vcc
  v_cndmask_b32 v7, v7, 0, vcc
  v_add_u32 v2, v2, v8
  s_add_u32 m0, s38, 7168
  s_nop 0
  buffer_load_dwordx4 v2, s[8:11], 0 offen lds
  v_cmp_eq_u32 vcc, 8, v7
  v_add_u32 v7, 1, v7
  s_nop 0
  v_cndmask_b32 v8, v11, v12, vcc
  v_cndmask_b32 v7, v7, 0, vcc
  v_add_u32 v2, v2, v8
  s_add_u32 m0, s38, 8192
  s_nop 0
  buffer_load_dwordx4 v2, s[8:11], 0 offen lds
  v_cmp_eq_u32 vcc, 8, v7
  v_add_u32 v7, 1, v7
  s_nop 0
  v_cndmask_b32 v8, v11, v12, vcc
  v_cndmask_b32 v7, v7, 0, vcc
  v_add_u32 v2, v2, v8
  s_add_u32 m0, s38, 9216
  s_nop 0
  buffer_load_dwordx4 v2, s[8:11], 0 offen lds
  v_cmp_eq_u32 vcc, 8, v7
  v_add_u32 v7, 1, v7
  s_nop 0
  v_cndmask_b32 v8, v11, v12, vcc
  v_cndmask_b32 v7, v7, 0, vcc
  v_add_u32 v2, v2, v8
  s_add_u32 m0, s38, 10240
  s_nop 0
  buffer_load_dwordx4 v2, s[8:11], 0 offen lds
  v_cmp_eq_u32 vcc, 8, v7
  v_add_u32 v7, 1, v7
  s_nop 0
  v_cndmask_b32 v8, v11, v12, vcc
  v_cndmask_b32 v7, v7, 0, vcc
  v_add_u32 v2, v2, v8
  s_add_u32 m0, s38, 11264
  s_nop 0
  buffer_load_dwordx4 v2, s[8:11], 0 offen lds
  v_cmp_eq_u32 vcc, 8, v7
  v_add_u32 v7, 1, v7
  s_nop 0
  v_cndmask_b32 v8, v11, v12, vcc
  v_cndmask_b32 v7, v7, 0, vcc
  v_add_u32 v2, v2, v8
  s_add_u32 m0, s38, 12288
  s_nop 0
  buffer_load_dwordx4 v2, s[8:11], 0 offen lds
  v_cmp_eq_u32 vcc, 8, v7
  v_add_u32 v7, 1, v7
  s_nop 0
  v_cndmask_b32 v8, v11, v12, vcc
  v_cndmask_b32 v7, v7, 0, vcc
  v_add_u32 v2, v2, v8
  s_add_u32 m0, s38, 13312
  s_nop 0
  buffer_load_dwordx4 v2, s[8:11], 0 offen lds
  v_cmp_eq_u32 vcc, 8, v7
  v_add_u32 v7, 1, v7
  s_nop 0
  v_cndmask_b32 v8, v11, v12, vcc
  v_cndmask_b32 v7, v7, 0, vcc
  v_add_u32 v2, v2, v8
  s_add_u32 m0, s38, 14336
  s_nop 0
  buffer_load_dwordx4 v2, s[8:11], 0 offen lds
  v_cmp_eq_u32 vcc, 8, v7
  v_add_u32 v7, 1, v7
  s_nop 0
  v_cndmask_b32 v8, v11, v12, vcc
  v_cndmask_b32 v7, v7, 0, vcc
  v_add_u32 v2, v2, v8
  s_add_u32 m0, s38, 15360
  s_nop 0
  buffer_load_dwordx4 v2, s[8:11], 0 offen lds
  v_cmp_eq_u32 vcc, 8, v7
  v_add_u32 v7, 1, v7
  s_nop 0
  v_cndmask_b32 v8, v11, v12, vcc
  v_cndmask_b32 v7, v7, 0, vcc
  v_add_u32 v2, v2, v8
  s_add_u32 m0, s38, 16384
  s_nop 0
  buffer_load_dwordx4 v2, s[8:11], 0 offen lds
  v_cmp_eq_u32 vcc, 8, v7
  v_add_u32 v7, 1, v7
  s_nop 0
  v_cndmask_b32 v8, v11, v12, vcc
  v_cndmask_b32 v7, v7, 0, vcc
  v_add_u32 v2, v2, v8
  s_add_u32 m0, s38, 17408
  s_nop 0
  buffer_load_dwordx4 v2, s[8:11], 0 offen lds
  v_cmp_eq_u32 vcc, 8, v7
  v_add_u32 v7, 1, v7
  s_nop 0
  v_cndmask_b32 v8, v11, v12, vcc
  v_cndmask_b32 v7, v7, 0, vcc
  v_add_u32 v2, v2, v8
  s_add_u32 m0, s38, 18432
  s_nop 0
  buffer_load_dwordx4 v2, s[8:11], 0 offen lds
  v_cmp_eq_u32 vcc, 8, v7
  v_add_u32 v7, 1, v7
  s_nop 0
  v_cndmask_b32 v8, v11, v12, vcc
  v_cndmask_b32 v7, v7, 0, vcc
  v_add_u32 v2, v2, v8
  s_add_u32 m0, s38, 19456
  s_nop 0
  buffer_load_dwordx4 v2, s[8:11], 0 offen lds
  v_cmp_eq_u32 vcc, 8, v7
  v_add_u32 v7, 1, v7
  s_nop 0
  v_cndmask_b32 v8, v11, v12, vcc
  v_cndmask_b32 v7, v7, 0, vcc
  v_add_u32 v2, v2, v8
  s_add_u32 m0, s38, 20480
  s_nop 0
  buffer_load_dwordx4 v2, s[8:11], 0 offen lds
  v_bfe_u32 v8, v1, 2, 2
  v_lshrrev_b32 v9, 4, v1
  v_lshl_add_u32 v11, v9, 2, v8
  v_mul_u32_u24 v11, 144, v11
  v_add_u32 v11, s38, v11
  v_lshrrev_b32 v12, 1, v9
  v_and_b32 v13, 2, v8
  v_add_u32 v12, v12, v13
  v_mul_u32_u24 v12, 36, v12
  v_and_b32 v13, 1, v9
  v_lshl_add_u32 v12, v13, 1, v12
  v_and_b32 v13, 1, v8
  v_add3_u32 v12, v12, v13, 16
  v_mul_u32_u24 v12, 144, v12
  v_add_u32 v12, s38, v12
  v_and_b32 v13, 3, v1
  v_lshl_add_u32 v3, v13, 4, v11
  v_lshl_add_u32 v4, v13, 3, v11
  v_lshl_add_u32 v5, v13, 4, v12
  v_lshl_add_u32 v6, v13, 3, v12
  s_waitcnt vmcnt(0)
  ds_read_b64_tr_b16 v[16:17], v3 offset:0
  ds_read_b64_tr_b16 v[18:19], v3 offset:2880
  s_mov_b32 s34, 0
  s_waitcnt lgkmcnt(0)
  buffer_store_dwordx4 v[16:19], v10, s[12:15], s34 offen offset:0 sc1
  ds_read_b64_tr_b16 v[20:21], v3 offset:8
  ds_read_b64_tr_b16 v[22:23], v3 offset:2888
  s_waitcnt lgkmcnt(0)
  buffer_store_dwordx4 v[20:23], v10, s[12:15], s34 offen offset:1024 sc1
  ds_read_b64_tr_b16 v[24:25], v3 offset:64
  ds_read_b64_tr_b16 v[26:27], v3 offset:2944
  s_waitcnt lgkmcnt(0)
  buffer_store_dwordx4 v[24:27], v10, s[12:15], s34 offen offset:2048 sc1
  ds_read_b64_tr_b16 v[28:29], v3 offset:72
  ds_read_b64_tr_b16 v[30:31], v3 offset:2952
  s_waitcnt lgkmcnt(0)
  buffer_store_dwordx4 v[28:31], v10, s[12:15], s34 offen offset:3072 sc1
  ds_read_b64_tr_b16 v[32:33], v4 offset:128
  ds_read_b64_tr_b16 v[34:35], v4 offset:3008
  s_mov_b32 s34, 4096
  s_waitcnt lgkmcnt(0)
  buffer_store_dwordx4 v[32:35], v10, s[12:15], s34 offen offset:0 sc1
  ds_read_b64_tr_b16 v[36:37], v3 offset:5184
  ds_read_b64_tr_b16 v[38:39], v3 offset:8064
  s_waitcnt lgkmcnt(0)
  buffer_store_dwordx4 v[36:39], v10, s[12:15], s34 offen offset:1024 sc1
  ds_read_b64_tr_b16 v[40:41], v3 offset:5192
  ds_read_b64_tr_b16 v[42:43], v3 offset:8072
  s_waitcnt lgkmcnt(0)
  buffer_store_dwordx4 v[40:43], v10, s[12:15], s34 offen offset:2048 sc1
  ds_read_b64_tr_b16 v[44:45], v3 offset:5248
  ds_read_b64_tr_b16 v[46:47], v3 offset:8128
  s_waitcnt lgkmcnt(0)
  buffer_store_dwordx4 v[44:47], v10, s[12:15], s34 offen offset:3072 sc1
  ds_read_b64_tr_b16 v[16:17], v3 offset:5256
  ds_read_b64_tr_b16 v[18:19], v3 offset:8136
  s_mov_b32 s34, 8192
  s_waitcnt lgkmcnt(0)
  buffer_store_dwordx4 v[16:19], v10, s[12:15], s34 offen offset:0 sc1
  ds_read_b64_tr_b16 v[20:21], v4 offset:5312
  ds_read_b64_tr_b16 v[22:23], v4 offset:8192
  s_waitcnt lgkmcnt(0)
  buffer_store_dwordx4 v[20:23], v10, s[12:15], s34 offen offset:1024 sc1
  ds_read_b64_tr_b16 v[24:25], v3 offset:10368
  ds_read_b64_tr_b16 v[26:27], v3 offset:13248
  s_waitcnt lgkmcnt(0)
  buffer_store_dwordx4 v[24:27], v10, s[12:15], s34 offen offset:2048 sc1
  ds_read_b64_tr_b16 v[28:29], v3 offset:10376
  ds_read_b64_tr_b16 v[30:31], v3 offset:13256
  s_waitcnt lgkmcnt(0)
  buffer_store_dwordx4 v[28:31], v10, s[12:15], s34 offen offset:3072 sc1
  ds_read_b64_tr_b16 v[32:33], v3 offset:10432
  ds_read_b64_tr_b16 v[34:35], v3 offset:13312
  s_mov_b32 s34, 12288
  s_waitcnt lgkmcnt(0)
  buffer_store_dwordx4 v[32:35], v10, s[12:15], s34 offen offset:0 sc1
  ds_read_b64_tr_b16 v[36:37], v3 offset:10440
  ds_read_b64_tr_b16 v[38:39], v3 offset:13320
  s_waitcnt lgkmcnt(0)
  buffer_store_dwordx4 v[36:39], v10, s[12:15], s34 offen offset:1024 sc1
  ds_read_b64_tr_b16 v[40:41], v4 offset:10496
  ds_read_b64_tr_b16 v[42:43], v4 offset:13376
  s_waitcnt lgkmcnt(0)
  buffer_store_dwordx4 v[40:43], v10, s[12:15], s34 offen offset:2048 sc1
  ds_read_b64_tr_b16 v[44:45], v3 offset:15552
  ds_read_b64_tr_b16 v[46:47], v3 offset:18432
  s_waitcnt lgkmcnt(0)
  buffer_store_dwordx4 v[44:47], v10, s[12:15], s34 offen offset:3072 sc1
  ds_read_b64_tr_b16 v[16:17], v3 offset:15560
  ds_read_b64_tr_b16 v[18:19], v3 offset:18440
  s_mov_b32 s34, 16384
  s_waitcnt lgkmcnt(0)
  buffer_store_dwordx4 v[16:19], v10, s[12:15], s34 offen offset:0 sc1
  ds_read_b64_tr_b16 v[20:21], v3 offset:15616
  ds_read_b64_tr_b16 v[22:23], v3 offset:18496
  s_waitcnt lgkmcnt(0)
  buffer_store_dwordx4 v[20:23], v10, s[12:15], s34 offen offset:1024 sc1
  ds_read_b64_tr_b16 v[24:25], v3 offset:15624
  ds_read_b64_tr_b16 v[26:27], v3 offset:18504
  s_waitcnt lgkmcnt(0)
  buffer_store_dwordx4 v[24:27], v10, s[12:15], s34 offen offset:2048 sc1
  ds_read_b64_tr_b16 v[28:29], v4 offset:15680
  ds_read_b64_tr_b16 v[30:31], v4 offset:18560
  s_waitcnt lgkmcnt(0)
  buffer_store_dwordx4 v[28:31], v10, s[12:15], s34 offen offset:3072 sc1
  ds_read_b64_tr_b16 v[32:33], v5 offset:0
  v_mov_b32 v34, 0
  v_mov_b32 v35, 0
  s_mov_b32 s34, 20480
  s_waitcnt lgkmcnt(0)
  buffer_store_dwordx4 v[32:35], v10, s[12:15], s34 offen offset:0 sc1
  ds_read_b64_tr_b16 v[36:37], v5 offset:8
  v_mov_b32 v38, 0
  v_mov_b32 v39, 0
  s_waitcnt lgkmcnt(0)
  buffer_store_dwordx4 v[36:39], v10, s[12:15], s34 offen offset:1024 sc1
  ds_read_b64_tr_b16 v[40:41], v5 offset:64
  v_mov_b32 v42, 0
  v_mov_b32 v43, 0
  s_waitcnt lgkmcnt(0)
  buffer_store_dwordx4 v[40:43], v10, s[12:15], s34 offen offset:2048 sc1
  ds_read_b64_tr_b16 v[44:45], v5 offset:72
  v_mov_b32 v46, 0
  v_mov_b32 v47, 0
  s_waitcnt lgkmcnt(0)
  buffer_store_dwordx4 v[44:47], v10, s[12:15], s34 offen offset:3072 sc1
  ds_read_b64_tr_b16 v[16:17], v6 offset:128
  v_mov_b32 v18, 0
  v_mov_b32 v19, 0
  s_mov_b32 s34, 24576
  s_waitcnt lgkmcnt(0)
  buffer_store_dwordx4 v[16:19], v10, s[12:15], s34 offen offset:0 sc1
  s_endpgm
L_sw_zero:
  s_mul_i32 s34, s32, 5632
  s_add_u32 s12, s4, s34
  s_addc_u32 s13, s5, 0
  s_add_u32 s12, s12, 11513856
  s_addc_u32 s13, s13, 0
  s_and_b32 s13, s13, 0xffff
  s_mov_b32 s14, 5632
  s_mov_b32 s15, 0x20000
  s_mov_b32 s16, s28
  s_mov_b32 s17, s29
  s_and_b32 s17, s17, 0xffff
  s_mov_b32 s18, 256
  s_mov_b32 s19, 0x20000
  v_mov_b32 v16, 0
  v_mov_b32 v17, 0
  v_mov_b32 v18, 0
  v_mov_b32 v19, 0
  buffer_store_dwordx4 v[16:19], v10, s[12:15], 0 offen offset:0 sc0 sc1
  buffer_store_dwordx4 v[16:19], v10, s[12:15], 0 offen offset:1024 sc0 sc1
  buffer_store_dwordx4 v[16:19], v10, s[12:15], 0 offen offset:2048 sc0 sc1
  buffer_store_dwordx4 v[16:19], v10, s[12:15], 0 offen offset:3072 sc0 sc1
  v_add_u32 v10, 4096, v10
  buffer_store_dwordx4 v[16:19], v10, s[12:15], 0 offen offset:0 sc0 sc1
  buffer_store_dwordx4 v[16:19], v10, s[12:15], 0 offen offset:1024 sc0 sc1
  s_lshl_b32 s34, s32, 2
  v_mov_b32 v8, s34
  v_mov_b32 v9, 1
  s_barrier
  s_waitcnt vmcnt(0)
  s_mul_i32 s35, s32, 1664
  s_add_u32 s8, s4, s35
  s_addc_u32 s9, s5, 0
  s_add_u32 s8, s8, 35282944
  s_addc_u32 s9, s9, 0
  s_and_b32 s9, s9, 0xffff
  s_mov_b32 s10, 1664
  s_mov_b32 s11, 0x20000
  v_lshlrev_b32 v11, 4, v1
  buffer_store_dwordx4 v[16:19], v11, s[8:11], 0 offen sc1
  buffer_store_dwordx4 v[16:19], v11, s[8:11], 0 offen offset:1024 sc1
  buffer_store_dword v9, v8, s[16:19], 0 offen sc0 sc1
  s_endpgm
L_k1_end:
  s_endpgm
.text
.globl attn_kernel
.p2align 8
.type attn_kernel,@function
attn_kernel:
  s_cmp_ge_u32 s2, 256
  s_cbranch_scc1 L_kf_end
  s_load_dwordx2 s[8:9], s[0:1], 80
  s_load_dwordx2 s[12:13], s[0:1], 0
  s_load_dwordx2 s[16:17], s[0:1], 48
  s_load_dwordx2 s[20:21], s[0:1], 40
  s_load_dwordx2 s[24:25], s[0:1], 56
  s_load_dwordx2 s[28:29], s[0:1], 64
  v_lshrrev_b32 v5, 6, v0
  v_and_b32 v1, 63, v0
  v_readfirstlane_b32 s32, v5
  s_mov_b32 s10, 35296256
  s_mov_b32 s11, 0x20000
  s_mov_b32 s14, 2359296
  s_mov_b32 s15, 0x20000
  s_mov_b32 s18, 5308416
  s_mov_b32 s19, 0x20000
  s_mov_b32 s22, 9216
  s_mov_b32 s23, 0x20000
  s_mov_b32 s26, 1152
  s_mov_b32 s27, 0x20000
  s_mov_b32 s30, 2359296
  s_mov_b32 s31, 0x20000
  s_and_b32 s33, s2, 1
  s_lshl_b32 s33, s33, 2
  s_bfe_u32 s35, s2, 0x20003
  s_add_u32 s33, s33, s35
  s_bfe_u32 s34, s2, 0x20001
  s_mul_i32 s34, s34, 8
  s_lshr_b32 s35, s2, 5
  s_add_u32 s34, s34, s35
  v_lshlrev_b32 v4, 4, v1
  v_lshlrev_b32 v21, 3, v1
  s_mul_i32 s38, s32, 11264
  s_add_u32 s38, s38, 11513856
  s_mul_i32 s37, s32, 18432
  s_add_u32 s37, s37, 81920
  s_lshl_b32 s39, s34, 4
  s_add_u32 s39, s39, s32
  s_mul_i32 s39, s39, 4608
  s_add_u32 s39, s39, 11558912
  s_lshl_b32 s3, s34, 2
  s_add_u32 s3, s3, s32
  s_mul_i32 s64, s3, 57
  s_lshr_b32 s64, s64, 9
  s_mul_i32 s65, s64, 9
  s_sub_u32 s65, s3, s65
  s_add_u32 s64, s64, 4
  s_getpc_b64 s[4:5]
  L_kf_pc:
  s_add_u32 s4, s4, L_kf_tab-L_kf_pc
  s_addc_u32 s5, s5, 0
  s_lshl_b32 s35, s65, 4
  s_lshl_b32 s36, s64, 2
  s_add_u32 s36, s36, 144
  s_waitcnt lgkmcnt(0)
  s_and_b32 s9, s9, 0xffff
  s_load_dwordx4 s[88:91], s[4:5], s35
  s_load_dword s48, s[4:5], s36
  s_add_u32 m0, s37, 0
  s_add_u32 s58, s38, 0
  buffer_load_dwordx4 v4, s[8:11], s58 offen offset:0 lds
  buffer_load_dwordx4 v4, s[8:11], s58 offen offset:1024 lds
  buffer_load_dwordx4 v4, s[8:11], s58 offen offset:2048 lds
  buffer_load_dwordx4 v4, s[8:11], s58 offen offset:3072 lds
  s_add_u32 m0, s37, 4096
  s_add_u32 s58, s38, 4096
  buffer_load_dwordx4 v4, s[8:11], s58 offen offset:0 lds
  v_and_b32 v2, 15, v0
  v_bfe_u32 v3, v0, 4, 2
  v_lshrrev_b32 v5, 3, v2
  v_lshlrev_b32 v5, 1, v5
  v_xor_b32 v5, v5, v3
  v_lshlrev_b32 v5, 4, v5
  v_lshl_add_u32 v9, v2, 6, v5
  v_add_u32 v9, s37, v9
  v_lshlrev_b32 v10, 3, v2
  v_add_u32 v10, s37, v10
  s_add_u32 s35, s37, 1376
  v_mov_b32 v218, s35
  buffer_load_dwordx4 v4, s[8:11], s58 offen offset:1024 lds
  v_and_b32 v5, 3, v2
  v_lshrrev_b32 v6, 2, v2
  s_add_u32 s35, s37, 1024
  v_lshlrev_b32 v219, 6, v5
  v_lshl_add_u32 v219, v3, 4, v219
  v_add_u32 v219, s35, v219
  s_add_u32 s35, s37, 1344
  v_lshlrev_b32 v220, 3, v5
  v_add_u32 v220, s35, v220
  v_cmp_eq_u32 s[60:61], 0, v5
  v_cmp_ne_u32 s[62:63], 3, v5
  buffer_load_dwordx4 v4, s[8:11], s58 offen offset:2048 lds
  v_cmp_eq_u32 vcc, 0, v6
  v_cmp_eq_u32 s[40:41], 0, v3
  v_mov_b32 v32, 0x358637bd
  s_and_b64 vcc, vcc, s[62:63]
  s_or_b64 vcc, vcc, s[60:61]
  v_cndmask_b32 v11, v218, v219, vcc
  v_cndmask_b32 v15, v218, v220, vcc
  v_cmp_eq_u32 vcc, 1, v6
  v_cmp_eq_u32 s[42:43], 1, v3
  v_mov_b32 v33, 0
  s_and_b64 vcc, vcc, s[62:63]
  buffer_load_dwordx4 v4, s[8:11], s58 offen offset:3072 lds
  s_or_b64 vcc, vcc, s[60:61]
  v_cndmask_b32 v12, v218, v219, vcc
  v_cndmask_b32 v16, v218, v220, vcc
  v_cmp_eq_u32 vcc, 2, v6
  v_cmp_eq_u32 s[44:45], 2, v3
  v_mov_b32 v34, 0
  s_and_b64 vcc, vcc, s[62:63]
  s_or_b64 vcc, vcc, s[60:61]
  v_cndmask_b32 v13, v218, v219, vcc
  v_cndmask_b32 v17, v218, v220, vcc
  v_cmp_eq_u32 vcc, 3, v6
  s_add_u32 m0, s37, 8192
  s_add_u32 s58, s38, 8192
  buffer_load_dwordx4 v4, s[8:11], s58 offen offset:0 lds
  v_cmp_eq_u32 s[46:47], 3, v3
  v_mov_b32 v35, 0
  s_and_b64 vcc, vcc, s[62:63]
  s_or_b64 vcc, vcc, s[60:61]
  v_cndmask_b32 v14, v218, v219, vcc
  v_cndmask_b32 v18, v218, v220, vcc
  v_mov_b32 v166, 0
  v_mov_b32 v167, 0
  v_mov_b32 v186, 0
  buffer_load_dwordx4 v4, s[8:11], s58 offen offset:1024 lds
  v_mov_b32 v187, 0
  v_mov_b32 v206, 0
  v_mov_b32 v207, 0
  v_mov_b32 v63, 0
  v_mov_b32 v67, 0
  v_mov_b32 v68, 0
  v_mov_b32 v72, 0
  v_mov_b32 v79, 0
  v_mov_b32 v83, 0
  v_mov_b32 v84, 0
  v_mov_b32 v88, 0
  buffer_load_dwordx4 v4, s[8:11], s58 offen offset:2048 lds
  v_mov_b32 v95, 0
  v_mov_b32 v99, 0
  v_mov_b32 v100, 0
  v_mov_b32 v104, 0
  v_mov_b32 v111, 0
  v_mov_b32 v115, 0
  v_mov_b32 v116, 0
  v_mov_b32 v120, 0
  s_lshl_b32 s54, s33, 2
  s_add_u32 s54, s54, s32
  s_mul_i32 s54, s54, 25600
  s_add_u32 s58, s39, 4096
  buffer_load_dwordx2 a[0:1], v21, s[8:11], s58 offen
  s_sub_u32 s58, s58, 4096
  s_add_u32 s54, s54, 10616832
  s_and_b32 s13, s13, 0xffff
  s_and_b32 s17, s17, 0xffff
  s_and_b32 s21, s21, 0xffff
  s_and_b32 s25, s25, 0xffff
  s_and_b32 s29, s29, 0xffff
  s_mul_i32 s55, s3, 18432
  s_add_u32 s55, s55, 13918208
  s_mul_i32 s35, s33, 576
  buffer_load_dwordx4 a[20:23], v4, s[8:11], s58 offen offset:3072
  s_lshl_b32 s36, s64, 5
  s_add_u32 s35, s35, s36
  s_mul_i32 s35, s35, 1152
  s_lshl_b32 s36, s65, 7
  s_add_u32 s56, s35, s36
  s_mul_i32 s35, s33, 1327104
  s_waitcnt lgkmcnt(0)
  s_add_u32 s35, s35, s48
  s_cmp_lt_u32 s3, 126
  s_cselect_b32 s35, s35, 0x7fdffff0
  s_cselect_b32 s18, s18, 0
  s_add_u32 s88, s88, s35
  buffer_load_dwordx4 a[2:5], v4, s[8:11], s58 offen offset:0
  s_add_u32 s89, s89, s35
  s_add_u32 s90, s90, s35
  s_add_u32 s91, s91, s35
  s_add_u32 s57, s37, 11264
  v_lshrrev_b32 v5, 3, v1
  v_mul_u32_u24 v24, 1152, v5
  v_bfe_u32 v5, v1, 4, 1
  v_lshlrev_b32 v5, 2, v5
  v_and_b32 v6, 7, v1
  v_xor_b32 v5, v5, v6
  v_lshl_add_u32 v24, v5, 4, v24
  buffer_load_dwordx4 a[8:11], v4, s[8:11], s58 offen offset:1024
  v_bfe_u32 v5, v1, 2, 2
  v_lshrrev_b32 v6, 4, v1
  v_lshl_add_u32 v222, v6, 2, v5
  v_lshlrev_b32 v222, 7, v222
  v_add_u32 v222, s57, v222
  v_lshrrev_b32 v5, 1, v5
  v_lshlrev_b32 v5, 2, v5
  v_and_b32 v6, 3, v1
  v_xor_b32 v5, v5, v6
  v_xor_b32 v6, 0, v5
  v_lshl_add_u32 v25, v6, 4, v222
  buffer_load_dwordx4 a[14:17], v4, s[8:11], s58 offen offset:2048
  v_xor_b32 v6, 0, v5
  v_lshl_add_u32 v26, v6, 4, v222
  v_add_u32 v26, 8, v26
  v_xor_b32 v6, 4, v5
  v_lshl_add_u32 v27, v6, 4, v222
  v_xor_b32 v6, 4, v5
  v_lshl_add_u32 v28, v6, 4, v222
  v_add_u32 v28, 8, v28
  v_lshrrev_b32 v5, 3, v1
  v_lshlrev_b32 v5, 9, v5
  v_and_b32 v29, 7, v1
  s_add_u32 s58, s39, 22528
  buffer_load_dwordx2 a[26:27], v21, s[8:11], s58 offen
  s_sub_u32 s58, s58, 4096
  v_lshl_add_u32 v29, v29, 4, v5
  v_mov_b32 v222, 2147483632
  v_mov_b32 v8, 1
  s_lshl_b32 s49, s34, 7
  s_add_u32 s49, s49, 35282944
  s_add_u32 s50, s49, 4096
  s_lshl_b32 s51, s33, 7
  s_add_u32 s51, s51, 35291136
  s_lshl_b32 s35, s3, 4
  buffer_load_dwordx4 a[46:49], v4, s[8:11], s58 offen offset:3072
  v_add_u32 v5, s35, v2
  v_mul_u32_u24 v19, 1152, v5
  s_mul_i32 s36, s33, 144
  v_add_u32 v19, s36, v19
  v_lshl_add_u32 v20, v3, 3, v19
  v_cmp_gt_u32 s[52:53], 2, v3
  v_add_u32 v20, 128, v20
  v_lshl_add_u32 v19, v3, 4, v19
  v_cndmask_b32 v20, v222, v20, s[52:53]
  s_lshl_b32 s35, s34, 12
  s_lshl_b32 s36, s33, 9
  buffer_load_dwordx4 a[28:31], v4, s[8:11], s58 offen offset:0
  s_add_u32 s35, s35, s36
  s_lshl_b32 s36, s32, 7
  s_add_u32 s35, s35, s36
  s_add_u32 s35, s35, 16277504
  v_lshlrev_b32 v5, 3, v2
  v_add_u32 v5, s35, v5
  v_cndmask_b32 v30, v222, v5, s[40:41]
  s_mul_i32 s35, s33, 2304
  v_lshlrev_b32 v22, 8, v3
  v_lshl_add_u32 v22, v2, 4, v22
  v_add_u32 v22, s35, v22
  buffer_load_dwordx4 a[34:37], v4, s[8:11], s58 offen offset:1024
  v_lshlrev_b32 v23, 4, v2
  v_lshl_add_u32 v23, v3, 3, v23
  s_add_u32 s35, s35, 2048
  v_add_u32 v23, s35, v23
  v_cndmask_b32 v23, v222, v23, s[52:53]
  s_waitcnt vmcnt(18)
  ds_read_b128 v[36:39], v9 offset:0
  ds_read_b128 v[40:43], v11 offset:0
  ds_read_b64 v[44:45], v10 offset:1216
  ds_read_b64 v[46:47], v15 offset:0
  s_waitcnt vmcnt(17)
  ds_read_b128 v[48:51], v9 offset:1408
  ds_read_b128 v[52:55], v12 offset:1408
  ds_read_b64 v[56:57], v10 offset:2624
  ds_read_b64 v[58:59], v16 offset:1408
  s_waitcnt lgkmcnt(4)
  v_cvt_pk_bf16_f32 v5, v46, v47
  v_cvt_pk_bf16_f32 v64, v40, v41
  v_cndmask_b32 v66, 0, v5, s[40:41]
  v_cvt_pk_bf16_f32 v65, v42, v43
  v_cvt_pk_bf16_f32 v5, v44, v45
  v_cvt_pk_bf16_f32 v60, v36, v37
  v_cndmask_b32 v62, 0, v5, s[40:41]
  v_cvt_pk_bf16_f32 v61, v38, v39
  buffer_load_dwordx4 a[40:43], v4, s[8:11], s58 offen offset:2048
  s_waitcnt vmcnt(16)
  ds_read_b128 v[36:39], v9 offset:2816
  ds_read_b128 v[40:43], v13 offset:2816
  ds_read_b64 v[44:45], v10 offset:4032
  ds_read_b64 v[46:47], v17 offset:2816
  s_waitcnt lgkmcnt(4)
  v_cvt_pk_bf16_f32 v5, v58, v59
  v_cvt_pk_bf16_f32 v74, v52, v53
  v_cndmask_b32 v73, 0, v5, s[40:41]
  v_cvt_pk_bf16_f32 v75, v54, v55
  v_cvt_pk_bf16_f32 v5, v56, v57
  v_cvt_pk_bf16_f32 v70, v48, v49
  v_cndmask_b32 v69, 0, v5, s[40:41]
  v_cvt_pk_bf16_f32 v71, v50, v51
  s_waitcnt vmcnt(15)
  ds_read_b128 v[48:51], v9 offset:4224
  ds_read_b128 v[52:55], v14 offset:4224
  ds_read_b64 v[56:57], v10 offset:5440
  s_add_u32 s58, s39, 40960
  buffer_load_dwordx2 a[52:53], v21, s[8:11], s58 offen
  s_sub_u32 s58, s58, 4096
  ds_read_b64 v[58:59], v18 offset:4224
  s_waitcnt vmcnt(10)
  v_accvgpr_mov_b32 a24, a0
  v_accvgpr_mov_b32 a25, a1
  v_accvgpr_mov_b32 a6, a0
  v_accvgpr_mov_b32 a7, a1
  v_accvgpr_mov_b32 a12, a0
  v_accvgpr_mov_b32 a13, a1
  v_accvgpr_mov_b32 a18, a0
  v_accvgpr_mov_b32 a19, a1
  s_waitcnt vmcnt(9)
  v_mfma_f32_16x16x32_bf16 v[128:131], v[64:67], a[22:25], v[32:35]
  v_mfma_f32_16x16x32_bf16 v[124:127], v[60:63], a[22:25], 0
  buffer_load_dwordx4 a[72:75], v4, s[8:11], s58 offen offset:3072
  s_waitcnt vmcnt(9)
  v_mfma_f32_16x16x32_bf16 v[136:139], v[72:75], a[0:3], v[32:35]
  v_mfma_f32_16x16x32_bf16 v[132:135], v[68:71], a[0:3], 0
  s_waitcnt lgkmcnt(4)
  v_cvt_pk_bf16_f32 v5, v46, v47
  v_cvt_pk_bf16_f32 v80, v40, v41
  v_cndmask_b32 v82, 0, v5, s[42:43]
  v_cvt_pk_bf16_f32 v81, v42, v43
  v_cvt_pk_bf16_f32 v5, v44, v45
  v_cvt_pk_bf16_f32 v76, v36, v37
  v_cndmask_b32 v78, 0, v5, s[42:43]
  v_cvt_pk_bf16_f32 v77, v38, v39
  ds_read_b128 v[36:39], v9 offset:5632
  ds_read_b128 v[40:43], v11 offset:5632
  ds_read_b64 v[44:45], v10 offset:6848
  buffer_load_dwordx4 a[54:57], v4, s[8:11], s58 offen offset:0
  ds_read_b64 v[46:47], v15 offset:5632
  v_rcp_f32 v128, v128
  v_mfma_f32_16x16x32_bf16 v[144:147], v[80:83], a[4:7], v[32:35]
  v_mul_f32 v124, v124, v128
  v_mfma_f32_16x16x32_bf16 v[140:143], v[76:79], a[4:7], 0
  v_mul_f32 v125, v125, v128
  v_mul_f32 v126, v126, v128
  v_mul_f32 v127, v127, v128
  v_mul_f32 v218, v129, v128
  v_mul_f32 v219, v130, v128
  v_cvt_pk_bf16_f32 v148, v124, v125
  v_cvt_pk_bf16_f32 v149, v126, v127
  buffer_load_dwordx4 a[60:63], v4, s[8:11], s58 offen offset:1024
  s_waitcnt lgkmcnt(4)
  v_cvt_pk_bf16_f32 v5, v58, v59
  v_cvt_pk_bf16_f32 v90, v52, v53
  v_cndmask_b32 v89, 0, v5, s[42:43]
  v_cvt_pk_bf16_f32 v91, v54, v55
  v_cvt_pk_bf16_f32 v5, v56, v57
  v_cvt_pk_bf16_f32 v86, v48, v49
  v_cndmask_b32 v85, 0, v5, s[42:43]
  v_cvt_pk_bf16_f32 v87, v50, v51
  ds_read_b128 v[48:51], v9 offset:7040
  ds_read_b128 v[52:55], v12 offset:7040
  ds_read_b64 v[56:57], v10 offset:8256
  ds_read_b64 v[58:59], v16 offset:7040
  v_rcp_f32 v136, v136
  s_waitcnt vmcnt(10)
  v_mfma_f32_16x16x32_bf16 v[128:131], v[88:91], a[6:9], v[32:35]
  buffer_load_dwordx4 a[66:69], v4, s[8:11], s58 offen offset:2048
  v_mul_f32 v132, v132, v136
  v_mfma_f32_16x16x32_bf16 v[124:127], v[84:87], a[6:9], 0
  v_mul_f32 v133, v133, v136
  v_mul_f32 v134, v134, v136
  v_mul_f32 v135, v135, v136
  v_fmac_f32 v218, v137, v136
  v_fmac_f32 v219, v138, v136
  v_cvt_pk_bf16_f32 v150, v132, v133
  v_cvt_pk_bf16_f32 v151, v134, v135
  s_waitcnt lgkmcnt(4)
  v_cvt_pk_bf16_f32 v5, v46, v47
  v_cvt_pk_bf16_f32 v96, v40, v41
  v_cndmask_b32 v98, 0, v5, s[44:45]
  v_cvt_pk_bf16_f32 v97, v42, v43
  v_cvt_pk_bf16_f32 v5, v44, v45
  s_add_u32 s58, s54, 0
  buffer_load_dwordx4 a[104:107], v4, s[8:11], s58 offen offset:0
  v_cvt_pk_bf16_f32 v92, v36, v37
  v_cndmask_b32 v94, 0, v5, s[44:45]
  v_cvt_pk_bf16_f32 v93, v38, v39
  ds_read_b128 v[36:39], v9 offset:8448
  ds_read_b128 v[40:43], v13 offset:8448
  ds_read_b64 v[44:45], v10 offset:9664
  ds_read_b64 v[46:47], v17 offset:8448
  v_rcp_f32 v144, v144
  v_mfma_f32_16x16x32_bf16 v[136:139], v[96:99], a[10:13], v[32:35]
  v_mul_f32 v140, v140, v144
  v_mfma_f32_16x16x32_bf16 v[132:135], v[92:95], a[10:13], 0
  buffer_load_dwordx4 a[108:111], v4, s[8:11], s58 offen offset:1024
  v_mul_f32 v141, v141, v144
  v_mul_f32 v142, v142, v144
  v_mul_f32 v143, v143, v144
  v_fmac_f32 v218, v145, v144
  v_fmac_f32 v219, v146, v144
  v_cvt_pk_bf16_f32 v152, v140, v141
  v_cvt_pk_bf16_f32 v153, v142, v143
  s_waitcnt lgkmcnt(4)
  v_cvt_pk_bf16_f32 v5, v58, v59
  v_cvt_pk_bf16_f32 v106, v52, v53
  v_cndmask_b32 v105, 0, v5, s[44:45]
  v_cvt_pk_bf16_f32 v107, v54, v55
  v_cvt_pk_bf16_f32 v5, v56, v57
  v_cvt_pk_bf16_f32 v102, v48, v49
  v_cndmask_b32 v101, 0, v5, s[44:45]
  v_cvt_pk_bf16_f32 v103, v50, v51
  buffer_load_dwordx4 a[112:115], v4, s[8:11], s58 offen offset:2048
  ds_read_b128 v[48:51], v9 offset:9856
  ds_read_b128 v[52:55], v14 offset:9856
  ds_read_b64 v[56:57], v10 offset:11072
  ds_read_b64 v[58:59], v18 offset:9856
  v_rcp_f32 v128, v128
  s_waitcnt vmcnt(13)
  v_mfma_f32_16x16x32_bf16 v[144:147], v[104:107], a[12:15], v[32:35]
  v_mul_f32 v124, v124, v128
  v_mfma_f32_16x16x32_bf16 v[140:143], v[100:103], a[12:15], 0
  v_mul_f32 v125, v125, v128
  v_mul_f32 v126, v126, v128
  v_mul_f32 v127, v127, v128
  v_fmac_f32 v218, v129, v128
  buffer_load_dwordx4 a[116:119], v4, s[8:11], s58 offen offset:3072
  v_fmac_f32 v219, v130, v128
  v_cvt_pk_bf16_f32 v154, v124, v125
  v_cvt_pk_bf16_f32 v155, v126, v127
  v_cvt_pk_bf16_f32 v164, v218, v219
  s_waitcnt lgkmcnt(4)
  v_cvt_pk_bf16_f32 v5, v46, v47
  v_cvt_pk_bf16_f32 v112, v40, v41
  v_cndmask_b32 v114, 0, v5, s[46:47]
  v_cvt_pk_bf16_f32 v113, v42, v43
  v_cvt_pk_bf16_f32 v5, v44, v45
  v_cvt_pk_bf16_f32 v108, v36, v37
  v_cndmask_b32 v110, 0, v5, s[46:47]
  v_cvt_pk_bf16_f32 v109, v38, v39
  v_rcp_f32 v136, v136
  v_mfma_f32_16x16x32_bf16 v[128:131], v[112:115], a[16:19], v[32:35]
  s_add_u32 s58, s54, 4096
  buffer_load_dwordx4 a[120:123], v4, s[8:11], s58 offen offset:0
  v_mul_f32 v132, v132, v136
  v_mfma_f32_16x16x32_bf16 v[124:127], v[108:111], a[16:19], 0
  v_mul_f32 v133, v133, v136
  v_mul_f32 v134, v134, v136
  v_mul_f32 v135, v135, v136
  v_mul_f32 v220, v137, v136
  v_mul_f32 v221, v138, v136
  v_cvt_pk_bf16_f32 v156, v132, v133
  v_cvt_pk_bf16_f32 v157, v134, v135
  s_waitcnt lgkmcnt(0)
  v_cvt_pk_bf16_f32 v5, v58, v59
  v_cvt_pk_bf16_f32 v122, v52, v53
  v_cndmask_b32 v121, 0, v5, s[46:47]
  v_cvt_pk_bf16_f32 v123, v54, v55
  buffer_load_dwordx4 a[124:127], v4, s[8:11], s58 offen offset:1024
  v_cvt_pk_bf16_f32 v5, v56, v57
  v_cvt_pk_bf16_f32 v118, v48, v49
  v_cndmask_b32 v117, 0, v5, s[46:47]
  v_cvt_pk_bf16_f32 v119, v50, v51
  v_rcp_f32 v144, v144
  v_mfma_f32_16x16x32_bf16 v[136:139], v[120:123], a[18:21], v[32:35]
  v_mul_f32 v140, v140, v144
  v_mfma_f32_16x16x32_bf16 v[132:135], v[116:119], a[18:21], 0
  v_mul_f32 v141, v141, v144
  v_mul_f32 v142, v142, v144
  v_mul_f32 v143, v143, v144
  v_fmac_f32 v220, v145, v144
  buffer_load_dwordx4 a[128:131], v4, s[8:11], s58 offen offset:2048
  v_fmac_f32 v221, v146, v144
  v_cvt_pk_bf16_f32 v158, v140, v141
  v_cvt_pk_bf16_f32 v159, v142, v143
  v_rcp_f32 v128, v128
  s_waitcnt vmcnt(16)
  v_accvgpr_mov_b32 a50, a26
  v_mul_f32 v124, v124, v128
  v_accvgpr_mov_b32 a51, a27
  v_accvgpr_mov_b32 a32, a26
  v_mul_f32 v125, v125, v128
  v_accvgpr_mov_b32 a33, a27
  v_mul_f32 v126, v126, v128
  v_accvgpr_mov_b32 a38, a26
  v_mul_f32 v127, v127, v128
  v_accvgpr_mov_b32 a39, a27
  buffer_load_dwordx4 a[132:135], v4, s[8:11], s58 offen offset:3072
  v_fmac_f32 v220, v129, v128
  v_accvgpr_mov_b32 a44, a26
  v_fmac_f32 v221, v130, v128
  v_accvgpr_mov_b32 a45, a27
  v_cvt_pk_bf16_f32 v160, v124, v125
  s_waitcnt vmcnt(16)
  v_mfma_f32_16x16x32_bf16 v[144:147], v[64:67], a[48:51], v[32:35]
  v_cvt_pk_bf16_f32 v161, v126, v127
  v_mfma_f32_16x16x32_bf16 v[140:143], v[60:63], a[48:51], 0
  v_rcp_f32 v136, v136
  s_waitcnt vmcnt(15)
  v_mfma_f32_16x16x32_bf16 v[128:131], v[72:75], a[26:29], v[32:35]
  v_mul_f32 v132, v132, v136
  s_add_u32 s58, s54, 8192
  buffer_load_dwordx4 a[136:139], v4, s[8:11], s58 offen offset:0
  v_mfma_f32_16x16x32_bf16 v[124:127], v[68:71], a[26:29], 0
  v_mul_f32 v133, v133, v136
  v_mul_f32 v134, v134, v136
  v_mul_f32 v135, v135, v136
  v_fmac_f32 v220, v137, v136
  v_fmac_f32 v221, v138, v136
  v_cvt_pk_bf16_f32 v162, v132, v133
  v_cvt_pk_bf16_f32 v163, v134, v135
  v_cvt_pk_bf16_f32 v165, v220, v221
  v_rcp_f32 v144, v144
  v_mfma_f32_16x16x32_bf16 v[136:139], v[80:83], a[30:33], v[32:35]
  buffer_load_dwordx4 a[140:143], v4, s[8:11], s58 offen offset:1024
  v_mul_f32 v140, v140, v144
  v_mfma_f32_16x16x32_bf16 v[132:135], v[76:79], a[30:33], 0
  v_mul_f32 v141, v141, v144
  v_mul_f32 v142, v142, v144
  v_mul_f32 v143, v143, v144
  v_mul_f32 v218, v145, v144
  v_mul_f32 v219, v146, v144
  v_cvt_pk_bf16_f32 v168, v140, v141
  v_cvt_pk_bf16_f32 v169, v142, v143
  s_mul_i32 s60, s32, 5120
  s_add_u32 s61, s60, 0
  v_add_u32 v11, s61, v4
  s_add_u32 s61, s60, 20480
  v_add_u32 v12, s61, v4
  s_add_u32 s58, s39, 59392
  buffer_load_dwordx2 a[78:79], v21, s[8:11], s58 offen
  s_sub_u32 s58, s58, 4096
  s_add_u32 s61, s60, 40960
  v_add_u32 v13, s61, v4
  s_add_u32 s61, s60, 61440
  v_add_u32 v14, s61, v4
  v_mov_b32 v54, 0
  v_mov_b32 v55, 0
  v_rcp_f32 v128, v128
  s_waitcnt vmcnt(17)
  v_mfma_f32_16x16x32_bf16 v[144:147], v[88:91], a[32:35], v[32:35]
  v_mul_f32 v124, v124, v128
  v_mfma_f32_16x16x32_bf16 v[140:143], v[84:87], a[32:35], 0
  buffer_load_dwordx4 a[98:101], v4, s[8:11], s58 offen offset:3072
  v_mul_f32 v125, v125, v128
  v_mul_f32 v126, v126, v128
  v_mul_f32 v127, v127, v128
  v_fmac_f32 v218, v129, v128
  v_fmac_f32 v219, v130, v128
  v_cvt_pk_bf16_f32 v170, v124, v125
  v_cvt_pk_bf16_f32 v171, v126, v127
  v_rcp_f32 v136, v136
  v_mfma_f32_16x16x32_bf16 v[128:131], v[96:99], a[36:39], v[32:35]
  v_mul_f32 v132, v132, v136
  v_mfma_f32_16x16x32_bf16 v[124:127], v[92:95], a[36:39], 0
  v_mul_f32 v133, v133, v136
  buffer_load_dwordx4 a[80:83], v4, s[8:11], s58 offen offset:0
  v_mul_f32 v134, v134, v136
  v_mul_f32 v135, v135, v136
  v_fmac_f32 v218, v137, v136
  v_fmac_f32 v219, v138, v136
  v_cvt_pk_bf16_f32 v172, v132, v133
  v_cvt_pk_bf16_f32 v173, v134, v135
  v_rcp_f32 v144, v144
  s_waitcnt vmcnt(18)
  v_mfma_f32_16x16x32_bf16 v[136:139], v[104:107], a[38:41], v[32:35]
  v_mul_f32 v140, v140, v144
  v_mfma_f32_16x16x32_bf16 v[132:135], v[100:103], a[38:41], 0
  v_mul_f32 v141, v141, v144
  v_mul_f32 v142, v142, v144
  buffer_load_dwordx4 a[86:89], v4, s[8:11], s58 offen offset:1024
  v_mul_f32 v143, v143, v144
  v_fmac_f32 v218, v145, v144
  v_fmac_f32 v219, v146, v144
  v_cvt_pk_bf16_f32 v174, v140, v141
  v_cvt_pk_bf16_f32 v175, v142, v143
  v_cvt_pk_bf16_f32 v184, v218, v219
  v_rcp_f32 v128, v128
  v_mfma_f32_16x16x32_bf16 v[144:147], v[112:115], a[42:45], v[32:35]
  v_mul_f32 v124, v124, v128
  v_mfma_f32_16x16x32_bf16 v[140:143], v[108:111], a[42:45], 0
  v_mul_f32 v125, v125, v128
  v_mul_f32 v126, v126, v128
  buffer_load_dwordx4 a[92:95], v4, s[8:11], s58 offen offset:2048
  v_mul_f32 v127, v127, v128
  v_mul_f32 v220, v129, v128
  v_mul_f32 v221, v130, v128
  v_cvt_pk_bf16_f32 v176, v124, v125
  v_cvt_pk_bf16_f32 v177, v126, v127
  v_rcp_f32 v136, v136
  v_mfma_f32_16x16x32_bf16 v[128:131], v[120:123], a[44:47], v[32:35]
  v_mul_f32 v132, v132, v136
  v_mfma_f32_16x16x32_bf16 v[124:127], v[116:119], a[44:47], 0
  v_mul_f32 v133, v133, v136
  v_mul_f32 v134, v134, v136
  v_mul_f32 v135, v135, v136
  s_add_u32 s58, s54, 8192
  buffer_load_dwordx4 a[144:147], v4, s[8:11], s58 offen offset:2048
  v_fmac_f32 v220, v137, v136
  v_fmac_f32 v221, v138, v136
  v_cvt_pk_bf16_f32 v178, v132, v133
  v_cvt_pk_bf16_f32 v179, v134, v135
  v_rcp_f32 v144, v144
  s_waitcnt vmcnt(20)
  v_accvgpr_mov_b32 a76, a52
  v_mul_f32 v140, v140, v144
  v_accvgpr_mov_b32 a77, a53
  v_accvgpr_mov_b32 a58, a52
  v_mul_f32 v141, v141, v144
  v_accvgpr_mov_b32 a59, a53
  v_mul_f32 v142, v142, v144
  v_accvgpr_mov_b32 a64, a52
  buffer_load_dwordx4 a[148:151], v4, s[8:11], s58 offen offset:3072
  v_mul_f32 v143, v143, v144
  v_accvgpr_mov_b32 a65, a53
  v_fmac_f32 v220, v145, v144
  v_accvgpr_mov_b32 a70, a52
  v_fmac_f32 v221, v146, v144
  v_accvgpr_mov_b32 a71, a53
  v_cvt_pk_bf16_f32 v180, v140, v141
  s_waitcnt vmcnt(20)
  v_mfma_f32_16x16x32_bf16 v[136:139], v[64:67], a[74:77], v[32:35]
  v_cvt_pk_bf16_f32 v181, v142, v143
  v_mfma_f32_16x16x32_bf16 v[132:135], v[60:63], a[74:77], 0
  v_rcp_f32 v128, v128
  s_waitcnt vmcnt(19)
  v_mfma_f32_16x16x32_bf16 v[144:147], v[72:75], a[52:55], v[32:35]
  s_add_u32 s58, s54, 12288
  buffer_load_dwordx4 a[152:155], v4, s[8:11], s58 offen offset:0
  v_mul_f32 v124, v124, v128
  v_mfma_f32_16x16x32_bf16 v[140:143], v[68:71], a[52:55], 0
  v_mul_f32 v125, v125, v128
  v_mul_f32 v126, v126, v128
  v_mul_f32 v127, v127, v128
  v_fmac_f32 v220, v129, v128
  v_fmac_f32 v221, v130, v128
  v_cvt_pk_bf16_f32 v182, v124, v125
  v_cvt_pk_bf16_f32 v183, v126, v127
  v_cvt_pk_bf16_f32 v185, v220, v221
  v_rcp_f32 v136, v136
  buffer_load_dwordx4 a[156:159], v4, s[8:11], s58 offen offset:1024
  v_mfma_f32_16x16x32_bf16 v[128:131], v[80:83], a[56:59], v[32:35]
  v_mul_f32 v132, v132, v136
  v_mfma_f32_16x16x32_bf16 v[124:127], v[76:79], a[56:59], 0
  v_mul_f32 v133, v133, v136
  v_mul_f32 v134, v134, v136
  v_mul_f32 v135, v135, v136
  v_mul_f32 v218, v137, v136
  v_mul_f32 v219, v138, v136
  v_cvt_pk_bf16_f32 v188, v132, v133
  v_cvt_pk_bf16_f32 v189, v134, v135
  v_rcp_f32 v144, v144
  s_waitcnt vmcnt(20)
  v_mfma_f32_16x16x32_bf16 v[136:139], v[88:91], a[58:61], v[32:35]
  buffer_load_dwordx4 a[160:163], v4, s[8:11], s58 offen offset:2048
  v_mul_f32 v140, v140, v144
  v_mfma_f32_16x16x32_bf16 v[132:135], v[84:87], a[58:61], 0
  v_mul_f32 v141, v141, v144
  v_mul_f32 v142, v142, v144
  v_mul_f32 v143, v143, v144
  v_fmac_f32 v218, v145, v144
  v_fmac_f32 v219, v146, v144
  v_cvt_pk_bf16_f32 v190, v140, v141
  v_cvt_pk_bf16_f32 v191, v142, v143
  v_rcp_f32 v128, v128
  v_mfma_f32_16x16x32_bf16 v[144:147], v[96:99], a[62:65], v[32:35]
  v_mul_f32 v124, v124, v128
  buffer_load_dwordx4 a[164:167], v4, s[8:11], s58 offen offset:3072
  v_mfma_f32_16x16x32_bf16 v[140:143], v[92:95], a[62:65], 0
  v_mul_f32 v125, v125, v128
  v_mul_f32 v126, v126, v128
  v_mul_f32 v127, v127, v128
  v_fmac_f32 v218, v129, v128
  v_fmac_f32 v219, v130, v128
  v_cvt_pk_bf16_f32 v192, v124, v125
  v_cvt_pk_bf16_f32 v193, v126, v127
  v_rcp_f32 v136, v136
  s_waitcnt vmcnt(21)
  v_mfma_f32_16x16x32_bf16 v[128:131], v[104:107], a[64:67], v[32:35]
  v_mul_f32 v132, v132, v136
  v_mfma_f32_16x16x32_bf16 v[124:127], v[100:103], a[64:67], 0
  s_add_u32 s58, s54, 16384
  buffer_load_dwordx4 a[168:171], v4, s[8:11], s58 offen offset:0
  v_mul_f32 v133, v133, v136
  v_mul_f32 v134, v134, v136
  v_mul_f32 v135, v135, v136
  v_fmac_f32 v218, v137, v136
  v_fmac_f32 v219, v138, v136
  v_cvt_pk_bf16_f32 v194, v132, v133
  v_cvt_pk_bf16_f32 v195, v134, v135
  v_cvt_pk_bf16_f32 v204, v218, v219
  v_rcp_f32 v144, v144
  v_mfma_f32_16x16x32_bf16 v[136:139], v[112:115], a[68:71], v[32:35]
  v_mul_f32 v140, v140, v144
  v_mfma_f32_16x16x32_bf16 v[132:135], v[108:111], a[68:71], 0
  buffer_load_dwordx4 a[172:175], v4, s[8:11], s58 offen offset:1024
  v_mul_f32 v141, v141, v144
  v_mul_f32 v142, v142, v144
  v_mul_f32 v143, v143, v144
  v_mul_f32 v220, v145, v144
  v_mul_f32 v221, v146, v144
  v_cvt_pk_bf16_f32 v196, v140, v141
  v_cvt_pk_bf16_f32 v197, v142, v143
  v_rcp_f32 v128, v128
  v_mfma_f32_16x16x32_bf16 v[144:147], v[120:123], a[70:73], v[32:35]
  v_mul_f32 v124, v124, v128
  v_mfma_f32_16x16x32_bf16 v[140:143], v[116:119], a[70:73], 0
  v_mul_f32 v125, v125, v128
  buffer_load_dwordx4 a[176:179], v4, s[8:11], s58 offen offset:2048
  v_mul_f32 v126, v126, v128
  v_mul_f32 v127, v127, v128
  v_fmac_f32 v220, v129, v128
  v_fmac_f32 v221, v130, v128
  v_cvt_pk_bf16_f32 v198, v124, v125
  v_cvt_pk_bf16_f32 v199, v126, v127
  v_rcp_f32 v136, v136
  s_waitcnt vmcnt(13)
  v_accvgpr_mov_b32 a102, a78
  v_mul_f32 v132, v132, v136
  v_accvgpr_mov_b32 a103, a79
  v_accvgpr_mov_b32 a84, a78
  v_mul_f32 v133, v133, v136
  v_accvgpr_mov_b32 a85, a79
  v_mul_f32 v134, v134, v136
  buffer_load_dwordx4 a[180:183], v4, s[8:11], s58 offen offset:3072
  v_accvgpr_mov_b32 a90, a78
  v_mul_f32 v135, v135, v136
  v_accvgpr_mov_b32 a91, a79
  v_fmac_f32 v220, v137, v136
  v_accvgpr_mov_b32 a96, a78
  v_fmac_f32 v221, v138, v136
  v_accvgpr_mov_b32 a97, a79
  v_cvt_pk_bf16_f32 v200, v132, v133
  s_waitcnt vmcnt(13)
  v_mfma_f32_16x16x32_bf16 v[128:131], v[64:67], a[100:103], v[32:35]
  v_cvt_pk_bf16_f32 v201, v134, v135
  v_mfma_f32_16x16x32_bf16 v[124:127], v[60:63], a[100:103], 0
  v_rcp_f32 v144, v144
  s_add_u32 s58, s54, 20480
  buffer_load_dwordx4 a[184:187], v4, s[8:11], s58 offen offset:0
  s_waitcnt vmcnt(13)
  v_mfma_f32_16x16x32_bf16 v[136:139], v[72:75], a[78:81], v[32:35]
  v_mul_f32 v140, v140, v144
  v_mfma_f32_16x16x32_bf16 v[132:135], v[68:71], a[78:81], 0
  v_mul_f32 v141, v141, v144
  v_mul_f32 v142, v142, v144
  v_mul_f32 v143, v143, v144
  v_fmac_f32 v220, v145, v144
  v_fmac_f32 v221, v146, v144
  v_cvt_pk_bf16_f32 v202, v140, v141
  v_cvt_pk_bf16_f32 v203, v142, v143
  v_cvt_pk_bf16_f32 v205, v220, v221
  buffer_load_dwordx4 a[188:191], v4, s[8:11], s58 offen offset:1024
  v_rcp_f32 v128, v128
  v_mfma_f32_16x16x32_bf16 v[144:147], v[80:83], a[82:85], v[32:35]
  v_mul_f32 v124, v124, v128
  v_mfma_f32_16x16x32_bf16 v[140:143], v[76:79], a[82:85], 0
  v_mul_f32 v125, v125, v128
  v_mul_f32 v126, v126, v128
  v_mfma_f32_16x16x32_bf16 a[204:207], a[104:107], v[148:151], 0
  v_mul_f32 v127, v127, v128
  v_mul_f32 v218, v129, v128
  v_mfma_f32_16x16x32_bf16 a[208:211], a[108:111], v[148:151], 0
  buffer_load_dwordx4 a[192:195], v4, s[8:11], s58 offen offset:2048
  v_mul_f32 v219, v130, v128
  v_cvt_pk_bf16_f32 v36, v124, v125
  v_mfma_f32_16x16x32_bf16 a[212:215], a[112:115], v[148:151], 0
  v_cvt_pk_bf16_f32 v37, v126, v127
  v_rcp_f32 v136, v136
  s_waitcnt vmcnt(14)
  v_mfma_f32_16x16x32_bf16 v[128:131], v[88:91], a[84:87], v[32:35]
  v_mul_f32 v132, v132, v136
  v_mfma_f32_16x16x32_bf16 v[124:127], v[84:87], a[84:87], 0
  v_mul_f32 v133, v133, v136
  v_mfma_f32_16x16x32_bf16 a[216:219], a[116:119], v[148:151], 0
  buffer_load_dwordx4 a[196:199], v4, s[8:11], s58 offen offset:3072
  v_mul_f32 v134, v134, v136
  v_mul_f32 v135, v135, v136
  v_mfma_f32_16x16x32_bf16 a[220:223], a[120:123], v[148:151], 0
  v_fmac_f32 v218, v137, v136
  v_mfma_f32_16x16x32_bf16 a[224:227], a[104:107], v[168:171], 0
  v_fmac_f32 v219, v138, v136
  v_cvt_pk_bf16_f32 v38, v132, v133
  v_mfma_f32_16x16x32_bf16 a[228:231], a[108:111], v[168:171], 0
  v_cvt_pk_bf16_f32 v39, v134, v135
  v_rcp_f32 v144, v144
  v_mfma_f32_16x16x32_bf16 v[136:139], v[96:99], a[88:91], v[32:35]
  s_add_u32 s58, s54, 24576
  buffer_load_dwordx4 a[200:203], v4, s[8:11], s58 offen offset:0
  v_mul_f32 v140, v140, v144
  v_mfma_f32_16x16x32_bf16 v[132:135], v[92:95], a[88:91], 0
  v_mul_f32 v141, v141, v144
  v_mfma_f32_16x16x32_bf16 a[232:235], a[112:115], v[168:171], 0
  v_mul_f32 v142, v142, v144
  v_mul_f32 v143, v143, v144
  v_mfma_f32_16x16x32_bf16 a[236:239], a[116:119], v[168:171], 0
  v_fmac_f32 v218, v145, v144
  v_mfma_f32_16x16x32_bf16 a[240:243], a[120:123], v[168:171], 0
  v_fmac_f32 v219, v146, v144
  s_add_u32 m0, s57, 0
  s_add_u32 s58, s56, 0
  buffer_load_dwordx4 v24, s[16:19], s58 offen lds
  v_cvt_pk_bf16_f32 v40, v140, v141
  v_mfma_f32_16x16x32_bf16 a[204:207], a[124:127], v[152:155], a[204:207]
  v_cvt_pk_bf16_f32 v41, v142, v143
  v_rcp_f32 v128, v128
  s_waitcnt vmcnt(16)
  v_mfma_f32_16x16x32_bf16 v[144:147], v[104:107], a[90:93], v[32:35]
  v_mul_f32 v124, v124, v128
  v_mfma_f32_16x16x32_bf16 v[140:143], v[100:103], a[90:93], 0
  v_mul_f32 v125, v125, v128
  v_mfma_f32_16x16x32_bf16 a[208:211], a[128:131], v[152:155], a[208:211]
  s_add_u32 m0, s57, 1024
  s_add_u32 s58, s56, 9216
  buffer_load_dwordx4 v24, s[16:19], s58 offen lds
  v_mul_f32 v126, v126, v128
  v_mul_f32 v127, v127, v128
  v_mfma_f32_16x16x32_bf16 a[212:215], a[132:135], v[152:155], a[212:215]
  v_fmac_f32 v218, v129, v128
  v_fmac_f32 v219, v130, v128
  v_mfma_f32_16x16x32_bf16 a[216:219], a[136:139], v[152:155], a[216:219]
  v_cvt_pk_bf16_f32 v42, v124, v125
  v_cvt_pk_bf16_f32 v43, v126, v127
  v_mfma_f32_16x16x32_bf16 a[220:223], a[140:143], v[152:155], a[220:223]
  v_cvt_pk_bf16_f32 v52, v218, v219
  s_add_u32 m0, s57, 2048
  s_add_u32 s58, s56, 18432
  buffer_load_dwordx4 v24, s[16:19], s58 offen lds
  v_rcp_f32 v136, v136
  v_mfma_f32_16x16x32_bf16 v[128:131], v[112:115], a[94:97], v[32:35]
  v_mul_f32 v132, v132, v136
  v_mfma_f32_16x16x32_bf16 v[124:127], v[108:111], a[94:97], 0
  v_mul_f32 v133, v133, v136
  v_mul_f32 v134, v134, v136
  v_mfma_f32_16x16x32_bf16 a[224:227], a[124:127], v[172:175], a[224:227]
  v_mul_f32 v135, v135, v136
  v_mul_f32 v220, v137, v136
  s_add_u32 m0, s57, 3072
  s_add_u32 s58, s56, 27648
  buffer_load_dwordx4 v24, s[16:19], s58 offen lds
  v_mfma_f32_16x16x32_bf16 a[228:231], a[128:131], v[172:175], a[228:231]
  v_mul_f32 v221, v138, v136
  v_cvt_pk_bf16_f32 v44, v132, v133
  v_mfma_f32_16x16x32_bf16 a[232:235], a[132:135], v[172:175], a[232:235]
  v_cvt_pk_bf16_f32 v45, v134, v135
  v_rcp_f32 v144, v144
  v_mfma_f32_16x16x32_bf16 v[136:139], v[120:123], a[96:99], v[32:35]
  v_mul_f32 v140, v140, v144
  v_mfma_f32_16x16x32_bf16 v[132:135], v[116:119], a[96:99], 0
  buffer_load_dwordx4 v[208:211], v19, s[12:15], 0 offen
  v_mul_f32 v141, v141, v144
  v_mfma_f32_16x16x32_bf16 a[236:239], a[136:139], v[172:175], a[236:239]
  v_mul_f32 v142, v142, v144
  v_mul_f32 v143, v143, v144
  v_mfma_f32_16x16x32_bf16 a[240:243], a[140:143], v[172:175], a[240:243]
  v_fmac_f32 v220, v145, v144
  v_mfma_f32_16x16x32_bf16 a[244:247], a[104:107], v[188:191], 0
  v_fmac_f32 v221, v146, v144
  v_cvt_pk_bf16_f32 v46, v140, v141
  v_mfma_f32_16x16x32_bf16 a[248:251], a[108:111], v[188:191], 0
  v_cvt_pk_bf16_f32 v47, v142, v143
  v_rcp_f32 v128, v128
  v_mfma_f32_16x16x32_bf16 a[252:255], a[112:115], v[188:191], 0
  v_mul_f32 v124, v124, v128
  v_mfma_f32_16x16x32_bf16 v[224:227], a[116:119], v[188:191], 0
  v_mul_f32 v125, v125, v128
  v_mul_f32 v126, v126, v128
  v_mfma_f32_16x16x32_bf16 v[228:231], a[120:123], v[188:191], 0
  v_mul_f32 v127, v127, v128
  v_fmac_f32 v220, v129, v128
  v_fmac_f32 v221, v130, v128
  v_mfma_f32_16x16x32_bf16 a[244:247], a[124:127], v[192:195], a[244:247]
  v_cvt_pk_bf16_f32 v48, v124, v125
  v_cvt_pk_bf16_f32 v49, v126, v127
  v_rcp_f32 v136, v136
  v_mfma_f32_16x16x32_bf16 a[248:251], a[128:131], v[192:195], a[248:251]
  v_mul_f32 v132, v132, v136
  v_mfma_f32_16x16x32_bf16 a[252:255], a[132:135], v[192:195], a[252:255]
  v_mul_f32 v133, v133, v136
  v_mul_f32 v134, v134, v136
  v_mul_f32 v135, v135, v136
  v_mfma_f32_16x16x32_bf16 v[224:227], a[136:139], v[192:195], v[224:227]
  v_fmac_f32 v220, v137, v136
  v_fmac_f32 v221, v138, v136
  buffer_load_dwordx4 v[212:215], v19, s[12:15], 0 offen offset:64
  v_cvt_pk_bf16_f32 v50, v132, v133
  v_mfma_f32_16x16x32_bf16 v[228:231], a[140:143], v[192:195], v[228:231]
  v_cvt_pk_bf16_f32 v51, v134, v135
  v_cvt_pk_bf16_f32 v53, v220, v221
  v_mfma_f32_16x16x32_bf16 v[232:235], a[104:107], v[36:39], 0
  s_mul_i32 s35, s33, 576
  v_mfma_f32_16x16x32_bf16 v[236:239], a[108:111], v[36:39], 0
  v_mfma_f32_16x16x32_bf16 v[240:243], a[112:115], v[36:39], 0
  s_mul_i32 s36, s32, 144
  v_mfma_f32_16x16x32_bf16 v[244:247], a[116:119], v[36:39], 0
  v_mfma_f32_16x16x32_bf16 v[248:251], a[120:123], v[36:39], 0
  s_add_u32 s35, s35, s36
  v_mfma_f32_16x16x32_bf16 v[232:235], a[124:127], v[40:43], v[232:235]
  v_mfma_f32_16x16x32_bf16 v[236:239], a[128:131], v[40:43], v[236:239]
  v_mfma_f32_16x16x32_bf16 v[240:243], a[132:135], v[40:43], v[240:243]
  v_lshlrev_b32 v9, 2, v1
  v_mfma_f32_16x16x32_bf16 v[244:247], a[136:139], v[40:43], v[244:247]
  v_mfma_f32_16x16x32_bf16 v[248:251], a[140:143], v[40:43], v[248:251]
  v_add_u32 v9, s35, v9
  s_waitcnt vmcnt(20)
  v_mfma_f32_16x16x32_bf16 a[204:207], a[144:147], v[156:159], a[204:207]
  s_waitcnt vmcnt(19)
  v_mfma_f32_16x16x32_bf16 a[208:211], a[148:151], v[156:159], a[208:211]
  v_lshlrev_b32 v10, 1, v9
  s_waitcnt vmcnt(18)
  v_mfma_f32_16x16x32_bf16 a[212:215], a[152:155], v[156:159], a[212:215]
  s_waitcnt vmcnt(17)
  v_mfma_f32_16x16x32_bf16 a[216:219], a[156:159], v[156:159], a[216:219]
  s_waitcnt vmcnt(16)
  v_mfma_f32_16x16x32_bf16 a[220:223], a[160:163], v[156:159], a[220:223]
  v_lshlrev_b32 v9, 2, v9
  s_waitcnt vmcnt(15)
  v_mfma_f32_16x16x32_bf16 a[204:207], a[164:167], v[160:163], a[204:207]
  s_waitcnt vmcnt(14)
  v_mfma_f32_16x16x32_bf16 a[208:211], a[168:171], v[160:163], a[208:211]
  s_mov_b32 s35, 11436032
  s_waitcnt vmcnt(13)
  v_mfma_f32_16x16x32_bf16 a[212:215], a[172:175], v[160:163], a[212:215]
  buffer_load_dwordx2 v[216:217], v20, s[12:15], 0 offen
  s_waitcnt vmcnt(13)
  v_mfma_f32_16x16x32_bf16 a[216:219], a[176:179], v[160:163], a[216:219]
  buffer_load_dwordx4 v[124:127], v9, s[8:11], s35 offen
  s_waitcnt vmcnt(13)
  v_mfma_f32_16x16x32_bf16 a[220:223], a[180:183], v[160:163], a[220:223]
  s_waitcnt vmcnt(12)
  v_mfma_f32_16x16x32_bf16 a[204:207], a[184:187], v[164:167], a[204:207]
  s_waitcnt vmcnt(11)
  v_mfma_f32_16x16x32_bf16 a[208:211], a[188:191], v[164:167], a[208:211]
  s_mov_b32 s35, 11454464
  s_waitcnt vmcnt(10)
  v_mfma_f32_16x16x32_bf16 a[212:215], a[192:195], v[164:167], a[212:215]
  s_waitcnt vmcnt(9)
  v_mfma_f32_16x16x32_bf16 a[216:219], a[196:199], v[164:167], a[216:219]
  buffer_load_dwordx4 v[128:131], v9, s[8:11], s35 offen
  s_waitcnt vmcnt(9)
  v_mfma_f32_16x16x32_bf16 a[220:223], a[200:203], v[164:167], a[220:223]
  v_mfma_f32_16x16x32_bf16 a[224:227], a[144:147], v[176:179], a[224:227]
  buffer_load_dwordx2 v[136:137], v10, s[20:23], 0 offen
  v_mfma_f32_16x16x32_bf16 a[228:231], a[148:151], v[176:179], a[228:231]
  v_mfma_f32_16x16x32_bf16 a[232:235], a[152:155], v[176:179], a[232:235]
  v_mfma_f32_16x16x32_bf16 a[236:239], a[156:159], v[176:179], a[236:239]
  ds_write_b128 v11, a[204:207] offset:0
  v_mfma_f32_16x16x32_bf16 a[240:243], a[160:163], v[176:179], a[240:243]
  ds_write_b128 v11, a[208:211] offset:1024
  v_mfma_f32_16x16x32_bf16 a[224:227], a[164:167], v[180:183], a[224:227]
  ds_write_b128 v11, a[212:215] offset:2048
  v_mfma_f32_16x16x32_bf16 a[228:231], a[168:171], v[180:183], a[228:231]
  ds_write_b128 v11, a[216:219] offset:3072
  v_mfma_f32_16x16x32_bf16 a[232:235], a[172:175], v[180:183], a[232:235]
  ds_write_b128 v11, a[220:223] offset:4096
  v_mfma_f32_16x16x32_bf16 a[236:239], a[176:179], v[180:183], a[236:239]
  s_waitcnt vmcnt(6)
  v_mfma_f32_16x16x32_bf16 a[240:243], a[180:183], v[180:183], a[240:243]
  ds_read_b64_tr_b16 v[60:61], v25 offset:0
  v_mfma_f32_16x16x32_bf16 a[224:227], a[184:187], v[184:187], a[224:227]
  ds_read_b64_tr_b16 v[62:63], v25 offset:2048
  v_mfma_f32_16x16x32_bf16 a[228:231], a[188:191], v[184:187], a[228:231]
  ds_read_b64_tr_b16 v[64:65], v26 offset:0
  v_mfma_f32_16x16x32_bf16 a[232:235], a[192:195], v[184:187], a[232:235]
  ds_read_b64_tr_b16 v[66:67], v26 offset:2048
  v_mfma_f32_16x16x32_bf16 a[236:239], a[196:199], v[184:187], a[236:239]
  ds_read_b64_tr_b16 v[68:69], v27 offset:0
  v_mfma_f32_16x16x32_bf16 a[240:243], a[200:203], v[184:187], a[240:243]
  ds_read_b64_tr_b16 v[70:71], v27 offset:2048
  v_mfma_f32_16x16x32_bf16 a[244:247], a[144:147], v[196:199], a[244:247]
  ds_read_b64_tr_b16 v[72:73], v28 offset:0
  v_mfma_f32_16x16x32_bf16 a[248:251], a[148:151], v[196:199], a[248:251]
  ds_read_b64_tr_b16 v[74:75], v28 offset:2048
  v_mfma_f32_16x16x32_bf16 a[252:255], a[152:155], v[196:199], a[252:255]
  v_mfma_f32_16x16x32_bf16 v[224:227], a[156:159], v[196:199], v[224:227]
  ds_write_b128 v12, a[224:227] offset:0
  v_mfma_f32_16x16x32_bf16 v[228:231], a[160:163], v[196:199], v[228:231]
  ds_write_b128 v12, a[228:231] offset:1024
  v_mfma_f32_16x16x32_bf16 a[244:247], a[164:167], v[200:203], a[244:247]
  v_mfma_f32_16x16x32_bf16 a[248:251], a[168:171], v[200:203], a[248:251]
  ds_write_b128 v12, a[232:235] offset:2048
  v_mfma_f32_16x16x32_bf16 a[252:255], a[172:175], v[200:203], a[252:255]
  v_mfma_f32_16x16x32_bf16 v[224:227], a[176:179], v[200:203], v[224:227]
  ds_write_b128 v12, a[236:239] offset:3072
  v_mfma_f32_16x16x32_bf16 v[228:231], a[180:183], v[200:203], v[228:231]
  ds_write_b128 v12, a[240:243] offset:4096
  v_mfma_f32_16x16x32_bf16 a[244:247], a[184:187], v[204:207], a[244:247]
  v_mfma_f32_16x16x32_bf16 a[248:251], a[188:191], v[204:207], a[248:251]
  s_waitcnt lgkmcnt(11)
  buffer_store_dwordx4 v[60:63], v29, s[8:11], s88 offen sc1
  v_mfma_f32_16x16x32_bf16 a[252:255], a[192:195], v[204:207], a[252:255]
  v_mfma_f32_16x16x32_bf16 v[224:227], a[196:199], v[204:207], v[224:227]
  s_waitcnt lgkmcnt(9)
  buffer_store_dwordx4 v[64:67], v29, s[8:11], s89 offen sc1
  v_mfma_f32_16x16x32_bf16 v[228:231], a[200:203], v[204:207], v[228:231]
  s_waitcnt lgkmcnt(7)
  buffer_store_dwordx4 v[68:71], v29, s[8:11], s90 offen sc1
  v_mfma_f32_16x16x32_bf16 v[232:235], a[144:147], v[44:47], v[232:235]
  v_mfma_f32_16x16x32_bf16 v[236:239], a[148:151], v[44:47], v[236:239]
  s_waitcnt lgkmcnt(5)
  buffer_store_dwordx4 v[72:75], v29, s[8:11], s91 offen sc1
  v_mfma_f32_16x16x32_bf16 v[240:243], a[152:155], v[44:47], v[240:243]
  v_mfma_f32_16x16x32_bf16 v[244:247], a[156:159], v[44:47], v[244:247]
  ds_write_b128 v13, a[244:247] offset:0
  v_mfma_f32_16x16x32_bf16 v[248:251], a[160:163], v[44:47], v[248:251]
  v_mfma_f32_16x16x32_bf16 v[232:235], a[164:167], v[48:51], v[232:235]
  ds_write_b128 v13, a[248:251] offset:1024
  v_mfma_f32_16x16x32_bf16 v[236:239], a[168:171], v[48:51], v[236:239]
  v_mfma_f32_16x16x32_bf16 v[240:243], a[172:175], v[48:51], v[240:243]
  ds_write_b128 v13, a[252:255] offset:2048
  v_mfma_f32_16x16x32_bf16 v[244:247], a[176:179], v[48:51], v[244:247]
  v_mfma_f32_16x16x32_bf16 v[248:251], a[180:183], v[48:51], v[248:251]
  v_mfma_f32_16x16x32_bf16 v[232:235], a[184:187], v[52:55], v[232:235]
  ds_write_b128 v13, v[224:227] offset:3072
  v_mfma_f32_16x16x32_bf16 v[236:239], a[188:191], v[52:55], v[236:239]
  v_mfma_f32_16x16x32_bf16 v[240:243], a[192:195], v[52:55], v[240:243]
  ds_write_b128 v13, v[228:231] offset:4096
  v_mfma_f32_16x16x32_bf16 v[244:247], a[196:199], v[52:55], v[244:247]
  v_mfma_f32_16x16x32_bf16 v[248:251], a[200:203], v[52:55], v[248:251]
  s_nop 1
  ds_write_b128 v14, v[232:235] offset:0
  s_nop 0
  ds_write_b128 v14, v[236:239] offset:1024
  ds_write_b128 v14, v[240:243] offset:2048
  s_nop 0
  ds_write_b128 v14, v[244:247] offset:3072
  ds_write_b128 v14, v[248:251] offset:4096
  s_mul_i32 s35, s32, 20480
  v_add_u32 v21, s35, v4
  s_waitcnt vmcnt(9)
  v_lshlrev_b32 v148, 16, v208
  v_and_b32 v149, 0xffff0000, v208
  v_lshlrev_b32 v150, 16, v209
  v_and_b32 v151, 0xffff0000, v209
  v_lshlrev_b32 v152, 16, v210
  v_and_b32 v153, 0xffff0000, v210
  v_lshlrev_b32 v154, 16, v211
  v_and_b32 v155, 0xffff0000, v211
  s_waitcnt vmcnt(8)
  v_lshlrev_b32 v156, 16, v212
  v_and_b32 v157, 0xffff0000, v212
  v_lshlrev_b32 v158, 16, v213
  v_and_b32 v159, 0xffff0000, v213
  v_lshlrev_b32 v160, 16, v214
  v_and_b32 v161, 0xffff0000, v214
  v_lshlrev_b32 v162, 16, v215
  v_and_b32 v163, 0xffff0000, v215
  s_waitcnt vmcnt(7)
  v_lshlrev_b32 v164, 16, v216
  v_and_b32 v165, 0xffff0000, v216
  v_lshlrev_b32 v166, 16, v217
  v_and_b32 v167, 0xffff0000, v217
  s_waitcnt lgkmcnt(0)
  s_barrier
  ds_read_b128 v[60:63], v21 offset:0
  ds_read_b128 v[64:67], v21 offset:5120
  ds_read_b128 v[68:71], v21 offset:10240
  ds_read_b128 v[72:75], v21 offset:15360
  ds_read_b128 v[76:79], v21 offset:1024
  ds_read_b128 v[80:83], v21 offset:6144
  ds_read_b128 v[84:87], v21 offset:11264
  ds_read_b128 v[88:91], v21 offset:16384
  ds_read_b128 v[92:95], v21 offset:2048
  ds_read_b128 v[96:99], v21 offset:7168
  ds_read_b128 v[100:103], v21 offset:12288
  ds_read_b128 v[104:107], v21 offset:17408
  ds_read_b128 v[108:111], v21 offset:3072
  ds_read_b128 v[112:115], v21 offset:8192
  ds_read_b128 v[116:119], v21 offset:13312
  ds_read_b128 v[120:123], v21 offset:18432
  ds_read_b128 v[36:39], v21 offset:4096
  ds_read_b128 v[40:43], v21 offset:9216
  ds_read_b128 v[44:47], v21 offset:14336
  ds_read_b128 v[48:51], v21 offset:19456
  s_mov_b32 s35, 0x3f803f80
  v_mov_b32 v218, 0
  v_mov_b32 v219, 0
  s_waitcnt lgkmcnt(15)
  v_pk_add_f32 v[60:61], v[60:61], v[64:65]
  v_pk_add_f32 v[68:69], v[68:69], v[72:73]
  v_pk_add_f32 v[62:63], v[62:63], v[66:67]
  v_pk_add_f32 v[70:71], v[70:71], v[74:75]
  v_pk_add_f32 v[148:149], v[148:149], v[60:61]
  v_pk_add_f32 v[150:151], v[150:151], v[62:63]
  v_pk_add_f32 v[148:149], v[148:149], v[68:69]
  v_pk_add_f32 v[150:151], v[150:151], v[70:71]
  v_cvt_pk_bf16_f32 v168, v148, v149
  v_cvt_pk_bf16_f32 v169, v150, v151
  v_dot2_f32_bf16 v218, v168, s35, v218
  v_dot2_f32_bf16 v219, v168, v168, v219
  v_dot2_f32_bf16 v218, v169, s35, v218
  v_dot2_f32_bf16 v219, v169, v169, v219
  s_waitcnt lgkmcnt(14)
  v_pk_add_f32 v[76:77], v[76:77], v[80:81]
  s_waitcnt lgkmcnt(12)
  v_pk_add_f32 v[84:85], v[84:85], v[88:89]
  v_pk_add_f32 v[78:79], v[78:79], v[82:83]
  v_pk_add_f32 v[86:87], v[86:87], v[90:91]
  v_pk_add_f32 v[152:153], v[152:153], v[76:77]
  v_pk_add_f32 v[154:155], v[154:155], v[78:79]
  v_pk_add_f32 v[152:153], v[152:153], v[84:85]
  v_pk_add_f32 v[154:155], v[154:155], v[86:87]
  v_cvt_pk_bf16_f32 v170, v152, v153
  v_cvt_pk_bf16_f32 v171, v154, v155
  buffer_store_dwordx4 v[168:171], v22, s[8:11], s55 offen sc1
  v_dot2_f32_bf16 v218, v170, s35, v218
  v_dot2_f32_bf16 v219, v170, v170, v219
  v_dot2_f32_bf16 v218, v171, s35, v218
  v_dot2_f32_bf16 v219, v171, v171, v219
  s_waitcnt lgkmcnt(10)
  v_pk_add_f32 v[92:93], v[92:93], v[96:97]
  s_waitcnt lgkmcnt(8)
  v_pk_add_f32 v[100:101], v[100:101], v[104:105]
  v_pk_add_f32 v[94:95], v[94:95], v[98:99]
  v_pk_add_f32 v[102:103], v[102:103], v[106:107]
  v_pk_add_f32 v[156:157], v[156:157], v[92:93]
  v_pk_add_f32 v[158:159], v[158:159], v[94:95]
  v_pk_add_f32 v[156:157], v[156:157], v[100:101]
  v_pk_add_f32 v[158:159], v[158:159], v[102:103]
  v_cvt_pk_bf16_f32 v172, v156, v157
  v_cvt_pk_bf16_f32 v173, v158, v159
  v_dot2_f32_bf16 v218, v172, s35, v218
  v_dot2_f32_bf16 v219, v172, v172, v219
  v_dot2_f32_bf16 v218, v173, s35, v218
  v_dot2_f32_bf16 v219, v173, v173, v219
  s_waitcnt lgkmcnt(6)
  v_pk_add_f32 v[108:109], v[108:109], v[112:113]
  s_waitcnt lgkmcnt(4)
  v_pk_add_f32 v[116:117], v[116:117], v[120:121]
  v_pk_add_f32 v[110:111], v[110:111], v[114:115]
  v_pk_add_f32 v[118:119], v[118:119], v[122:123]
  v_pk_add_f32 v[160:161], v[160:161], v[108:109]
  v_pk_add_f32 v[162:163], v[162:163], v[110:111]
  v_pk_add_f32 v[160:161], v[160:161], v[116:117]
  v_pk_add_f32 v[162:163], v[162:163], v[118:119]
  v_cvt_pk_bf16_f32 v174, v160, v161
  v_cvt_pk_bf16_f32 v175, v162, v163
  buffer_store_dwordx4 v[172:175], v22, s[8:11], s55 offen offset:1024 sc1
  v_dot2_f32_bf16 v218, v174, s35, v218
  v_dot2_f32_bf16 v219, v174, v174, v219
  v_dot2_f32_bf16 v218, v175, s35, v218
  v_dot2_f32_bf16 v219, v175, v175, v219
  s_waitcnt lgkmcnt(2)
  v_pk_add_f32 v[36:37], v[36:37], v[40:41]
  s_waitcnt lgkmcnt(0)
  v_pk_add_f32 v[44:45], v[44:45], v[48:49]
  v_pk_add_f32 v[38:39], v[38:39], v[42:43]
  v_pk_add_f32 v[46:47], v[46:47], v[50:51]
  v_pk_add_f32 v[164:165], v[164:165], v[36:37]
  v_pk_add_f32 v[166:167], v[166:167], v[38:39]
  v_pk_add_f32 v[164:165], v[164:165], v[44:45]
  v_pk_add_f32 v[166:167], v[166:167], v[46:47]
  v_cvt_pk_bf16_f32 v176, v164, v165
  v_cvt_pk_bf16_f32 v177, v166, v167
  v_cndmask_b32 v176, 0, v176, s[52:53]
  v_cndmask_b32 v177, 0, v177, s[52:53]
  buffer_store_dwordx2 v[176:177], v23, s[8:11], s55 offen sc1
  v_dot2_f32_bf16 v218, v176, s35, v218
  v_dot2_f32_bf16 v219, v176, v176, v219
  v_dot2_f32_bf16 v218, v177, s35, v218
  v_dot2_f32_bf16 v219, v177, v177, v219
  s_nop 1
  v_mov_b32 v220, v218
  v_mov_b32 v221, v219
  s_nop 0
  v_permlane16_swap_b32 v218, v220
  v_permlane16_swap_b32 v219, v221
  v_add_f32 v218, v218, v220
  v_add_f32 v219, v219, v221
  v_mov_b32 v220, v218
  v_mov_b32 v221, v219
  s_nop 0
  v_permlane32_swap_b32 v218, v220
  v_permlane32_swap_b32 v219, v221
  v_add_f32 v218, v218, v220
  v_add_f32 v219, v219, v221
  buffer_store_dwordx2 v[218:219], v30, s[8:11], 0 offen sc1
  s_mul_i32 s35, s32, 1152
  s_add_u32 s35, s35, 155648
  v_lshlrev_b32 v12, 5, v3
  v_add_u32 v12, s35, v12
  v_lshlrev_b32 v5, 5, v1
  v_add_u32 v5, s35, v5
  s_waitcnt vmcnt(9)
  v_add_f32 v124, v124, v128
  v_add_f32 v125, v125, v129
  v_add_f32 v126, v126, v130
  v_add_f32 v127, v127, v131
  s_waitcnt vmcnt(8)
  v_lshlrev_b32 v128, 16, v136
  v_and_b32 v129, 0xffff0000, v136
  v_lshlrev_b32 v130, 16, v137
  v_and_b32 v131, 0xffff0000, v137
  s_mov_b32 exec_hi, 15
  ds_write_b128 v5, v[124:127]
  ds_write_b128 v5, v[128:131] offset:16
  s_mov_b64 exec, -1
  s_lshl_b32 s35, s32, 7
  v_add_u32 v25, s35, v29
  v_add_u32 v26, 0x1000, v25
  v_add_u32 v27, 0x2000, v25
  v_add_u32 v9, 0x10000, v4
  v_add_u32 v13, s37, v4
  v_lshlrev_b32 v14, 3, v2
  v_lshl_add_u32 v14, v3, 10, v14
  s_mul_i32 s40, s33, 1327104
  s_mov_b32 s12, s8
  s_mov_b32 s13, s9
  s_add_u32 s14, s40, 1327104
  s_mul_i32 s39, s34, 73728
  s_add_u32 s38, s39, 16408576
  s_add_u32 s39, s39, 13918208
  s_mul_i32 s35, s33, 2359296
  s_add_u32 s46, s38, s35
  s_mul_i32 s35, s32, 9
  s_add_u32 s36, s35, 1
  s_lshr_b32 s41, s36, 1
  s_lshl_b32 s41, s41, 12
  s_add_u32 s41, s41, s46
  s_lshr_b32 s43, s32, 1
  s_mul_i32 s43, s43, 9
  s_add_u32 s43, s43, 4
  s_lshl_b32 s43, s43, 12
  s_and_b32 s42, s32, 1
  s_lshl_b32 s42, s42, 11
  s_add_u32 s43, s43, s42
  s_add_u32 s43, s43, s46
  s_lshr_b32 s42, s35, 1
  s_lshl_b32 s42, s42, 12
  s_and_b32 s35, s35, 1
  s_lshl_b32 s35, s35, 3
  s_add_u32 s42, s42, s35
  v_add_u32 v10, s42, v4
  s_lshr_b32 s42, s36, 1
  s_lshl_b32 s42, s42, 12
  s_and_b32 s36, s36, 1
  s_lshl_b32 s36, s36, 3
  s_add_u32 s42, s42, s36
  v_add_u32 v11, s42, v4
  s_lshl_b32 s44, s32, 10
  s_mul_i32 s45, s32, 18432
  s_add_u32 s45, s45, s39
  s_lshl_b32 s47, s34, 12
  s_add_u32 s47, s47, 16277504
  buffer_load_dwordx4 v[172:175], v25, s[12:15], s40 offen sc1
  buffer_load_dwordx4 v[176:179], v26, s[12:15], s40 offen sc1
  buffer_load_dwordx4 v[180:183], v27, s[12:15], s40 offen sc1
  s_add_u32 s40, s40, 12288
  buffer_load_dwordx4 v[184:187], v25, s[12:15], s40 offen sc1
  buffer_load_dwordx4 v[188:191], v26, s[12:15], s40 offen sc1
  buffer_load_dwordx4 v[192:195], v27, s[12:15], s40 offen sc1
  s_add_u32 s40, s40, 12288
  s_waitcnt vmcnt(6)
  s_barrier
  s_cmp_lg_u32 s32, 0
  s_cbranch_scc1 L_kf_ar1
  s_mov_b64 exec, 1
  buffer_atomic_add v8, off, s[8:11], s49
  buffer_atomic_add v8, off, s[8:11], s51
  s_mov_b64 exec, -1
  L_kf_ar1:
  buffer_load_dwordx4 v[196:199], v25, s[12:15], s40 offen sc1
  buffer_load_dwordx4 v[200:203], v26, s[12:15], s40 offen sc1
  buffer_load_dwordx4 v[204:207], v27, s[12:15], s40 offen sc1
  s_add_u32 s40, s40, 12288
  buffer_load_dwordx4 v[208:211], v25, s[12:15], s40 offen sc1
  buffer_load_dwordx4 v[212:215], v26, s[12:15], s40 offen sc1
  buffer_load_dwordx4 v[216:219], v27, s[12:15], s40 offen sc1
  s_add_u32 s40, s40, 12288
  s_mov_b32 s36, 0
  L_kf_sp2:
  buffer_load_dword v7, off, s[8:11], s49 sc1
  s_waitcnt vmcnt(0)
  v_readfirstlane_b32 s35, v7
  s_add_u32 s36, s36, 1
  s_cmp_ge_u32 s35, 8
  s_cbranch_scc1 L_kf_ok2
  s_sleep 6
  s_cmp_lt_u32 s36, 4194304
  s_cbranch_scc1 L_kf_sp2
  L_kf_ok2:
  s_waitcnt vmcnt(0)
  buffer_load_dwordx2 v[56:57], v14, s[8:11], s47 offen offset:0 sc1
  buffer_load_dwordx2 v[58:59], v14, s[8:11], s47 offen offset:512 sc1
  buffer_load_dwordx2 v[60:61], v14, s[8:11], s47 offen offset:128 sc1
  buffer_load_dwordx2 v[62:63], v14, s[8:11], s47 offen offset:640 sc1
  buffer_load_dwordx2 v[64:65], v14, s[8:11], s47 offen offset:256 sc1
  buffer_load_dwordx2 v[66:67], v14, s[8:11], s47 offen offset:768 sc1
  buffer_load_dwordx2 v[68:69], v14, s[8:11], s47 offen offset:384 sc1
  buffer_load_dwordx2 v[70:71], v14, s[8:11], s47 offen offset:896 sc1
  s_add_u32 m0, s44, 0
  s_nop 0
  buffer_load_dwordx4 v4, s[8:11], s45 offen offset:0 sc1 lds
  s_add_u32 m0, s44, 3072
  s_nop 0
  buffer_load_dwordx4 v4, s[8:11], s45 offen offset:1024 sc1 lds
  s_add_u32 m0, s44, 6144
  s_nop 0
  buffer_load_dwordx4 v4, s[8:11], s45 offen offset:2048 sc1 lds
  s_add_u32 m0, s44, 9216
  s_nop 0
  buffer_load_dwordx4 v4, s[8:11], s45 offen offset:3072 sc1 lds
  s_add_u32 s45, s45, 4096
  s_add_u32 m0, s44, 16384
  s_nop 0
  buffer_load_dwordx4 v4, s[8:11], s45 offen offset:0 sc1 lds
  s_add_u32 m0, s44, 19456
  s_nop 0
  buffer_load_dwordx4 v4, s[8:11], s45 offen offset:1024 sc1 lds
  s_add_u32 m0, s44, 22528
  s_nop 0
  buffer_load_dwordx4 v4, s[8:11], s45 offen offset:2048 sc1 lds
  s_add_u32 m0, s44, 25600
  s_nop 0
  buffer_load_dwordx4 v4, s[8:11], s45 offen offset:3072 sc1 lds
  s_add_u32 s45, s45, 4096
  s_add_u32 m0, s44, 32768
  s_nop 0
  buffer_load_dwordx4 v4, s[8:11], s45 offen offset:0 sc1 lds
  s_add_u32 m0, s44, 35840
  s_nop 0
  buffer_load_dwordx4 v4, s[8:11], s45 offen offset:1024 sc1 lds
  s_add_u32 m0, s44, 38912
  s_nop 0
  buffer_load_dwordx4 v4, s[8:11], s45 offen offset:2048 sc1 lds
  s_add_u32 m0, s44, 41984
  s_nop 0
  buffer_load_dwordx4 v4, s[8:11], s45 offen offset:3072 sc1 lds
  s_add_u32 s45, s45, 4096
  s_add_u32 m0, s44, 49152
  s_nop 0
  buffer_load_dwordx4 v4, s[8:11], s45 offen offset:0 sc1 lds
  s_add_u32 m0, s44, 52224
  s_nop 0
  buffer_load_dwordx4 v4, s[8:11], s45 offen offset:1024 sc1 lds
  s_add_u32 m0, s44, 55296
  s_nop 0
  buffer_load_dwordx4 v4, s[8:11], s45 offen offset:2048 sc1 lds
  s_add_u32 m0, s44, 58368
  s_nop 0
  buffer_load_dwordx4 v4, s[8:11], s45 offen offset:3072 sc1 lds
  s_add_u32 s45, s45, 4096
  s_add_u32 m0, s44, 65536
  s_nop 0
  buffer_load_dwordx4 v4, s[8:11], s45 offen offset:0 sc1 lds
  s_add_u32 m0, s44, 68608
  s_nop 0
  buffer_load_dwordx4 v4, s[8:11], s45 offen offset:1024 sc1 lds
  buffer_load_dword v7, off, s[8:11], s51 sc1
  s_mov_b32 s35, 0x3ae38e39
  s_mov_b32 s36, 0x3727c5ac
  s_waitcnt vmcnt(25)
  v_add_f32 v56, v56, v58
  v_add_f32 v57, v57, v59
  s_waitcnt vmcnt(23)
  v_add_f32 v60, v60, v62
  v_add_f32 v61, v61, v63
  s_waitcnt vmcnt(21)
  v_add_f32 v64, v64, v66
  v_add_f32 v65, v65, v67
  s_waitcnt vmcnt(19)
  v_add_f32 v68, v68, v70
  v_add_f32 v69, v69, v71
  v_mov_b32 v58, v56
  v_mov_b32 v59, v57
  v_mov_b32 v62, v60
  v_mov_b32 v63, v61
  v_mov_b32 v66, v64
  v_mov_b32 v67, v65
  v_mov_b32 v70, v68
  v_mov_b32 v71, v69
  v_permlane16_swap_b32 v56, v58
  v_permlane16_swap_b32 v57, v59
  v_permlane16_swap_b32 v60, v62
  v_permlane16_swap_b32 v61, v63
  v_permlane16_swap_b32 v64, v66
  v_permlane16_swap_b32 v65, v67
  v_permlane16_swap_b32 v68, v70
  v_permlane16_swap_b32 v69, v71
  v_add_f32 v56, v56, v58
  v_add_f32 v57, v57, v59
  v_add_f32 v60, v60, v62
  v_add_f32 v61, v61, v63
  v_add_f32 v64, v64, v66
  v_add_f32 v65, v65, v67
  v_add_f32 v68, v68, v70
  v_add_f32 v69, v69, v71
  v_mov_b32 v58, v56
  v_mov_b32 v59, v57
  v_mov_b32 v62, v60
  v_mov_b32 v63, v61
  v_mov_b32 v66, v64
  v_mov_b32 v67, v65
  v_mov_b32 v70, v68
  v_mov_b32 v71, v69
  v_permlane32_swap_b32 v56, v58
  v_permlane32_swap_b32 v57, v59
  v_permlane32_swap_b32 v60, v62
  v_permlane32_swap_b32 v61, v63
  v_permlane32_swap_b32 v64, v66
  v_permlane32_swap_b32 v65, v67
  v_permlane32_swap_b32 v68, v70
  v_permlane32_swap_b32 v69, v71
  v_add_f32 v56, v56, v58
  v_add_f32 v57, v57, v59
  v_add_f32 v60, v60, v62
  v_add_f32 v61, v61, v63
  v_add_f32 v64, v64, v66
  v_add_f32 v65, v65, v67
  v_add_f32 v68, v68, v70
  v_add_f32 v69, v69, v71
  v_mul_f32 v56, s35, v56
  v_mul_f32 v57, s35, v57
  v_fma_f32 v57, -v56, v56, v57
  v_max_f32 v57, 0, v57
  v_add_f32 v57, s36, v57
  v_rsq_f32 v32, v57
  v_mul_f32 v60, s35, v60
  v_mul_f32 v61, s35, v61
  v_fma_f32 v61, -v60, v60, v61
  v_max_f32 v61, 0, v61
  v_add_f32 v61, s36, v61
  v_rsq_f32 v33, v61
  v_mul_f32 v64, s35, v64
  v_mul_f32 v65, s35, v65
  v_fma_f32 v65, -v64, v64, v65
  v_max_f32 v65, 0, v65
  v_add_f32 v65, s36, v65
  v_rsq_f32 v34, v65
  v_mul_f32 v68, s35, v68
  v_mul_f32 v69, s35, v69
  v_fma_f32 v69, -v68, v68, v69
  v_max_f32 v69, 0, v69
  v_add_f32 v69, s36, v69
  v_rsq_f32 v35, v69
  v_mul_f32 v36, -v56, v32
  v_mul_f32 v37, -v60, v33
  v_mul_f32 v38, -v64, v34
  v_mul_f32 v39, -v68, v35
  s_waitcnt vmcnt(13)
  s_barrier
  ds_read_b128 a[0:3], v4 offset:0
  ds_read_b128 a[16:19], v4 offset:4096
  ds_read_b128 a[32:35], v4 offset:8192
  ds_read_b128 a[4:7], v4 offset:1024
  ds_read_b128 a[20:23], v4 offset:5120
  ds_read_b128 a[36:39], v4 offset:9216
  ds_read_b128 a[8:11], v4 offset:2048
  ds_read_b128 a[24:27], v4 offset:6144
  ds_read_b128 a[40:43], v4 offset:10240
  ds_read_b128 a[12:15], v4 offset:3072
  ds_read_b128 a[28:31], v4 offset:7168
  ds_read_b128 a[44:47], v4 offset:11264
  ds_read_b128 v[40:43], v12 offset:0
  ds_read_b128 v[44:47], v12 offset:16
  s_waitcnt lgkmcnt(8)
  v_mfma_f32_16x16x32_bf16 v[140:143], v[172:175], a[0:3], 0
  ds_read_b128 a[48:51], v4 offset:12288
  buffer_load_dwordx4 v[220:223], v25, s[12:15], s40 offen sc1
  v_mfma_f32_16x16x32_bf16 v[140:143], v[176:179], a[16:19], v[140:143]
  ds_read_b128 a[64:67], v4 offset:16384
  buffer_load_dwordx4 v[224:227], v26, s[12:15], s40 offen sc1
  v_mfma_f32_16x16x32_bf16 v[140:143], v[180:183], a[32:35], v[140:143]
  ds_read_b128 a[80:83], v4 offset:20480
  v_mfma_f32_16x16x32_bf16 v[144:147], v[172:175], a[4:7], 0
  ds_read_b128 a[52:55], v4 offset:13312
  buffer_load_dwordx4 v[228:231], v27, s[12:15], s40 offen sc1
  v_mfma_f32_16x16x32_bf16 v[144:147], v[176:179], a[20:23], v[144:147]
  ds_read_b128 a[68:71], v4 offset:17408
  s_add_u32 s40, s40, 12288
  v_mfma_f32_16x16x32_bf16 v[144:147], v[180:183], a[36:39], v[144:147]
  ds_read_b128 a[84:87], v4 offset:21504
  s_waitcnt lgkmcnt(8)
  v_mfma_f32_16x16x32_bf16 v[148:151], v[172:175], a[8:11], 0
  ds_read_b128 a[56:59], v4 offset:14336
  buffer_load_dwordx4 v[232:235], v25, s[12:15], s40 offen sc1
  v_mfma_f32_16x16x32_bf16 v[148:151], v[176:179], a[24:27], v[148:151]
  ds_read_b128 a[72:75], v4 offset:18432
  buffer_load_dwordx4 v[236:239], v26, s[12:15], s40 offen sc1
  v_mfma_f32_16x16x32_bf16 v[148:151], v[180:183], a[40:43], v[148:151]
  ds_read_b128 a[88:91], v4 offset:22528
  v_mfma_f32_16x16x32_bf16 v[152:155], v[172:175], a[12:15], 0
  ds_read_b128 a[60:63], v4 offset:15360
  buffer_load_dwordx4 v[240:243], v27, s[12:15], s40 offen sc1
  v_mfma_f32_16x16x32_bf16 v[152:155], v[176:179], a[28:31], v[152:155]
  ds_read_b128 a[76:79], v4 offset:19456
  s_add_u32 s40, s40, 12288
  v_mfma_f32_16x16x32_bf16 v[152:155], v[180:183], a[44:47], v[152:155]
  ds_read_b128 a[92:95], v4 offset:23552
  s_waitcnt lgkmcnt(6)
  v_mfma_f32_16x16x32_bf16 v[140:143], v[184:187], a[48:51], v[140:143]
  s_waitcnt vmcnt(13)
  s_barrier
  v_mfma_f32_16x16x32_bf16 v[140:143], v[188:191], a[64:67], v[140:143]
  ds_read_b128 a[96:99], v4 offset:24576
  v_mfma_f32_16x16x32_bf16 v[140:143], v[192:195], a[80:83], v[140:143]
  buffer_load_dwordx4 v[172:175], v25, s[12:15], s40 offen sc1
  ds_read_b128 a[112:115], v4 offset:28672
  v_mfma_f32_16x16x32_bf16 v[144:147], v[184:187], a[52:55], v[144:147]
  ds_read_b128 a[128:131], v4 offset:32768
  v_mfma_f32_16x16x32_bf16 v[144:147], v[188:191], a[68:71], v[144:147]
  ds_read_b128 a[100:103], v4 offset:25600
  buffer_load_dwordx4 v[176:179], v26, s[12:15], s40 offen sc1
  v_mfma_f32_16x16x32_bf16 v[144:147], v[192:195], a[84:87], v[144:147]
  ds_read_b128 a[116:119], v4 offset:29696
  s_waitcnt lgkmcnt(5)
  v_mfma_f32_16x16x32_bf16 v[148:151], v[184:187], a[56:59], v[148:151]
  ds_read_b128 a[132:135], v4 offset:33792
  ds_read_b128 a[104:107], v4 offset:26624
  v_mfma_f32_16x16x32_bf16 v[148:151], v[188:191], a[72:75], v[148:151]
  buffer_load_dwordx4 v[180:183], v27, s[12:15], s40 offen sc1
  v_mfma_f32_16x16x32_bf16 v[148:151], v[192:195], a[88:91], v[148:151]
  ds_read_b128 a[120:123], v4 offset:30720
  ds_read_b128 a[136:139], v4 offset:34816
  v_mfma_f32_16x16x32_bf16 v[152:155], v[184:187], a[60:63], v[152:155]
  ds_read_b128 a[108:111], v4 offset:27648
  v_mfma_f32_16x16x32_bf16 v[152:155], v[188:191], a[76:79], v[152:155]
  s_add_u32 s40, s40, 12288
  ds_read_b128 a[124:127], v4 offset:31744
  v_mfma_f32_16x16x32_bf16 v[152:155], v[192:195], a[92:95], v[152:155]
  ds_read_b128 a[140:143], v4 offset:35840
  s_waitcnt lgkmcnt(6)
  v_mfma_f32_16x16x32_bf16 v[140:143], v[196:199], a[96:99], v[140:143]
  ds_read_b128 a[144:147], v4 offset:36864
  buffer_load_dwordx4 v[184:187], v25, s[12:15], s40 offen sc1
  v_mfma_f32_16x16x32_bf16 v[140:143], v[200:203], a[112:115], v[140:143]
  ds_read_b128 a[160:163], v4 offset:40960
  v_mfma_f32_16x16x32_bf16 v[140:143], v[204:207], a[128:131], v[140:143]
  ds_read_b128 a[176:179], v4 offset:45056
  v_mfma_f32_16x16x32_bf16 v[144:147], v[196:199], a[100:103], v[144:147]
  ds_read_b128 a[148:151], v4 offset:37888
  buffer_load_dwordx4 v[188:191], v26, s[12:15], s40 offen sc1
  v_mfma_f32_16x16x32_bf16 v[144:147], v[200:203], a[116:119], v[144:147]
  ds_read_b128 a[164:167], v4 offset:41984
  v_mfma_f32_16x16x32_bf16 v[144:147], v[204:207], a[132:135], v[144:147]
  ds_read_b128 a[180:183], v4 offset:46080
  s_waitcnt lgkmcnt(6)
  v_mfma_f32_16x16x32_bf16 v[148:151], v[196:199], a[104:107], v[148:151]
  ds_read_b128 a[152:155], v4 offset:38912
  buffer_load_dwordx4 v[192:195], v27, s[12:15], s40 offen sc1
  v_mfma_f32_16x16x32_bf16 v[148:151], v[200:203], a[120:123], v[148:151]
  ds_read_b128 a[168:171], v4 offset:43008
  v_mfma_f32_16x16x32_bf16 v[148:151], v[204:207], a[136:139], v[148:151]
  ds_read_b128 a[184:187], v4 offset:47104
  v_mfma_f32_16x16x32_bf16 v[152:155], v[196:199], a[108:111], v[152:155]
  ds_read_b128 a[156:159], v4 offset:39936
  s_add_u32 s40, s40, 12288
  v_mfma_f32_16x16x32_bf16 v[152:155], v[200:203], a[124:127], v[152:155]
  ds_read_b128 a[172:175], v4 offset:44032
  v_mfma_f32_16x16x32_bf16 v[152:155], v[204:207], a[140:143], v[152:155]
  ds_read_b128 a[188:191], v4 offset:48128
  s_waitcnt lgkmcnt(6)
  v_mfma_f32_16x16x32_bf16 v[140:143], v[208:211], a[144:147], v[140:143]
  s_waitcnt vmcnt(13)
  s_barrier
  v_mfma_f32_16x16x32_bf16 v[140:143], v[212:215], a[160:163], v[140:143]
  ds_read_b128 a[192:195], v4 offset:49152
  v_mfma_f32_16x16x32_bf16 v[140:143], v[216:219], a[176:179], v[140:143]
  buffer_load_dwordx4 v[196:199], v25, s[12:15], s40 offen sc1
  ds_read_b128 a[208:211], v4 offset:53248
  v_mfma_f32_16x16x32_bf16 v[144:147], v[208:211], a[148:151], v[144:147]
  ds_read_b128 a[224:227], v4 offset:57344
  v_mfma_f32_16x16x32_bf16 v[144:147], v[212:215], a[164:167], v[144:147]
  ds_read_b128 a[196:199], v4 offset:50176
  buffer_load_dwordx4 v[200:203], v26, s[12:15], s40 offen sc1
  v_mfma_f32_16x16x32_bf16 v[144:147], v[216:219], a[180:183], v[144:147]
  ds_read_b128 a[212:215], v4 offset:54272
  s_waitcnt lgkmcnt(5)
  v_mfma_f32_16x16x32_bf16 v[148:151], v[208:211], a[152:155], v[148:151]
  ds_read_b128 a[228:231], v4 offset:58368
  ds_read_b128 a[200:203], v4 offset:51200
  v_mfma_f32_16x16x32_bf16 v[148:151], v[212:215], a[168:171], v[148:151]
  buffer_load_dwordx4 v[204:207], v27, s[12:15], s40 offen sc1
  v_mfma_f32_16x16x32_bf16 v[148:151], v[216:219], a[184:187], v[148:151]
  ds_read_b128 a[216:219], v4 offset:55296
  ds_read_b128 a[232:235], v4 offset:59392
  v_mfma_f32_16x16x32_bf16 v[152:155], v[208:211], a[156:159], v[152:155]
  ds_read_b128 a[204:207], v4 offset:52224
  v_mfma_f32_16x16x32_bf16 v[152:155], v[212:215], a[172:175], v[152:155]
  s_add_u32 s40, s40, 12288
  ds_read_b128 a[220:223], v4 offset:56320
  v_mfma_f32_16x16x32_bf16 v[152:155], v[216:219], a[188:191], v[152:155]
  ds_read_b128 a[236:239], v4 offset:60416
  s_waitcnt vmcnt(12)
  s_waitcnt lgkmcnt(6)
  v_mfma_f32_16x16x32_bf16 v[140:143], v[220:223], a[192:195], v[140:143]
  ds_read_b128 a[240:243], v4 offset:61440
  buffer_load_dwordx4 v[208:211], v25, s[12:15], s40 offen sc1
  v_mfma_f32_16x16x32_bf16 v[140:143], v[224:227], a[208:211], v[140:143]
  ds_read_b128 v[72:75], v9 offset:0
  v_mfma_f32_16x16x32_bf16 v[140:143], v[228:231], a[224:227], v[140:143]
  ds_read_b128 v[88:91], v9 offset:4096
  v_mfma_f32_16x16x32_bf16 v[144:147], v[220:223], a[196:199], v[144:147]
  ds_read_b128 a[244:247], v4 offset:62464
  buffer_load_dwordx4 v[212:215], v26, s[12:15], s40 offen sc1
  v_mfma_f32_16x16x32_bf16 v[144:147], v[224:227], a[212:215], v[144:147]
  ds_read_b128 v[76:79], v9 offset:1024
  v_mfma_f32_16x16x32_bf16 v[144:147], v[228:231], a[228:231], v[144:147]
  ds_read_b128 v[92:95], v9 offset:5120
  s_waitcnt lgkmcnt(6)
  v_mfma_f32_16x16x32_bf16 v[148:151], v[220:223], a[200:203], v[148:151]
  ds_read_b128 a[248:251], v4 offset:63488
  buffer_load_dwordx4 v[216:219], v27, s[12:15], s40 offen sc1
  v_mfma_f32_16x16x32_bf16 v[148:151], v[224:227], a[216:219], v[148:151]
  ds_read_b128 v[80:83], v9 offset:2048
  v_mfma_f32_16x16x32_bf16 v[148:151], v[228:231], a[232:235], v[148:151]
  ds_read_b128 v[96:99], v9 offset:6144
  v_mfma_f32_16x16x32_bf16 v[152:155], v[220:223], a[204:207], v[152:155]
  ds_read_b128 a[252:255], v4 offset:64512
  s_add_u32 s40, s40, 12288
  v_mfma_f32_16x16x32_bf16 v[152:155], v[224:227], a[220:223], v[152:155]
  ds_read_b128 v[84:87], v9 offset:3072
  v_mfma_f32_16x16x32_bf16 v[152:155], v[228:231], a[236:239], v[152:155]
  ds_read_b128 v[100:103], v9 offset:7168
  s_waitcnt vmcnt(12)
  s_waitcnt lgkmcnt(6)
  v_mfma_f32_16x16x32_bf16 v[140:143], v[232:235], a[240:243], v[140:143]
  buffer_load_dwordx4 v[220:223], v25, s[12:15], s40 offen sc1
  v_mfma_f32_16x16x32_bf16 v[140:143], v[236:239], v[72:75], v[140:143]
  v_mfma_f32_16x16x32_bf16 v[140:143], v[240:243], v[88:91], v[140:143]
  v_mfma_f32_16x16x32_bf16 v[144:147], v[232:235], a[244:247], v[144:147]
  v_mfma_f32_16x16x32_bf16 v[144:147], v[236:239], v[76:79], v[144:147]
  buffer_load_dwordx4 v[224:227], v26, s[12:15], s40 offen sc1
  v_mfma_f32_16x16x32_bf16 v[144:147], v[240:243], v[92:95], v[144:147]
  s_waitcnt lgkmcnt(0)
  v_mfma_f32_16x16x32_bf16 v[148:151], v[232:235], a[248:251], v[148:151]
  v_mfma_f32_16x16x32_bf16 v[148:151], v[236:239], v[80:83], v[148:151]
  v_mfma_f32_16x16x32_bf16 v[148:151], v[240:243], v[96:99], v[148:151]
  buffer_load_dwordx4 v[228:231], v27, s[12:15], s40 offen sc1
  v_mfma_f32_16x16x32_bf16 v[152:155], v[232:235], a[252:255], v[152:155]
  s_add_u32 s40, s40, 12288
  v_mfma_f32_16x16x32_bf16 v[152:155], v[236:239], v[84:87], v[152:155]
  v_mfma_f32_16x16x32_bf16 v[152:155], v[240:243], v[100:103], v[152:155]
  v_readfirstlane_b32 s35, v7
  s_nop 1
  s_cmp_ge_u32 s35, 32
  s_cbranch_scc0 L_kf_go3
  L_kf_ok3:
  s_waitcnt lgkmcnt(0)
  s_barrier
  s_mov_b32 s42, 0
L_kf_p1:
  s_waitcnt vmcnt(12)
  v_mfma_f32_16x16x32_bf16 v[156:159], v[172:175], a[0:3], 0
  buffer_load_dwordx4 v[232:235], v25, s[12:15], s40 offen sc1
  v_mfma_f32_16x16x32_bf16 v[156:159], v[176:179], a[16:19], v[156:159]
  v_mfma_f32_16x16x32_bf16 v[156:159], v[180:183], a[32:35], v[156:159]
  v_mfma_f32_16x16x32_bf16 v[160:163], v[172:175], a[4:7], 0
  v_mfma_f32_16x16x32_bf16 v[160:163], v[176:179], a[20:23], v[160:163]
  buffer_load_dwordx4 v[236:239], v26, s[12:15], s40 offen sc1
  s_waitcnt lgkmcnt(1)
  v_fma_f32 v48, v36, v40, v44
  v_mfma_f32_16x16x32_bf16 v[160:163], v[180:183], a[36:39], v[160:163]
  v_fma_f32 v49, v36, v41, v45
  v_mfma_f32_16x16x32_bf16 v[164:167], v[172:175], a[8:11], 0
  v_fma_f32 v50, v36, v42, v46
  v_fma_f32 v51, v36, v43, v47
  v_mfma_f32_16x16x32_bf16 v[164:167], v[176:179], a[24:27], v[164:167]
  v_fma_f32 v48, v140, v32, v48
  v_mfma_f32_16x16x32_bf16 v[164:167], v[180:183], a[40:43], v[164:167]
  buffer_load_dwordx4 v[240:243], v27, s[12:15], s40 offen sc1
  v_fma_f32 v49, v141, v32, v49
  v_mfma_f32_16x16x32_bf16 v[168:171], v[172:175], a[12:15], 0
  s_add_u32 s40, s40, 12288
  v_mfma_f32_16x16x32_bf16 v[168:171], v[176:179], a[28:31], v[168:171]
  v_fma_f32 v50, v142, v32, v50
  v_fma_f32 v51, v143, v32, v51
  v_mfma_f32_16x16x32_bf16 v[168:171], v[180:183], a[44:47], v[168:171]
  s_waitcnt vmcnt(12)
  v_mfma_f32_16x16x32_bf16 v[156:159], v[184:187], a[48:51], v[156:159]
  buffer_load_dwordx4 v[172:175], v25, s[12:15], s40 offen sc1
  v_mul_f32 v48, v48, abs(v48)
  v_mfma_f32_16x16x32_bf16 v[156:159], v[188:191], a[64:67], v[156:159]
  v_mul_f32 v49, v49, abs(v49)
  v_mfma_f32_16x16x32_bf16 v[156:159], v[192:195], a[80:83], v[156:159]
  v_mul_f32 v50, v50, abs(v50)
  v_mul_f32 v51, v51, abs(v51)
  v_mfma_f32_16x16x32_bf16 v[160:163], v[184:187], a[52:55], v[160:163]
  v_cvt_pk_bf16_f32 v48, v48, v49
  v_mfma_f32_16x16x32_bf16 v[160:163], v[188:191], a[68:71], v[160:163]
  buffer_load_dwordx4 v[176:179], v26, s[12:15], s40 offen sc1
  v_cvt_pk_bf16_f32 v49, v50, v51
  v_mfma_f32_16x16x32_bf16 v[160:163], v[192:195], a[84:87], v[160:163]
  v_pk_max_i16 v48, v48, 0
  v_mfma_f32_16x16x32_bf16 v[164:167], v[184:187], a[56:59], v[164:167]
  v_pk_max_i16 v49, v49, 0
  v_mfma_f32_16x16x32_bf16 v[164:167], v[188:191], a[72:75], v[164:167]
  ds_write_b64 v10, v[48:49] offset:0
  v_fma_f32 v52, v37, v40, v44
  v_mfma_f32_16x16x32_bf16 v[164:167], v[192:195], a[88:91], v[164:167]
  buffer_load_dwordx4 v[180:183], v27, s[12:15], s40 offen sc1
  v_mfma_f32_16x16x32_bf16 v[168:171], v[184:187], a[60:63], v[168:171]
  s_add_u32 s40, s40, 12288
  v_fma_f32 v53, v37, v41, v45
  v_mfma_f32_16x16x32_bf16 v[168:171], v[188:191], a[76:79], v[168:171]
  v_fma_f32 v54, v37, v42, v46
  v_mfma_f32_16x16x32_bf16 v[168:171], v[192:195], a[92:95], v[168:171]
  v_fma_f32 v55, v37, v43, v47
  s_waitcnt vmcnt(12)
  v_mfma_f32_16x16x32_bf16 v[156:159], v[196:199], a[96:99], v[156:159]
  buffer_load_dwordx4 v[184:187], v25, s[12:15], s40 offen sc1
  v_fma_f32 v52, v144, v33, v52
  v_mfma_f32_16x16x32_bf16 v[156:159], v[200:203], a[112:115], v[156:159]
  v_fma_f32 v53, v145, v33, v53
  v_mfma_f32_16x16x32_bf16 v[156:159], v[204:207], a[128:131], v[156:159]
  v_fma_f32 v54, v146, v33, v54
  v_mfma_f32_16x16x32_bf16 v[160:163], v[196:199], a[100:103], v[160:163]
  v_fma_f32 v55, v147, v33, v55
  v_mul_f32 v52, v52, abs(v52)
  v_mfma_f32_16x16x32_bf16 v[160:163], v[200:203], a[116:119], v[160:163]
  buffer_load_dwordx4 v[188:191], v26, s[12:15], s40 offen sc1
  v_mfma_f32_16x16x32_bf16 v[160:163], v[204:207], a[132:135], v[160:163]
  v_mul_f32 v53, v53, abs(v53)
  v_mul_f32 v54, v54, abs(v54)
  v_mfma_f32_16x16x32_bf16 v[164:167], v[196:199], a[104:107], v[164:167]
  v_mul_f32 v55, v55, abs(v55)
  v_mfma_f32_16x16x32_bf16 v[164:167], v[200:203], a[120:123], v[164:167]
  v_cvt_pk_bf16_f32 v52, v52, v53
  v_mfma_f32_16x16x32_bf16 v[164:167], v[204:207], a[136:139], v[164:167]
  buffer_load_dwordx4 v[192:195], v27, s[12:15], s40 offen sc1
  v_cvt_pk_bf16_f32 v53, v54, v55
  v_mfma_f32_16x16x32_bf16 v[168:171], v[196:199], a[108:111], v[168:171]
  s_add_u32 s40, s40, 12288
  v_pk_max_i16 v52, v52, 0
  v_mfma_f32_16x16x32_bf16 v[168:171], v[200:203], a[124:127], v[168:171]
  v_pk_max_i16 v53, v53, 0
  v_mfma_f32_16x16x32_bf16 v[168:171], v[204:207], a[140:143], v[168:171]
  ds_write_b64 v10, v[52:53] offset:1024
  s_waitcnt vmcnt(12)
  v_mfma_f32_16x16x32_bf16 v[156:159], v[208:211], a[144:147], v[156:159]
  buffer_load_dwordx4 v[196:199], v25, s[12:15], s40 offen sc1
  v_mfma_f32_16x16x32_bf16 v[156:159], v[212:215], a[160:163], v[156:159]
  v_fma_f32 v48, v38, v40, v44
  v_fma_f32 v49, v38, v41, v45
  v_mfma_f32_16x16x32_bf16 v[156:159], v[216:219], a[176:179], v[156:159]
  v_fma_f32 v50, v38, v42, v46
  v_mfma_f32_16x16x32_bf16 v[160:163], v[208:211], a[148:151], v[160:163]
  v_fma_f32 v51, v38, v43, v47
  v_mfma_f32_16x16x32_bf16 v[160:163], v[212:215], a[164:167], v[160:163]
  buffer_load_dwordx4 v[200:203], v26, s[12:15], s40 offen sc1
  v_fma_f32 v48, v148, v34, v48
  v_mfma_f32_16x16x32_bf16 v[160:163], v[216:219], a[180:183], v[160:163]
  v_fma_f32 v49, v149, v34, v49
  v_mfma_f32_16x16x32_bf16 v[164:167], v[208:211], a[152:155], v[164:167]
  v_fma_f32 v50, v150, v34, v50
  v_fma_f32 v51, v151, v34, v51
  v_mfma_f32_16x16x32_bf16 v[164:167], v[212:215], a[168:171], v[164:167]
  v_mul_f32 v48, v48, abs(v48)
  v_mfma_f32_16x16x32_bf16 v[164:167], v[216:219], a[184:187], v[164:167]
  buffer_load_dwordx4 v[204:207], v27, s[12:15], s40 offen sc1
  v_mul_f32 v49, v49, abs(v49)
  v_mfma_f32_16x16x32_bf16 v[168:171], v[208:211], a[156:159], v[168:171]
  s_add_u32 s40, s40, 12288
  v_mfma_f32_16x16x32_bf16 v[168:171], v[212:215], a[172:175], v[168:171]
  v_mul_f32 v50, v50, abs(v50)
  v_mul_f32 v51, v51, abs(v51)
  v_mfma_f32_16x16x32_bf16 v[168:171], v[216:219], a[188:191], v[168:171]
  s_waitcnt vmcnt(12)
  v_mfma_f32_16x16x32_bf16 v[156:159], v[220:223], a[192:195], v[156:159]
  buffer_load_dwordx4 v[208:211], v25, s[12:15], s40 offen sc1
  v_cvt_pk_bf16_f32 v48, v48, v49
  v_mfma_f32_16x16x32_bf16 v[156:159], v[224:227], a[208:211], v[156:159]
  v_cvt_pk_bf16_f32 v49, v50, v51
  v_mfma_f32_16x16x32_bf16 v[156:159], v[228:231], a[224:227], v[156:159]
  v_pk_max_i16 v48, v48, 0
  v_pk_max_i16 v49, v49, 0
  v_mfma_f32_16x16x32_bf16 v[160:163], v[220:223], a[196:199], v[160:163]
  ds_write_b64 v10, v[48:49] offset:2048
  v_mfma_f32_16x16x32_bf16 v[160:163], v[224:227], a[212:215], v[160:163]
  buffer_load_dwordx4 v[212:215], v26, s[12:15], s40 offen sc1
  v_fma_f32 v52, v39, v40, v44
  v_mfma_f32_16x16x32_bf16 v[160:163], v[228:231], a[228:231], v[160:163]
  v_fma_f32 v53, v39, v41, v45
  v_mfma_f32_16x16x32_bf16 v[164:167], v[220:223], a[200:203], v[164:167]
  v_fma_f32 v54, v39, v42, v46
  v_mfma_f32_16x16x32_bf16 v[164:167], v[224:227], a[216:219], v[164:167]
  v_fma_f32 v55, v39, v43, v47
  ds_read_b128 v[40:43], v12 offset:128
  v_mfma_f32_16x16x32_bf16 v[164:167], v[228:231], a[232:235], v[164:167]
  buffer_load_dwordx4 v[216:219], v27, s[12:15], s40 offen sc1
  v_mfma_f32_16x16x32_bf16 v[168:171], v[220:223], a[204:207], v[168:171]
  s_add_u32 s40, s40, 12288
  ds_read_b128 v[44:47], v12 offset:144
  v_mfma_f32_16x16x32_bf16 v[168:171], v[224:227], a[220:223], v[168:171]
  v_fma_f32 v52, v152, v35, v52
  v_mfma_f32_16x16x32_bf16 v[168:171], v[228:231], a[236:239], v[168:171]
  v_fma_f32 v53, v153, v35, v53
  s_waitcnt vmcnt(12)
  v_mfma_f32_16x16x32_bf16 v[156:159], v[232:235], a[240:243], v[156:159]
  buffer_load_dwordx4 v[220:223], v25, s[12:15], s40 offen sc1
  v_fma_f32 v54, v154, v35, v54
  v_mfma_f32_16x16x32_bf16 v[156:159], v[236:239], v[72:75], v[156:159]
  v_fma_f32 v55, v155, v35, v55
  v_mfma_f32_16x16x32_bf16 v[156:159], v[240:243], v[88:91], v[156:159]
  v_mul_f32 v52, v52, abs(v52)
  v_mfma_f32_16x16x32_bf16 v[160:163], v[232:235], a[244:247], v[160:163]
  v_mul_f32 v53, v53, abs(v53)
  v_mul_f32 v54, v54, abs(v54)
  v_mfma_f32_16x16x32_bf16 v[160:163], v[236:239], v[76:79], v[160:163]
  buffer_load_dwordx4 v[224:227], v26, s[12:15], s40 offen sc1
  v_mfma_f32_16x16x32_bf16 v[160:163], v[240:243], v[92:95], v[160:163]
  v_mul_f32 v55, v55, abs(v55)
  v_cvt_pk_bf16_f32 v52, v52, v53
  v_mfma_f32_16x16x32_bf16 v[164:167], v[232:235], a[248:251], v[164:167]
  v_cvt_pk_bf16_f32 v53, v54, v55
  v_mfma_f32_16x16x32_bf16 v[164:167], v[236:239], v[80:83], v[164:167]
  v_pk_max_i16 v52, v52, 0
  v_mfma_f32_16x16x32_bf16 v[164:167], v[240:243], v[96:99], v[164:167]
  buffer_load_dwordx4 v[228:231], v27, s[12:15], s40 offen sc1
  v_pk_max_i16 v53, v53, 0
  v_mfma_f32_16x16x32_bf16 v[168:171], v[232:235], a[252:255], v[168:171]
  s_add_u32 s40, s40, 12288
  ds_write_b64 v10, v[52:53] offset:3072
  v_mfma_f32_16x16x32_bf16 v[168:171], v[236:239], v[84:87], v[168:171]
  v_add_u32 v10, 0x1000, v10
  v_mfma_f32_16x16x32_bf16 v[168:171], v[240:243], v[100:103], v[168:171]
  s_waitcnt vmcnt(12)
  v_mfma_f32_16x16x32_bf16 v[140:143], v[172:175], a[0:3], 0
  buffer_load_dwordx4 v[232:235], v25, s[12:15], s40 offen sc1
  v_mfma_f32_16x16x32_bf16 v[140:143], v[176:179], a[16:19], v[140:143]
  v_mfma_f32_16x16x32_bf16 v[140:143], v[180:183], a[32:35], v[140:143]
  v_mfma_f32_16x16x32_bf16 v[144:147], v[172:175], a[4:7], 0
  v_mfma_f32_16x16x32_bf16 v[144:147], v[176:179], a[20:23], v[144:147]
  buffer_load_dwordx4 v[236:239], v26, s[12:15], s40 offen sc1
  s_waitcnt lgkmcnt(1)
  v_fma_f32 v48, v36, v40, v44
  v_mfma_f32_16x16x32_bf16 v[144:147], v[180:183], a[36:39], v[144:147]
  v_fma_f32 v49, v36, v41, v45
  v_fma_f32 v50, v36, v42, v46
  v_mfma_f32_16x16x32_bf16 v[148:151], v[172:175], a[8:11], 0
  v_fma_f32 v51, v36, v43, v47
  v_mfma_f32_16x16x32_bf16 v[148:151], v[176:179], a[24:27], v[148:151]
  v_fma_f32 v48, v156, v32, v48
  v_mfma_f32_16x16x32_bf16 v[148:151], v[180:183], a[40:43], v[148:151]
  buffer_load_dwordx4 v[240:243], v27, s[12:15], s40 offen sc1
  v_fma_f32 v49, v157, v32, v49
  v_mfma_f32_16x16x32_bf16 v[152:155], v[172:175], a[12:15], 0
  s_add_u32 s40, s40, 12288
  v_fma_f32 v50, v158, v32, v50
  v_mfma_f32_16x16x32_bf16 v[152:155], v[176:179], a[28:31], v[152:155]
  v_fma_f32 v51, v159, v32, v51
  v_mfma_f32_16x16x32_bf16 v[152:155], v[180:183], a[44:47], v[152:155]
  v_mul_f32 v48, v48, abs(v48)
  s_waitcnt vmcnt(12)
  v_mfma_f32_16x16x32_bf16 v[140:143], v[184:187], a[48:51], v[140:143]
  buffer_load_dwordx4 v[172:175], v25, s[12:15], s40 offen sc1
  v_mfma_f32_16x16x32_bf16 v[140:143], v[188:191], a[64:67], v[140:143]
  v_mul_f32 v49, v49, abs(v49)
  v_mul_f32 v50, v50, abs(v50)
  v_mfma_f32_16x16x32_bf16 v[140:143], v[192:195], a[80:83], v[140:143]
  v_mul_f32 v51, v51, abs(v51)
  v_mfma_f32_16x16x32_bf16 v[144:147], v[184:187], a[52:55], v[144:147]
  v_cvt_pk_bf16_f32 v48, v48, v49
  v_mfma_f32_16x16x32_bf16 v[144:147], v[188:191], a[68:71], v[144:147]
  buffer_load_dwordx4 v[176:179], v26, s[12:15], s40 offen sc1
  v_cvt_pk_bf16_f32 v49, v50, v51
  v_mfma_f32_16x16x32_bf16 v[144:147], v[192:195], a[84:87], v[144:147]
  v_pk_max_i16 v48, v48, 0
  v_mfma_f32_16x16x32_bf16 v[148:151], v[184:187], a[56:59], v[148:151]
  v_pk_max_i16 v49, v49, 0
  ds_write_b64 v11, v[48:49] offset:0
  v_mfma_f32_16x16x32_bf16 v[148:151], v[188:191], a[72:75], v[148:151]
  v_fma_f32 v52, v37, v40, v44
  v_mfma_f32_16x16x32_bf16 v[148:151], v[192:195], a[88:91], v[148:151]
  buffer_load_dwordx4 v[180:183], v27, s[12:15], s40 offen sc1
  v_fma_f32 v53, v37, v41, v45
  v_mfma_f32_16x16x32_bf16 v[152:155], v[184:187], a[60:63], v[152:155]
  s_add_u32 s40, s40, 12288
  v_mfma_f32_16x16x32_bf16 v[152:155], v[188:191], a[76:79], v[152:155]
  v_fma_f32 v54, v37, v42, v46
  v_fma_f32 v55, v37, v43, v47
  v_mfma_f32_16x16x32_bf16 v[152:155], v[192:195], a[92:95], v[152:155]
  s_waitcnt vmcnt(12)
  v_mfma_f32_16x16x32_bf16 v[140:143], v[196:199], a[96:99], v[140:143]
  buffer_load_dwordx4 v[184:187], v25, s[12:15], s40 offen sc1
  v_fma_f32 v52, v160, v33, v52
  v_mfma_f32_16x16x32_bf16 v[140:143], v[200:203], a[112:115], v[140:143]
  v_fma_f32 v53, v161, v33, v53
  v_mfma_f32_16x16x32_bf16 v[140:143], v[204:207], a[128:131], v[140:143]
  v_fma_f32 v54, v162, v33, v54
  v_fma_f32 v55, v163, v33, v55
  v_mfma_f32_16x16x32_bf16 v[144:147], v[196:199], a[100:103], v[144:147]
  v_mul_f32 v52, v52, abs(v52)
  v_mfma_f32_16x16x32_bf16 v[144:147], v[200:203], a[116:119], v[144:147]
  buffer_load_dwordx4 v[188:191], v26, s[12:15], s40 offen sc1
  v_mul_f32 v53, v53, abs(v53)
  v_mfma_f32_16x16x32_bf16 v[144:147], v[204:207], a[132:135], v[144:147]
  v_mul_f32 v54, v54, abs(v54)
  v_mfma_f32_16x16x32_bf16 v[148:151], v[196:199], a[104:107], v[148:151]
  v_mul_f32 v55, v55, abs(v55)
  v_mfma_f32_16x16x32_bf16 v[148:151], v[200:203], a[120:123], v[148:151]
  v_cvt_pk_bf16_f32 v52, v52, v53
  v_cvt_pk_bf16_f32 v53, v54, v55
  v_mfma_f32_16x16x32_bf16 v[148:151], v[204:207], a[136:139], v[148:151]
  buffer_load_dwordx4 v[192:195], v27, s[12:15], s40 offen sc1
  v_mfma_f32_16x16x32_bf16 v[152:155], v[196:199], a[108:111], v[152:155]
  s_add_u32 s40, s40, 12288
  v_pk_max_i16 v52, v52, 0
  v_mfma_f32_16x16x32_bf16 v[152:155], v[200:203], a[124:127], v[152:155]
  v_pk_max_i16 v53, v53, 0
  v_mfma_f32_16x16x32_bf16 v[152:155], v[204:207], a[140:143], v[152:155]
  ds_write_b64 v11, v[52:53] offset:1024
  s_waitcnt vmcnt(12)
  v_mfma_f32_16x16x32_bf16 v[140:143], v[208:211], a[144:147], v[140:143]
  buffer_load_dwordx4 v[196:199], v25, s[12:15], s40 offen sc1
  v_fma_f32 v48, v38, v40, v44
  v_mfma_f32_16x16x32_bf16 v[140:143], v[212:215], a[160:163], v[140:143]
  v_fma_f32 v49, v38, v41, v45
  v_mfma_f32_16x16x32_bf16 v[140:143], v[216:219], a[176:179], v[140:143]
  v_fma_f32 v50, v38, v42, v46
  v_fma_f32 v51, v38, v43, v47
  v_mfma_f32_16x16x32_bf16 v[144:147], v[208:211], a[148:151], v[144:147]
  v_fma_f32 v48, v164, v34, v48
  v_mfma_f32_16x16x32_bf16 v[144:147], v[212:215], a[164:167], v[144:147]
  buffer_load_dwordx4 v[200:203], v26, s[12:15], s40 offen sc1
  v_fma_f32 v49, v165, v34, v49
  v_mfma_f32_16x16x32_bf16 v[144:147], v[216:219], a[180:183], v[144:147]
  v_fma_f32 v50, v166, v34, v50
  v_mfma_f32_16x16x32_bf16 v[148:151], v[208:211], a[152:155], v[148:151]
  v_fma_f32 v51, v167, v34, v51
  v_mfma_f32_16x16x32_bf16 v[148:151], v[212:215], a[168:171], v[148:151]
  v_mul_f32 v48, v48, abs(v48)
  v_mul_f32 v49, v49, abs(v49)
  v_mfma_f32_16x16x32_bf16 v[148:151], v[216:219], a[184:187], v[148:151]
  buffer_load_dwordx4 v[204:207], v27, s[12:15], s40 offen sc1
  v_mfma_f32_16x16x32_bf16 v[152:155], v[208:211], a[156:159], v[152:155]
  s_add_u32 s40, s40, 12288
  v_mul_f32 v50, v50, abs(v50)
  v_mfma_f32_16x16x32_bf16 v[152:155], v[212:215], a[172:175], v[152:155]
  v_mul_f32 v51, v51, abs(v51)
  v_mfma_f32_16x16x32_bf16 v[152:155], v[216:219], a[188:191], v[152:155]
  v_cvt_pk_bf16_f32 v48, v48, v49
  s_waitcnt vmcnt(12)
  v_mfma_f32_16x16x32_bf16 v[140:143], v[220:223], a[192:195], v[140:143]
  buffer_load_dwordx4 v[208:211], v25, s[12:15], s40 offen sc1
  v_cvt_pk_bf16_f32 v49, v50, v51
  v_mfma_f32_16x16x32_bf16 v[140:143], v[224:227], a[208:211], v[140:143]
  v_pk_max_i16 v48, v48, 0
  v_mfma_f32_16x16x32_bf16 v[140:143], v[228:231], a[224:227], v[140:143]
  v_pk_max_i16 v49, v49, 0
  v_mfma_f32_16x16x32_bf16 v[144:147], v[220:223], a[196:199], v[144:147]
  ds_write_b64 v11, v[48:49] offset:2048
  v_fma_f32 v52, v39, v40, v44
  v_mfma_f32_16x16x32_bf16 v[144:147], v[224:227], a[212:215], v[144:147]
  buffer_load_dwordx4 v[212:215], v26, s[12:15], s40 offen sc1
  v_mfma_f32_16x16x32_bf16 v[144:147], v[228:231], a[228:231], v[144:147]
  v_fma_f32 v53, v39, v41, v45
  v_fma_f32 v54, v39, v42, v46
  v_mfma_f32_16x16x32_bf16 v[148:151], v[220:223], a[200:203], v[148:151]
  v_fma_f32 v55, v39, v43, v47
  v_mfma_f32_16x16x32_bf16 v[148:151], v[224:227], a[216:219], v[148:151]
  ds_read_b128 v[40:43], v12 offset:256
  v_mfma_f32_16x16x32_bf16 v[148:151], v[228:231], a[232:235], v[148:151]
  buffer_load_dwordx4 v[216:219], v27, s[12:15], s40 offen sc1
  ds_read_b128 v[44:47], v12 offset:272
  v_mfma_f32_16x16x32_bf16 v[152:155], v[220:223], a[204:207], v[152:155]
  s_add_u32 s40, s40, 12288
  v_fma_f32 v52, v168, v35, v52
  v_mfma_f32_16x16x32_bf16 v[152:155], v[224:227], a[220:223], v[152:155]
  v_fma_f32 v53, v169, v35, v53
  v_mfma_f32_16x16x32_bf16 v[152:155], v[228:231], a[236:239], v[152:155]
  v_fma_f32 v54, v170, v35, v54
  s_waitcnt vmcnt(12)
  v_mfma_f32_16x16x32_bf16 v[140:143], v[232:235], a[240:243], v[140:143]
  buffer_load_dwordx4 v[220:223], v25, s[12:15], s40 offen sc1
  v_mfma_f32_16x16x32_bf16 v[140:143], v[236:239], v[72:75], v[140:143]
  v_fma_f32 v55, v171, v35, v55
  v_mul_f32 v52, v52, abs(v52)
  v_mfma_f32_16x16x32_bf16 v[140:143], v[240:243], v[88:91], v[140:143]
  v_mul_f32 v53, v53, abs(v53)
  v_mfma_f32_16x16x32_bf16 v[144:147], v[232:235], a[244:247], v[144:147]
  v_mul_f32 v54, v54, abs(v54)
  v_mfma_f32_16x16x32_bf16 v[144:147], v[236:239], v[76:79], v[144:147]
  buffer_load_dwordx4 v[224:227], v26, s[12:15], s40 offen sc1
  v_mul_f32 v55, v55, abs(v55)
  v_mfma_f32_16x16x32_bf16 v[144:147], v[240:243], v[92:95], v[144:147]
  v_cvt_pk_bf16_f32 v52, v52, v53
  v_mfma_f32_16x16x32_bf16 v[148:151], v[232:235], a[248:251], v[148:151]
  v_cvt_pk_bf16_f32 v53, v54, v55
  v_pk_max_i16 v52, v52, 0
  v_mfma_f32_16x16x32_bf16 v[148:151], v[236:239], v[80:83], v[148:151]
  v_pk_max_i16 v53, v53, 0
  v_mfma_f32_16x16x32_bf16 v[148:151], v[240:243], v[96:99], v[148:151]
  buffer_load_dwordx4 v[228:231], v27, s[12:15], s40 offen sc1
  ds_write_b64 v11, v[52:53] offset:3072
  v_mfma_f32_16x16x32_bf16 v[152:155], v[232:235], a[252:255], v[152:155]
  s_add_u32 s40, s40, 12288
  v_mfma_f32_16x16x32_bf16 v[152:155], v[236:239], v[84:87], v[152:155]
  v_add_u32 v11, 0x1000, v11
  v_add_u32 v12, 0x100, v12
  v_mfma_f32_16x16x32_bf16 v[152:155], v[240:243], v[100:103], v[152:155]
  s_add_u32 s42, s42, 1
  s_cmp_lt_u32 s42, 4
  s_cbranch_scc1 L_kf_p1
  s_waitcnt lgkmcnt(0)
  s_barrier
  s_mov_b32 s47, 0x7fff7ff0
  ds_read_b128 a[0:3], v4 offset:0
  ds_read_b128 a[16:19], v4 offset:4096
  ds_read_b128 a[32:35], v4 offset:8192
  ds_read_b128 a[4:7], v4 offset:1024
  ds_read_b128 a[20:23], v4 offset:5120
  ds_read_b128 a[36:39], v4 offset:9216
  ds_read_b128 a[8:11], v4 offset:2048
  ds_read_b128 a[24:27], v4 offset:6144
  ds_read_b128 a[40:43], v4 offset:10240
  ds_read_b128 a[12:15], v4 offset:3072
  ds_read_b128 a[28:31], v4 offset:7168
  ds_read_b128 a[44:47], v4 offset:11264
  s_waitcnt vmcnt(12)
  s_waitcnt lgkmcnt(6)
  v_mfma_f32_16x16x32_bf16 v[156:159], v[172:175], a[0:3], 0
  ds_read_b128 a[48:51], v4 offset:12288
  buffer_load_dwordx4 v[232:235], v25, s[12:15], s40 offen sc1
  v_mfma_f32_16x16x32_bf16 v[156:159], v[176:179], a[16:19], v[156:159]
  ds_read_b128 a[64:67], v4 offset:20480
  v_mfma_f32_16x16x32_bf16 v[156:159], v[180:183], a[32:35], v[156:159]
  ds_read_b128 a[80:83], v4 offset:24576
  v_mfma_f32_16x16x32_bf16 v[160:163], v[172:175], a[4:7], 0
  ds_read_b128 a[52:55], v4 offset:13312
  buffer_load_dwordx4 v[236:239], v26, s[12:15], s40 offen sc1
  v_mfma_f32_16x16x32_bf16 v[160:163], v[176:179], a[20:23], v[160:163]
  ds_read_b128 a[68:71], v4 offset:21504
  v_fma_f32 v48, v36, v40, v44
  v_mfma_f32_16x16x32_bf16 v[160:163], v[180:183], a[36:39], v[160:163]
  ds_read_b128 a[84:87], v4 offset:25600
  v_fma_f32 v49, v36, v41, v45
  v_fma_f32 v50, v36, v42, v46
  s_waitcnt lgkmcnt(6)
  v_mfma_f32_16x16x32_bf16 v[164:167], v[172:175], a[8:11], 0
  ds_read_b128 a[56:59], v4 offset:14336
  buffer_load_dwordx4 v[240:243], v27, s[12:15], s40 offen sc1
  v_fma_f32 v51, v36, v43, v47
  v_mfma_f32_16x16x32_bf16 v[164:167], v[176:179], a[24:27], v[164:167]
  ds_read_b128 a[72:75], v4 offset:22528
  v_fma_f32 v48, v140, v32, v48
  v_fma_f32 v49, v141, v32, v49
  v_mfma_f32_16x16x32_bf16 v[164:167], v[180:183], a[40:43], v[164:167]
  ds_read_b128 a[88:91], v4 offset:26624
  v_fma_f32 v50, v142, v32, v50
  v_fma_f32 v51, v143, v32, v51
  v_mfma_f32_16x16x32_bf16 v[168:171], v[172:175], a[12:15], 0
  ds_read_b128 a[60:63], v4 offset:15360
  s_add_u32 s40, s40, 12288
  v_mul_f32 v48, v48, abs(v48)
  v_mfma_f32_16x16x32_bf16 v[168:171], v[176:179], a[28:31], v[168:171]
  ds_read_b128 a[76:79], v4 offset:23552
  v_mul_f32 v49, v49, abs(v49)
  v_mul_f32 v50, v50, abs(v50)
  v_mfma_f32_16x16x32_bf16 v[168:171], v[180:183], a[44:47], v[168:171]
  ds_read_b128 a[92:95], v4 offset:27648
  v_mul_f32 v51, v51, abs(v51)
  s_waitcnt vmcnt(12)
  s_waitcnt lgkmcnt(6)
  v_mfma_f32_16x16x32_bf16 v[156:159], v[184:187], a[48:51], v[156:159]
  ds_read_b128 a[96:99], v4 offset:28672
  buffer_load_dwordx4 v[172:175], v25, s[12:15], s40 offen sc1
  v_cvt_pk_bf16_f32 v48, v48, v49
  v_cvt_pk_bf16_f32 v49, v50, v51
  v_mfma_f32_16x16x32_bf16 v[156:159], v[188:191], a[64:67], v[156:159]
  ds_read_b128 a[112:115], v4 offset:36864
  v_pk_max_i16 v48, v48, 0
  v_pk_max_i16 v49, v49, 0
  v_mfma_f32_16x16x32_bf16 v[156:159], v[192:195], a[80:83], v[156:159]
  ds_read_b128 a[128:131], v4 offset:40960
  ds_write_b64 v10, v[48:49] offset:0
  v_mfma_f32_16x16x32_bf16 v[160:163], v[184:187], a[52:55], v[160:163]
  ds_read_b128 a[100:103], v4 offset:29696
  buffer_load_dwordx4 v[176:179], v26, s[12:15], s40 offen sc1
  v_fma_f32 v52, v37, v40, v44
  v_fma_f32 v53, v37, v41, v45
  v_mfma_f32_16x16x32_bf16 v[160:163], v[188:191], a[68:71], v[160:163]
  ds_read_b128 a[116:119], v4 offset:37888
  v_fma_f32 v54, v37, v42, v46
  v_fma_f32 v55, v37, v43, v47
  v_mfma_f32_16x16x32_bf16 v[160:163], v[192:195], a[84:87], v[160:163]
  ds_read_b128 a[132:135], v4 offset:41984
  v_fma_f32 v52, v144, v33, v52
  s_waitcnt lgkmcnt(7)
  v_mfma_f32_16x16x32_bf16 v[164:167], v[184:187], a[56:59], v[164:167]
  ds_read_b128 a[104:107], v4 offset:30720
  buffer_load_dwordx4 v[180:183], v27, s[12:15], s40 offen sc1
  v_fma_f32 v53, v145, v33, v53
  v_fma_f32 v54, v146, v33, v54
  v_mfma_f32_16x16x32_bf16 v[164:167], v[188:191], a[72:75], v[164:167]
  ds_read_b128 a[120:123], v4 offset:38912
  v_fma_f32 v55, v147, v33, v55
  v_mfma_f32_16x16x32_bf16 v[164:167], v[192:195], a[88:91], v[164:167]
  ds_read_b128 a[136:139], v4 offset:43008
  v_mul_f32 v52, v52, abs(v52)
  v_mul_f32 v53, v53, abs(v53)
  v_mfma_f32_16x16x32_bf16 v[168:171], v[184:187], a[60:63], v[168:171]
  ds_read_b128 a[108:111], v4 offset:31744
  s_add_u32 s40, s40, 12288
  v_mul_f32 v54, v54, abs(v54)
  v_mul_f32 v55, v55, abs(v55)
  v_mfma_f32_16x16x32_bf16 v[168:171], v[188:191], a[76:79], v[168:171]
  ds_read_b128 a[124:127], v4 offset:39936
  v_cvt_pk_bf16_f32 v52, v52, v53
  v_mfma_f32_16x16x32_bf16 v[168:171], v[192:195], a[92:95], v[168:171]
  ds_read_b128 a[140:143], v4 offset:44032
  v_cvt_pk_bf16_f32 v53, v54, v55
  v_pk_max_i16 v52, v52, 0
  s_waitcnt vmcnt(12)
  s_waitcnt lgkmcnt(6)
  v_mfma_f32_16x16x32_bf16 v[156:159], v[196:199], a[96:99], v[156:159]
  ds_read_b128 a[144:147], v4 offset:45056
  buffer_load_dwordx4 v[184:187], v25, s[12:15], s40 offen sc1
  v_pk_max_i16 v53, v53, 0
  ds_write_b64 v10, v[52:53] offset:1024
  v_mfma_f32_16x16x32_bf16 v[156:159], v[200:203], a[112:115], v[156:159]
  ds_read_b128 a[160:163], v4 offset:49152
  v_fma_f32 v48, v38, v40, v44
  v_mfma_f32_16x16x32_bf16 v[156:159], v[204:207], a[128:131], v[156:159]
  ds_read_b128 a[176:179], v4 offset:57344
  v_fma_f32 v49, v38, v41, v45
  v_fma_f32 v50, v38, v42, v46
  v_mfma_f32_16x16x32_bf16 v[160:163], v[196:199], a[100:103], v[160:163]
  ds_read_b128 a[148:151], v4 offset:46080
  buffer_load_dwordx4 v[188:191], v26, s[12:15], s40 offen sc1
  v_fma_f32 v51, v38, v43, v47
  v_mfma_f32_16x16x32_bf16 v[160:163], v[200:203], a[116:119], v[160:163]
  ds_read_b128 a[164:167], v4 offset:50176
  v_fma_f32 v48, v148, v34, v48
  v_fma_f32 v49, v149, v34, v49
  v_mfma_f32_16x16x32_bf16 v[160:163], v[204:207], a[132:135], v[160:163]
  ds_read_b128 a[180:183], v4 offset:58368
  v_fma_f32 v50, v150, v34, v50
  v_fma_f32 v51, v151, v34, v51
  s_waitcnt lgkmcnt(7)
  v_mfma_f32_16x16x32_bf16 v[164:167], v[196:199], a[104:107], v[164:167]
  ds_read_b128 a[152:155], v4 offset:47104
  buffer_load_dwordx4 v[192:195], v27, s[12:15], s40 offen sc1
  v_mul_f32 v48, v48, abs(v48)
  v_mfma_f32_16x16x32_bf16 v[164:167], v[200:203], a[120:123], v[164:167]
  ds_read_b128 a[168:171], v4 offset:51200
  v_mul_f32 v49, v49, abs(v49)
  v_mul_f32 v50, v50, abs(v50)
  v_mfma_f32_16x16x32_bf16 v[164:167], v[204:207], a[136:139], v[164:167]
  ds_read_b128 a[184:187], v4 offset:59392
  v_mul_f32 v51, v51, abs(v51)
  v_mfma_f32_16x16x32_bf16 v[168:171], v[196:199], a[108:111], v[168:171]
  ds_read_b128 a[156:159], v4 offset:48128
  s_add_u32 s40, s40, 12288
  v_cvt_pk_bf16_f32 v48, v48, v49
  v_cvt_pk_bf16_f32 v49, v50, v51
  v_mfma_f32_16x16x32_bf16 v[168:171], v[200:203], a[124:127], v[168:171]
  ds_read_b128 a[172:175], v4 offset:52224
  v_pk_max_i16 v48, v48, 0
  v_pk_max_i16 v49, v49, 0
  v_mfma_f32_16x16x32_bf16 v[168:171], v[204:207], a[140:143], v[168:171]
  ds_read_b128 a[188:191], v4 offset:60416
  ds_write_b64 v10, v[48:49] offset:2048
  s_waitcnt vmcnt(12)
  s_waitcnt lgkmcnt(7)
  v_mfma_f32_16x16x32_bf16 v[156:159], v[208:211], a[144:147], v[156:159]
  ds_read_b128 a[192:195], v4 offset:61440
  v_fma_f32 v52, v39, v40, v44
  v_fma_f32 v53, v39, v41, v45
  v_mfma_f32_16x16x32_bf16 v[156:159], v[212:215], a[160:163], v[156:159]
  buffer_load_dwordx4 v[196:199], v25, s[12:15], s40 offen sc1
  v_fma_f32 v54, v39, v42, v46
  v_fma_f32 v55, v39, v43, v47
  v_mfma_f32_16x16x32_bf16 v[156:159], v[216:219], a[176:179], v[156:159]
  ds_read_b128 a[208:211], v9 offset:0
  v_fma_f32 v52, v152, v35, v52
  v_mfma_f32_16x16x32_bf16 v[160:163], v[208:211], a[148:151], v[160:163]
  ds_read_b128 a[196:199], v4 offset:62464
  v_fma_f32 v53, v153, v35, v53
  v_fma_f32 v54, v154, v35, v54
  v_mfma_f32_16x16x32_bf16 v[160:163], v[212:215], a[164:167], v[160:163]
  buffer_load_dwordx4 v[200:203], v26, s[12:15], s40 offen sc1
  v_fma_f32 v55, v155, v35, v55
  v_mfma_f32_16x16x32_bf16 v[160:163], v[216:219], a[180:183], v[160:163]
  ds_read_b128 a[212:215], v9 offset:1024
  v_mul_f32 v52, v52, abs(v52)
  v_mul_f32 v53, v53, abs(v53)
  s_waitcnt lgkmcnt(5)
  v_mfma_f32_16x16x32_bf16 v[164:167], v[208:211], a[152:155], v[164:167]
  ds_read_b128 a[200:203], v4 offset:63488
  v_mul_f32 v54, v54, abs(v54)
  v_mul_f32 v55, v55, abs(v55)
  v_mfma_f32_16x16x32_bf16 v[164:167], v[212:215], a[168:171], v[164:167]
  buffer_load_dwordx4 v[204:207], v27, s[12:15], s40 offen sc1
  v_cvt_pk_bf16_f32 v52, v52, v53
  v_mfma_f32_16x16x32_bf16 v[164:167], v[216:219], a[184:187], v[164:167]
  ds_read_b128 a[216:219], v9 offset:2048
  v_cvt_pk_bf16_f32 v53, v54, v55
  v_pk_max_i16 v52, v52, 0
  v_mfma_f32_16x16x32_bf16 v[168:171], v[208:211], a[156:159], v[168:171]
  ds_read_b128 a[204:207], v4 offset:64512
  v_pk_max_i16 v53, v53, 0
  ds_write_b64 v10, v[52:53] offset:3072
  v_mfma_f32_16x16x32_bf16 v[168:171], v[212:215], a[172:175], v[168:171]
  s_add_u32 s40, s40, 12288
  v_mfma_f32_16x16x32_bf16 v[168:171], v[216:219], a[188:191], v[168:171]
  ds_read_b128 a[220:223], v9 offset:3072
  s_waitcnt lgkmcnt(0)
  s_barrier
  s_waitcnt vmcnt(12)
  v_mfma_f32_16x16x32_bf16 v[156:159], v[220:223], a[192:195], v[156:159]
  ds_read_b128 a[224:227], v4 offset:16384
  buffer_load_dwordx4 v[208:211], v25, s[12:15], s40 offen sc1
  v_mfma_f32_16x16x32_bf16 v[156:159], v[224:227], a[208:211], v[156:159]
  ds_read_b128 a[228:231], v4 offset:17408
  ds_read_b128 a[232:235], v4 offset:18432
  v_mfma_f32_16x16x32_bf16 v[160:163], v[220:223], a[196:199], v[160:163]
  ds_read_b128 a[236:239], v4 offset:19456
  v_mfma_f32_16x16x32_bf16 v[160:163], v[224:227], a[212:215], v[160:163]
  ds_read_b128 a[240:243], v4 offset:32768
  buffer_load_dwordx4 v[212:215], v26, s[12:15], s40 offen sc1
  v_mfma_f32_16x16x32_bf16 v[164:167], v[220:223], a[200:203], v[164:167]
  ds_read_b128 v[72:75], v4 offset:53248
  ds_read_b128 v[88:91], v9 offset:4096
  v_mfma_f32_16x16x32_bf16 v[164:167], v[224:227], a[216:219], v[164:167]
  ds_read_b128 a[244:247], v4 offset:33792
  v_mfma_f32_16x16x32_bf16 v[168:171], v[220:223], a[204:207], v[168:171]
  ds_read_b128 v[76:79], v4 offset:54272
  buffer_load_dwordx4 v[216:219], v27, s[12:15], s40 offen sc1
  v_mfma_f32_16x16x32_bf16 v[168:171], v[224:227], a[220:223], v[168:171]
  ds_read_b128 v[92:95], v9 offset:5120
  ds_read_b128 a[248:251], v4 offset:34816
  s_waitcnt lgkmcnt(7)
  v_mfma_f32_16x16x32_bf16 v[156:159], v[228:231], a[224:227], v[156:159]
  ds_read_b128 v[80:83], v4 offset:55296
  v_mfma_f32_16x16x32_bf16 v[160:163], v[228:231], a[228:231], v[160:163]
  ds_read_b128 v[96:99], v9 offset:6144
  s_add_u32 s40, s40, 12288
  v_mfma_f32_16x16x32_bf16 v[164:167], v[228:231], a[232:235], v[164:167]
  ds_read_b128 a[252:255], v4 offset:35840
  ds_read_b128 v[84:87], v4 offset:56320
  v_mfma_f32_16x16x32_bf16 v[168:171], v[228:231], a[236:239], v[168:171]
  ds_read_b128 v[100:103], v9 offset:7168
  s_waitcnt vmcnt(12)
  s_waitcnt lgkmcnt(6)
  v_mfma_f32_16x16x32_bf16 v[156:159], v[232:235], a[240:243], v[156:159]
  buffer_load_dwordx4 v[220:223], v25, s[12:15], s40 offen sc1
  v_mfma_f32_16x16x32_bf16 v[156:159], v[236:239], v[72:75], v[156:159]
  v_mfma_f32_16x16x32_bf16 v[156:159], v[240:243], v[88:91], v[156:159]
  v_mfma_f32_16x16x32_bf16 v[160:163], v[232:235], a[244:247], v[160:163]
  v_mfma_f32_16x16x32_bf16 v[160:163], v[236:239], v[76:79], v[160:163]
  buffer_load_dwordx4 v[224:227], v26, s[12:15], s40 offen sc1
  v_mfma_f32_16x16x32_bf16 v[160:163], v[240:243], v[92:95], v[160:163]
  s_waitcnt lgkmcnt(0)
  v_mfma_f32_16x16x32_bf16 v[164:167], v[232:235], a[248:251], v[164:167]
  v_mfma_f32_16x16x32_bf16 v[164:167], v[236:239], v[80:83], v[164:167]
  v_mfma_f32_16x16x32_bf16 v[164:167], v[240:243], v[96:99], v[164:167]
  buffer_load_dwordx4 v[228:231], v27, s[12:15], s40 offen sc1
  v_mfma_f32_16x16x32_bf16 v[168:171], v[232:235], a[252:255], v[168:171]
  s_add_u32 s40, s40, 12288
  v_mfma_f32_16x16x32_bf16 v[168:171], v[236:239], v[84:87], v[168:171]
  v_mfma_f32_16x16x32_bf16 v[168:171], v[240:243], v[100:103], v[168:171]
  s_waitcnt vmcnt(12)
  v_mfma_f32_16x16x32_bf16 v[140:143], v[172:175], a[0:3], 0
  buffer_load_dwordx4 v[232:235], v25, s[12:15], s40 offen sc1
  v_mfma_f32_16x16x32_bf16 v[140:143], v[176:179], a[16:19], v[140:143]
  v_mfma_f32_16x16x32_bf16 v[140:143], v[180:183], a[32:35], v[140:143]
  v_mfma_f32_16x16x32_bf16 v[144:147], v[172:175], a[4:7], 0
  v_mfma_f32_16x16x32_bf16 v[144:147], v[176:179], a[20:23], v[144:147]
  buffer_load_dwordx4 v[236:239], v26, s[12:15], s40 offen sc1
  v_cvt_pk_bf16_f32 v56, v156, v157
  v_cvt_pk_bf16_f32 v57, v158, v159
  v_mfma_f32_16x16x32_bf16 v[144:147], v[180:183], a[36:39], v[144:147]
  v_cvt_pk_bf16_f32 v58, v160, v161
  v_cvt_pk_bf16_f32 v59, v162, v163
  v_mfma_f32_16x16x32_bf16 v[148:151], v[172:175], a[8:11], 0
  buffer_store_dwordx4 v[56:59], v4, s[8:11], s43 offen offset:0 sc1
  v_cvt_pk_bf16_f32 v60, v164, v165
  v_mfma_f32_16x16x32_bf16 v[148:151], v[176:179], a[24:27], v[148:151]
  v_cvt_pk_bf16_f32 v61, v166, v167
  v_cvt_pk_bf16_f32 v62, v168, v169
  v_mfma_f32_16x16x32_bf16 v[148:151], v[180:183], a[40:43], v[148:151]
  buffer_load_dwordx4 v[240:243], v27, s[12:15], s40 offen sc1
  v_cvt_pk_bf16_f32 v63, v170, v171
  buffer_store_dwordx4 v[60:63], v4, s[8:11], s43 offen offset:1024 sc1
  v_mfma_f32_16x16x32_bf16 v[152:155], v[172:175], a[12:15], 0
  s_add_u32 s40, s40, 12288
  s_and_b32 s44, s33, 3
  s_lshr_b32 s48, s33, 2
  v_mfma_f32_16x16x32_bf16 v[152:155], v[176:179], a[28:31], v[152:155]
  s_mul_i32 s45, s48, 9
  s_add_u32 s52, s49, 9216
  v_mfma_f32_16x16x32_bf16 v[152:155], v[180:183], a[44:47], v[152:155]
  s_lshl_b32 s53, s32, 2
  s_add_u32 s53, s53, 2
  s_waitcnt vmcnt(14)
  v_mfma_f32_16x16x32_bf16 v[140:143], v[184:187], a[48:51], v[140:143]
  buffer_load_dwordx4 v[172:175], v25, s[12:15], s40 offen sc1
  s_add_u32 s35, s33, 0
  s_and_b32 s35, s35, 7
  v_mfma_f32_16x16x32_bf16 v[140:143], v[188:191], a[64:67], v[140:143]
  s_mul_i32 s35, s35, 2359296
  s_add_u32 s88, s35, s38
  v_mfma_f32_16x16x32_bf16 v[140:143], v[192:195], a[80:83], v[140:143]
  s_add_u32 s35, s33, 1
  s_and_b32 s35, s35, 7
  v_mfma_f32_16x16x32_bf16 v[144:147], v[184:187], a[52:55], v[144:147]
  s_mul_i32 s35, s35, 2359296
  s_add_u32 s89, s35, s38
  v_mfma_f32_16x16x32_bf16 v[144:147], v[188:191], a[68:71], v[144:147]
  buffer_load_dwordx4 v[176:179], v26, s[12:15], s40 offen sc1
  s_add_u32 s35, s33, 2
  s_and_b32 s35, s35, 7
  v_mfma_f32_16x16x32_bf16 v[144:147], v[192:195], a[84:87], v[144:147]
  s_mul_i32 s35, s35, 2359296
  s_add_u32 s90, s35, s38
  v_mfma_f32_16x16x32_bf16 v[148:151], v[184:187], a[56:59], v[148:151]
  s_add_u32 s35, s33, 3
  s_and_b32 s35, s35, 7
  v_mfma_f32_16x16x32_bf16 v[148:151], v[188:191], a[72:75], v[148:151]
  s_mul_i32 s35, s35, 2359296
  s_add_u32 s91, s35, s38
  v_mfma_f32_16x16x32_bf16 v[148:151], v[192:195], a[88:91], v[148:151]
  buffer_load_dwordx4 v[180:183], v27, s[12:15], s40 offen sc1
  s_add_u32 s35, s33, 4
  s_and_b32 s35, s35, 7
  v_mfma_f32_16x16x32_bf16 v[152:155], v[184:187], a[60:63], v[152:155]
  s_add_u32 s40, s40, 12288
  s_mul_i32 s35, s35, 2359296
  s_add_u32 s92, s35, s38
  v_mfma_f32_16x16x32_bf16 v[152:155], v[188:191], a[76:79], v[152:155]
  s_add_u32 s35, s33, 5
  s_and_b32 s35, s35, 7
  v_mfma_f32_16x16x32_bf16 v[152:155], v[192:195], a[92:95], v[152:155]
  s_mul_i32 s35, s35, 2359296
  s_add_u32 s93, s35, s38
  s_waitcnt vmcnt(14)
  v_mfma_f32_16x16x32_bf16 v[140:143], v[196:199], a[96:99], v[140:143]
  buffer_load_dwordx4 v[184:187], v25, s[12:15], s40 offen sc1
  s_add_u32 s35, s33, 6
  s_and_b32 s35, s35, 7
  v_mfma_f32_16x16x32_bf16 v[140:143], v[200:203], a[112:115], v[140:143]
  s_mul_i32 s35, s35, 2359296
  s_add_u32 s94, s35, s38
  v_mfma_f32_16x16x32_bf16 v[140:143], v[204:207], a[128:131], v[140:143]
  s_add_u32 s35, s33, 7
  s_and_b32 s35, s35, 7
  v_mfma_f32_16x16x32_bf16 v[144:147], v[196:199], a[100:103], v[144:147]
  s_mul_i32 s35, s35, 2359296
  s_add_u32 s95, s35, s38
  v_mfma_f32_16x16x32_bf16 v[144:147], v[200:203], a[116:119], v[144:147]
  buffer_load_dwordx4 v[188:191], v26, s[12:15], s40 offen sc1
  s_lshr_b32 s35, s32, 1
  s_xor_b32 s48, s48, s35
  v_mfma_f32_16x16x32_bf16 v[144:147], v[204:207], a[132:135], v[144:147]
  s_lshl_b32 s48, s48, 2
  s_add_u32 s48, s48, s44
  v_mfma_f32_16x16x32_bf16 v[148:151], v[196:199], a[104:107], v[148:151]
  v_lshrrev_b32 v5, 1, v3
  v_mul_u32_u24 v5, 36864, v5
  v_mfma_f32_16x16x32_bf16 v[148:151], v[200:203], a[120:123], v[148:151]
  v_and_b32 v6, 31, v1
  v_lshl_add_u32 v5, v6, 4, v5
  v_mfma_f32_16x16x32_bf16 v[148:151], v[204:207], a[136:139], v[148:151]
  buffer_load_dwordx4 v[192:195], v27, s[12:15], s40 offen sc1
  s_and_b32 s35, s32, 1
  s_mul_i32 s35, s35, 18432
  v_mfma_f32_16x16x32_bf16 v[152:155], v[196:199], a[108:111], v[152:155]
  s_add_u32 s40, s40, 12288
  s_add_u32 s35, s35, 81920
  v_add_u32 v5, s35, v5
  v_mfma_f32_16x16x32_bf16 v[152:155], v[200:203], a[124:127], v[152:155]
  s_add_u32 s35, s37, 14336
  v_add_u32 v6, s35, v4
  v_mfma_f32_16x16x32_bf16 v[152:155], v[204:207], a[140:143], v[152:155]
  s_cmp_eq_u32 s48, 0
  s_cselect_b64 vcc, -1, 0
  s_cselect_b32 s54, s47, s41
  s_waitcnt vmcnt(14)
  v_mfma_f32_16x16x32_bf16 v[140:143], v[208:211], a[144:147], v[140:143]
  buffer_load_dwordx4 v[196:199], v25, s[12:15], s40 offen sc1
  v_cndmask_b32 v116, v6, v5, vcc
  v_mfma_f32_16x16x32_bf16 v[140:143], v[212:215], a[160:163], v[140:143]
  s_add_u32 s54, s54, 0
  s_cmp_eq_u32 s48, 1
  s_cselect_b64 vcc, -1, 0
  s_cselect_b32 s55, s47, s41
  v_mfma_f32_16x16x32_bf16 v[140:143], v[216:219], a[176:179], v[140:143]
  v_mfma_f32_16x16x32_bf16 v[144:147], v[208:211], a[148:151], v[144:147]
  v_cndmask_b32 v117, v6, v5, vcc
  s_add_u32 s55, s55, 1024
  v_mfma_f32_16x16x32_bf16 v[144:147], v[212:215], a[164:167], v[144:147]
  buffer_load_dwordx4 v[200:203], v26, s[12:15], s40 offen sc1
  s_cmp_eq_u32 s48, 2
  s_cselect_b64 vcc, -1, 0
  s_cselect_b32 s56, s47, s41
  v_mfma_f32_16x16x32_bf16 v[144:147], v[216:219], a[180:183], v[144:147]
  v_cndmask_b32 v118, v6, v5, vcc
  v_mfma_f32_16x16x32_bf16 v[148:151], v[208:211], a[152:155], v[148:151]
  s_add_u32 s56, s56, 2048
  s_cmp_eq_u32 s48, 3
  s_cselect_b64 vcc, -1, 0
  s_cselect_b32 s57, s47, s41
  v_mfma_f32_16x16x32_bf16 v[148:151], v[212:215], a[168:171], v[148:151]
  v_mfma_f32_16x16x32_bf16 v[148:151], v[216:219], a[184:187], v[148:151]
  buffer_load_dwordx4 v[204:207], v27, s[12:15], s40 offen sc1
  v_cndmask_b32 v119, v6, v5, vcc
  s_add_u32 s57, s57, 3072
  v_mfma_f32_16x16x32_bf16 v[152:155], v[208:211], a[156:159], v[152:155]
  s_add_u32 s40, s40, 12288
  s_lshl_b32 s35, s34, 6
  s_lshl_b32 s36, s44, 4
  v_mfma_f32_16x16x32_bf16 v[152:155], v[212:215], a[172:175], v[152:155]
  s_add_u32 s35, s35, s36
  v_add_u32 v5, s35, v2
  v_mfma_f32_16x16x32_bf16 v[152:155], v[216:219], a[188:191], v[152:155]
  v_mul_u32_u24 v5, 1152, v5
  v_mov_b32 v7, 2147483632
  s_waitcnt vmcnt(14)
  v_mfma_f32_16x16x32_bf16 v[140:143], v[220:223], a[192:195], v[140:143]
  buffer_load_dwordx4 v[208:211], v25, s[12:15], s40 offen sc1
  v_cmp_gt_u32 vcc, 16, v1
  s_mul_i32 s46, s44, 18432
  v_mfma_f32_16x16x32_bf16 v[140:143], v[224:227], a[208:211], v[140:143]
  s_and_b32 s35, s32, 1
  s_mul_i32 s35, s35, 5
  v_mfma_f32_16x16x32_bf16 v[140:143], v[228:231], a[224:227], v[140:143]
  s_add_u32 s35, s35, s45
  v_lshrrev_b32 v6, 1, v3
  v_mfma_f32_16x16x32_bf16 v[144:147], v[220:223], a[196:199], v[144:147]
  v_add_u32 v6, s35, v6
  s_and_b32 s35, s32, 2
  v_mfma_f32_16x16x32_bf16 v[144:147], v[224:227], a[212:215], v[144:147]
  buffer_load_dwordx4 v[212:215], v26, s[12:15], s40 offen sc1
  v_and_b32 v122, 1, v3
  v_add_u32 v122, s35, v122
  v_mfma_f32_16x16x32_bf16 v[144:147], v[228:231], a[228:231], v[144:147]
  v_lshlrev_b32 v113, 6, v6
  v_lshl_add_u32 v113, v122, 4, v113
  v_mfma_f32_16x16x32_bf16 v[148:151], v[220:223], a[200:203], v[148:151]
  v_add_u32 v104, v5, v113
  v_lshlrev_b32 v107, 4, v2
  v_mfma_f32_16x16x32_bf16 v[148:151], v[224:227], a[216:219], v[148:151]
  v_lshl_add_u32 v107, v122, 8, v107
  v_lshl_add_u32 v110, v6, 10, v107
  v_mfma_f32_16x16x32_bf16 v[148:151], v[228:231], a[232:235], v[148:151]
  buffer_load_dwordx4 v[216:219], v27, s[12:15], s40 offen sc1
  v_add_u32 v110, s46, v110
  v_lshl_add_u32 v107, v6, 12, v107
  v_mfma_f32_16x16x32_bf16 v[152:155], v[220:223], a[204:207], v[152:155]
  s_add_u32 s40, s40, 12288
  s_lshl_b32 s35, s44, 10
  v_add_u32 v107, s35, v107
  v_mfma_f32_16x16x32_bf16 v[152:155], v[224:227], a[220:223], v[152:155]
  v_add_u32 v6, 2, v6
  v_lshlrev_b32 v114, 6, v6
  v_mfma_f32_16x16x32_bf16 v[152:155], v[228:231], a[236:239], v[152:155]
  v_lshl_add_u32 v114, v122, 4, v114
  v_add_u32 v105, v5, v114
  s_waitcnt vmcnt(13)
  v_mfma_f32_16x16x32_bf16 v[140:143], v[232:235], a[240:243], v[140:143]
  buffer_load_dwordx4 v[220:223], v25, s[12:15], s40 offen sc1
  v_lshlrev_b32 v108, 4, v2
  v_lshl_add_u32 v108, v122, 8, v108
  v_mfma_f32_16x16x32_bf16 v[140:143], v[236:239], v[72:75], v[140:143]
  v_lshl_add_u32 v111, v6, 10, v108
  v_add_u32 v111, s46, v111
  v_mfma_f32_16x16x32_bf16 v[140:143], v[240:243], v[88:91], v[140:143]
  v_lshl_add_u32 v108, v6, 12, v108
  s_lshl_b32 s35, s44, 10
  v_mfma_f32_16x16x32_bf16 v[144:147], v[232:235], a[244:247], v[144:147]
  v_add_u32 v108, s35, v108
  s_add_u32 s35, s45, 4
  v_mfma_f32_16x16x32_bf16 v[144:147], v[236:239], v[76:79], v[144:147]
  buffer_load_dwordx4 v[224:227], v26, s[12:15], s40 offen sc1
  v_mov_b32 v6, s35
  v_mov_b32 v122, s32
  v_mfma_f32_16x16x32_bf16 v[144:147], v[240:243], v[92:95], v[144:147]
  v_lshlrev_b32 v115, 6, v6
  v_lshl_add_u32 v115, v122, 4, v115
  v_mfma_f32_16x16x32_bf16 v[148:151], v[232:235], a[248:251], v[148:151]
  v_add_u32 v106, v5, v115
  v_lshlrev_b32 v109, 4, v2
  v_mfma_f32_16x16x32_bf16 v[148:151], v[236:239], v[80:83], v[148:151]
  v_lshl_add_u32 v109, v122, 8, v109
  v_lshl_add_u32 v112, v6, 10, v109
  v_mfma_f32_16x16x32_bf16 v[148:151], v[240:243], v[96:99], v[148:151]
  buffer_load_dwordx4 v[228:231], v27, s[12:15], s40 offen sc1
  v_add_u32 v112, s46, v112
  v_lshl_add_u32 v109, v6, 12, v109
  v_mfma_f32_16x16x32_bf16 v[152:155], v[232:235], a[252:255], v[152:155]
  s_add_u32 s40, s40, 12288
  s_lshr_b32 s35, s44, 1
  s_lshl_b32 s35, s35, 10
  v_mfma_f32_16x16x32_bf16 v[152:155], v[236:239], v[84:87], v[152:155]
  v_lshl_add_u32 v109, v3, 11, v109
  v_add_u32 v109, s35, v109
  v_mfma_f32_16x16x32_bf16 v[152:155], v[240:243], v[100:103], v[152:155]
  v_cndmask_b32 v106, v7, v106, vcc
  v_cndmask_b32 v112, v7, v112, vcc
  s_mov_b32 s42, 0
L_kf_p2:
  s_waitcnt vmcnt(12)
  v_mfma_f32_16x16x32_bf16 v[156:159], v[172:175], a[0:3], 0
  buffer_load_dwordx4 v[232:235], v25, s[12:15], s40 offen sc1
  v_mfma_f32_16x16x32_bf16 v[156:159], v[176:179], a[16:19], v[156:159]
  v_mfma_f32_16x16x32_bf16 v[156:159], v[180:183], a[32:35], v[156:159]
  v_mfma_f32_16x16x32_bf16 v[160:163], v[172:175], a[4:7], 0
  v_mfma_f32_16x16x32_bf16 v[160:163], v[176:179], a[20:23], v[160:163]
  buffer_load_dwordx4 v[236:239], v26, s[12:15], s40 offen sc1
  v_cvt_pk_bf16_f32 v56, v140, v141
  v_mfma_f32_16x16x32_bf16 v[160:163], v[180:183], a[36:39], v[160:163]
  v_mfma_f32_16x16x32_bf16 v[164:167], v[172:175], a[8:11], 0
  v_mfma_f32_16x16x32_bf16 v[164:167], v[176:179], a[24:27], v[164:167]
  v_mfma_f32_16x16x32_bf16 v[164:167], v[180:183], a[40:43], v[164:167]
  buffer_load_dwordx4 v[240:243], v27, s[12:15], s40 offen sc1
  v_mfma_f32_16x16x32_bf16 v[168:171], v[172:175], a[12:15], 0
  s_add_u32 s40, s40, 12288
  v_mfma_f32_16x16x32_bf16 v[168:171], v[176:179], a[28:31], v[168:171]
  v_mfma_f32_16x16x32_bf16 v[168:171], v[180:183], a[44:47], v[168:171]
  s_waitcnt vmcnt(12)
  v_mfma_f32_16x16x32_bf16 v[156:159], v[184:187], a[48:51], v[156:159]
  buffer_load_dwordx4 v[172:175], v25, s[12:15], s40 offen sc1
  v_mfma_f32_16x16x32_bf16 v[156:159], v[188:191], a[64:67], v[156:159]
  v_cvt_pk_bf16_f32 v57, v142, v143
  v_mfma_f32_16x16x32_bf16 v[156:159], v[192:195], a[80:83], v[156:159]
  v_mfma_f32_16x16x32_bf16 v[160:163], v[184:187], a[52:55], v[160:163]
  v_mfma_f32_16x16x32_bf16 v[160:163], v[188:191], a[68:71], v[160:163]
  buffer_load_dwordx4 v[176:179], v26, s[12:15], s40 offen sc1
  v_mfma_f32_16x16x32_bf16 v[160:163], v[192:195], a[84:87], v[160:163]
  v_mfma_f32_16x16x32_bf16 v[164:167], v[184:187], a[56:59], v[164:167]
  v_mfma_f32_16x16x32_bf16 v[164:167], v[188:191], a[72:75], v[164:167]
  v_mfma_f32_16x16x32_bf16 v[164:167], v[192:195], a[88:91], v[164:167]
  buffer_load_dwordx4 v[180:183], v27, s[12:15], s40 offen sc1
  v_cvt_pk_bf16_f32 v60, v144, v145
  v_mfma_f32_16x16x32_bf16 v[168:171], v[184:187], a[60:63], v[168:171]
  s_add_u32 s40, s40, 12288
  v_mfma_f32_16x16x32_bf16 v[168:171], v[188:191], a[76:79], v[168:171]
  v_mfma_f32_16x16x32_bf16 v[168:171], v[192:195], a[92:95], v[168:171]
  s_waitcnt vmcnt(12)
  v_mfma_f32_16x16x32_bf16 v[156:159], v[196:199], a[96:99], v[156:159]
  buffer_load_dwordx4 v[184:187], v25, s[12:15], s40 offen sc1
  v_mfma_f32_16x16x32_bf16 v[156:159], v[200:203], a[112:115], v[156:159]
  v_mfma_f32_16x16x32_bf16 v[156:159], v[204:207], a[128:131], v[156:159]
  v_mfma_f32_16x16x32_bf16 v[160:163], v[196:199], a[100:103], v[160:163]
  v_mfma_f32_16x16x32_bf16 v[160:163], v[200:203], a[116:119], v[160:163]
  buffer_load_dwordx4 v[188:191], v26, s[12:15], s40 offen sc1
  v_mfma_f32_16x16x32_bf16 v[160:163], v[204:207], a[132:135], v[160:163]
  v_cvt_pk_bf16_f32 v61, v146, v147
  v_mfma_f32_16x16x32_bf16 v[164:167], v[196:199], a[104:107], v[164:167]
  v_mfma_f32_16x16x32_bf16 v[164:167], v[200:203], a[120:123], v[164:167]
  v_mfma_f32_16x16x32_bf16 v[164:167], v[204:207], a[136:139], v[164:167]
  buffer_load_dwordx4 v[192:195], v27, s[12:15], s40 offen sc1
  v_mfma_f32_16x16x32_bf16 v[168:171], v[196:199], a[108:111], v[168:171]
  s_add_u32 s40, s40, 12288
  v_mfma_f32_16x16x32_bf16 v[168:171], v[200:203], a[124:127], v[168:171]
  v_mfma_f32_16x16x32_bf16 v[168:171], v[204:207], a[140:143], v[168:171]
  s_waitcnt vmcnt(12)
  v_mfma_f32_16x16x32_bf16 v[156:159], v[208:211], a[144:147], v[156:159]
  buffer_load_dwordx4 v[196:199], v25, s[12:15], s40 offen sc1
  v_mfma_f32_16x16x32_bf16 v[156:159], v[212:215], a[160:163], v[156:159]
  v_mfma_f32_16x16x32_bf16 v[156:159], v[216:219], a[176:179], v[156:159]
  v_cvt_pk_bf16_f32 v64, v148, v149
  v_mfma_f32_16x16x32_bf16 v[160:163], v[208:211], a[148:151], v[160:163]
  v_mfma_f32_16x16x32_bf16 v[160:163], v[212:215], a[164:167], v[160:163]
  buffer_load_dwordx4 v[200:203], v26, s[12:15], s40 offen sc1
  v_mfma_f32_16x16x32_bf16 v[160:163], v[216:219], a[180:183], v[160:163]
  v_mfma_f32_16x16x32_bf16 v[164:167], v[208:211], a[152:155], v[164:167]
  v_mfma_f32_16x16x32_bf16 v[164:167], v[212:215], a[168:171], v[164:167]
  v_mfma_f32_16x16x32_bf16 v[164:167], v[216:219], a[184:187], v[164:167]
  buffer_load_dwordx4 v[204:207], v27, s[12:15], s40 offen sc1
  v_mfma_f32_16x16x32_bf16 v[168:171], v[208:211], a[156:159], v[168:171]
  s_add_u32 s40, s40, 12288
  v_mfma_f32_16x16x32_bf16 v[168:171], v[212:215], a[172:175], v[168:171]
  v_cvt_pk_bf16_f32 v65, v150, v151
  v_mfma_f32_16x16x32_bf16 v[168:171], v[216:219], a[188:191], v[168:171]
  s_waitcnt vmcnt(12)
  v_mfma_f32_16x16x32_bf16 v[156:159], v[220:223], a[192:195], v[156:159]
  buffer_load_dwordx4 v[208:211], v25, s[12:15], s40 offen sc1
  v_mfma_f32_16x16x32_bf16 v[156:159], v[224:227], a[208:211], v[156:159]
  v_mfma_f32_16x16x32_bf16 v[156:159], v[228:231], a[224:227], v[156:159]
  v_mfma_f32_16x16x32_bf16 v[160:163], v[220:223], a[196:199], v[160:163]
  v_mfma_f32_16x16x32_bf16 v[160:163], v[224:227], a[212:215], v[160:163]
  buffer_load_dwordx4 v[212:215], v26, s[12:15], s40 offen sc1
  v_mfma_f32_16x16x32_bf16 v[160:163], v[228:231], a[228:231], v[160:163]
  v_mfma_f32_16x16x32_bf16 v[164:167], v[220:223], a[200:203], v[164:167]
  v_cvt_pk_bf16_f32 v68, v152, v153
  v_mfma_f32_16x16x32_bf16 v[164:167], v[224:227], a[216:219], v[164:167]
  v_mfma_f32_16x16x32_bf16 v[164:167], v[228:231], a[232:235], v[164:167]
  buffer_load_dwordx4 v[216:219], v27, s[12:15], s40 offen sc1
  v_mfma_f32_16x16x32_bf16 v[168:171], v[220:223], a[204:207], v[168:171]
  s_add_u32 s40, s40, 12288
  v_mfma_f32_16x16x32_bf16 v[168:171], v[224:227], a[220:223], v[168:171]
  v_mfma_f32_16x16x32_bf16 v[168:171], v[228:231], a[236:239], v[168:171]
  s_waitcnt vmcnt(12)
  v_mfma_f32_16x16x32_bf16 v[156:159], v[232:235], a[240:243], v[156:159]
  buffer_load_dwordx4 v[220:223], v25, s[12:15], s40 offen sc1
  v_mfma_f32_16x16x32_bf16 v[156:159], v[236:239], v[72:75], v[156:159]
  v_mfma_f32_16x16x32_bf16 v[156:159], v[240:243], v[88:91], v[156:159]
  v_mfma_f32_16x16x32_bf16 v[160:163], v[232:235], a[244:247], v[160:163]
  v_cvt_pk_bf16_f32 v69, v154, v155
  v_mfma_f32_16x16x32_bf16 v[160:163], v[236:239], v[76:79], v[160:163]
  buffer_load_dwordx4 v[224:227], v26, s[12:15], s40 offen sc1
  v_mfma_f32_16x16x32_bf16 v[160:163], v[240:243], v[92:95], v[160:163]
  v_mfma_f32_16x16x32_bf16 v[164:167], v[232:235], a[248:251], v[164:167]
  v_mfma_f32_16x16x32_bf16 v[164:167], v[236:239], v[80:83], v[164:167]
  v_mfma_f32_16x16x32_bf16 v[164:167], v[240:243], v[96:99], v[164:167]
  buffer_load_dwordx4 v[228:231], v27, s[12:15], s40 offen sc1
  v_mfma_f32_16x16x32_bf16 v[168:171], v[232:235], a[252:255], v[168:171]
  s_add_u32 s40, s40, 12288
  v_mfma_f32_16x16x32_bf16 v[168:171], v[236:239], v[84:87], v[168:171]
  v_mfma_f32_16x16x32_bf16 v[168:171], v[240:243], v[100:103], v[168:171]
  s_waitcnt vmcnt(12)
  v_mfma_f32_16x16x32_bf16 v[140:143], v[172:175], a[0:3], 0
  buffer_load_dwordx4 v[232:235], v25, s[12:15], s40 offen sc1
  v_mfma_f32_16x16x32_bf16 v[140:143], v[176:179], a[16:19], v[140:143]
  v_mfma_f32_16x16x32_bf16 v[140:143], v[180:183], a[32:35], v[140:143]
  v_mfma_f32_16x16x32_bf16 v[144:147], v[172:175], a[4:7], 0
  v_mfma_f32_16x16x32_bf16 v[144:147], v[176:179], a[20:23], v[144:147]
  buffer_load_dwordx4 v[236:239], v26, s[12:15], s40 offen sc1
  v_cvt_pk_bf16_f32 v58, v156, v157
  v_mfma_f32_16x16x32_bf16 v[144:147], v[180:183], a[36:39], v[144:147]
  v_mfma_f32_16x16x32_bf16 v[148:151], v[172:175], a[8:11], 0
  v_cvt_pk_bf16_f32 v59, v158, v159
  v_mfma_f32_16x16x32_bf16 v[148:151], v[176:179], a[24:27], v[148:151]
  v_mfma_f32_16x16x32_bf16 v[148:151], v[180:183], a[40:43], v[148:151]
  buffer_load_dwordx4 v[240:243], v27, s[12:15], s40 offen sc1
  v_mfma_f32_16x16x32_bf16 v[152:155], v[172:175], a[12:15], 0
  s_add_u32 s40, s40, 12288
  buffer_store_dwordx4 v[56:59], v4, s[8:11], s54 offen sc1
  v_mfma_f32_16x16x32_bf16 v[152:155], v[176:179], a[28:31], v[152:155]
  v_mfma_f32_16x16x32_bf16 v[152:155], v[180:183], a[44:47], v[152:155]
  s_waitcnt vmcnt(13)
  v_mfma_f32_16x16x32_bf16 v[140:143], v[184:187], a[48:51], v[140:143]
  buffer_load_dwordx4 v[172:175], v25, s[12:15], s40 offen sc1
  v_mfma_f32_16x16x32_bf16 v[140:143], v[188:191], a[64:67], v[140:143]
  ds_write_b128 v116, v[56:59]
  v_mfma_f32_16x16x32_bf16 v[140:143], v[192:195], a[80:83], v[140:143]
  v_mfma_f32_16x16x32_bf16 v[144:147], v[184:187], a[52:55], v[144:147]
  s_add_u32 s54, s54, 4096
  v_mfma_f32_16x16x32_bf16 v[144:147], v[188:191], a[68:71], v[144:147]
  buffer_load_dwordx4 v[176:179], v26, s[12:15], s40 offen sc1
  v_mfma_f32_16x16x32_bf16 v[144:147], v[192:195], a[84:87], v[144:147]
  v_mfma_f32_16x16x32_bf16 v[148:151], v[184:187], a[56:59], v[148:151]
  v_add_u32 v116, 0x200, v116
  v_mfma_f32_16x16x32_bf16 v[148:151], v[188:191], a[72:75], v[148:151]
  v_mfma_f32_16x16x32_bf16 v[148:151], v[192:195], a[88:91], v[148:151]
  buffer_load_dwordx4 v[180:183], v27, s[12:15], s40 offen sc1
  v_cvt_pk_bf16_f32 v62, v160, v161
  v_mfma_f32_16x16x32_bf16 v[152:155], v[184:187], a[60:63], v[152:155]
  s_add_u32 s40, s40, 12288
  v_mfma_f32_16x16x32_bf16 v[152:155], v[188:191], a[76:79], v[152:155]
  v_mfma_f32_16x16x32_bf16 v[152:155], v[192:195], a[92:95], v[152:155]
  s_waitcnt vmcnt(13)
  v_mfma_f32_16x16x32_bf16 v[140:143], v[196:199], a[96:99], v[140:143]
  buffer_load_dwordx4 v[184:187], v25, s[12:15], s40 offen sc1
  v_cvt_pk_bf16_f32 v63, v162, v163
  v_mfma_f32_16x16x32_bf16 v[140:143], v[200:203], a[112:115], v[140:143]
  v_mfma_f32_16x16x32_bf16 v[140:143], v[204:207], a[128:131], v[140:143]
  buffer_store_dwordx4 v[60:63], v4, s[8:11], s55 offen sc1
  v_mfma_f32_16x16x32_bf16 v[144:147], v[196:199], a[100:103], v[144:147]
  v_mfma_f32_16x16x32_bf16 v[144:147], v[200:203], a[116:119], v[144:147]
  buffer_load_dwordx4 v[188:191], v26, s[12:15], s40 offen sc1
  v_mfma_f32_16x16x32_bf16 v[144:147], v[204:207], a[132:135], v[144:147]
  ds_write_b128 v117, v[60:63]
  v_mfma_f32_16x16x32_bf16 v[148:151], v[196:199], a[104:107], v[148:151]
  v_mfma_f32_16x16x32_bf16 v[148:151], v[200:203], a[120:123], v[148:151]
  s_add_u32 s55, s55, 4096
  v_mfma_f32_16x16x32_bf16 v[148:151], v[204:207], a[136:139], v[148:151]
  buffer_load_dwordx4 v[192:195], v27, s[12:15], s40 offen sc1
  v_mfma_f32_16x16x32_bf16 v[152:155], v[196:199], a[108:111], v[152:155]
  s_add_u32 s40, s40, 12288
  v_mfma_f32_16x16x32_bf16 v[152:155], v[200:203], a[124:127], v[152:155]
  v_mfma_f32_16x16x32_bf16 v[152:155], v[204:207], a[140:143], v[152:155]
  v_add_u32 v117, 0x200, v117
  s_waitcnt vmcnt(14)
  v_mfma_f32_16x16x32_bf16 v[140:143], v[208:211], a[144:147], v[140:143]
  buffer_load_dwordx4 v[196:199], v25, s[12:15], s40 offen sc1
  v_mfma_f32_16x16x32_bf16 v[140:143], v[212:215], a[160:163], v[140:143]
  v_mfma_f32_16x16x32_bf16 v[140:143], v[216:219], a[176:179], v[140:143]
  v_cvt_pk_bf16_f32 v66, v164, v165
  v_mfma_f32_16x16x32_bf16 v[144:147], v[208:211], a[148:151], v[144:147]
  v_mfma_f32_16x16x32_bf16 v[144:147], v[212:215], a[164:167], v[144:147]
  buffer_load_dwordx4 v[200:203], v26, s[12:15], s40 offen sc1
  v_cvt_pk_bf16_f32 v67, v166, v167
  v_mfma_f32_16x16x32_bf16 v[144:147], v[216:219], a[180:183], v[144:147]
  v_mfma_f32_16x16x32_bf16 v[148:151], v[208:211], a[152:155], v[148:151]
  v_mfma_f32_16x16x32_bf16 v[148:151], v[212:215], a[168:171], v[148:151]
  buffer_store_dwordx4 v[64:67], v4, s[8:11], s56 offen sc1
  v_mfma_f32_16x16x32_bf16 v[148:151], v[216:219], a[184:187], v[148:151]
  buffer_load_dwordx4 v[204:207], v27, s[12:15], s40 offen sc1
  v_mfma_f32_16x16x32_bf16 v[152:155], v[208:211], a[156:159], v[152:155]
  s_add_u32 s40, s40, 12288
  v_mfma_f32_16x16x32_bf16 v[152:155], v[212:215], a[172:175], v[152:155]
  ds_write_b128 v118, v[64:67]
  v_mfma_f32_16x16x32_bf16 v[152:155], v[216:219], a[188:191], v[152:155]
  s_waitcnt vmcnt(15)
  v_mfma_f32_16x16x32_bf16 v[140:143], v[220:223], a[192:195], v[140:143]
  buffer_load_dwordx4 v[208:211], v25, s[12:15], s40 offen sc1
  v_mfma_f32_16x16x32_bf16 v[140:143], v[224:227], a[208:211], v[140:143]
  s_add_u32 s56, s56, 4096
  v_mfma_f32_16x16x32_bf16 v[140:143], v[228:231], a[224:227], v[140:143]
  v_mfma_f32_16x16x32_bf16 v[144:147], v[220:223], a[196:199], v[144:147]
  v_add_u32 v118, 0x200, v118
  v_mfma_f32_16x16x32_bf16 v[144:147], v[224:227], a[212:215], v[144:147]
  buffer_load_dwordx4 v[212:215], v26, s[12:15], s40 offen sc1
  v_mfma_f32_16x16x32_bf16 v[144:147], v[228:231], a[228:231], v[144:147]
  v_mfma_f32_16x16x32_bf16 v[148:151], v[220:223], a[200:203], v[148:151]
  v_cvt_pk_bf16_f32 v70, v168, v169
  v_mfma_f32_16x16x32_bf16 v[148:151], v[224:227], a[216:219], v[148:151]
  v_mfma_f32_16x16x32_bf16 v[148:151], v[228:231], a[232:235], v[148:151]
  buffer_load_dwordx4 v[216:219], v27, s[12:15], s40 offen sc1
  v_mfma_f32_16x16x32_bf16 v[152:155], v[220:223], a[204:207], v[152:155]
  s_add_u32 s40, s40, 12288
  v_cvt_pk_bf16_f32 v71, v170, v171
  v_mfma_f32_16x16x32_bf16 v[152:155], v[224:227], a[220:223], v[152:155]
  v_mfma_f32_16x16x32_bf16 v[152:155], v[228:231], a[236:239], v[152:155]
  s_waitcnt vmcnt(15)
  v_mfma_f32_16x16x32_bf16 v[140:143], v[232:235], a[240:243], v[140:143]
  buffer_load_dwordx4 v[220:223], v25, s[12:15], s40 offen sc1
  v_mfma_f32_16x16x32_bf16 v[140:143], v[236:239], v[72:75], v[140:143]
  buffer_store_dwordx4 v[68:71], v4, s[8:11], s57 offen sc1
  v_mfma_f32_16x16x32_bf16 v[140:143], v[240:243], v[88:91], v[140:143]
  v_mfma_f32_16x16x32_bf16 v[144:147], v[232:235], a[244:247], v[144:147]
  ds_write_b128 v119, v[68:71]
  v_mfma_f32_16x16x32_bf16 v[144:147], v[236:239], v[76:79], v[144:147]
  buffer_load_dwordx4 v[224:227], v26, s[12:15], s40 offen sc1
  v_mfma_f32_16x16x32_bf16 v[144:147], v[240:243], v[92:95], v[144:147]
  v_mfma_f32_16x16x32_bf16 v[148:151], v[232:235], a[248:251], v[148:151]
  s_add_u32 s57, s57, 4096
  v_mfma_f32_16x16x32_bf16 v[148:151], v[236:239], v[80:83], v[148:151]
  v_mfma_f32_16x16x32_bf16 v[148:151], v[240:243], v[96:99], v[148:151]
  buffer_load_dwordx4 v[228:231], v27, s[12:15], s40 offen sc1
  v_add_u32 v119, 0x200, v119
  v_mfma_f32_16x16x32_bf16 v[152:155], v[232:235], a[252:255], v[152:155]
  s_add_u32 s40, s40, 12288
  v_mfma_f32_16x16x32_bf16 v[152:155], v[236:239], v[84:87], v[152:155]
  v_mfma_f32_16x16x32_bf16 v[152:155], v[240:243], v[100:103], v[152:155]
  s_add_u32 s42, s42, 1
  s_cmp_lt_u32 s42, 2
  s_cbranch_scc1 L_kf_p2
  s_waitcnt vmcnt(15)
  v_mfma_f32_16x16x32_bf16 v[156:159], v[172:175], a[0:3], 0
  buffer_load_dwordx4 v[232:235], v25, s[12:15], s40 offen sc1
  v_mfma_f32_16x16x32_bf16 v[156:159], v[176:179], a[16:19], v[156:159]
  v_mfma_f32_16x16x32_bf16 v[156:159], v[180:183], a[32:35], v[156:159]
  v_mfma_f32_16x16x32_bf16 v[160:163], v[172:175], a[4:7], 0
  v_mfma_f32_16x16x32_bf16 v[160:163], v[176:179], a[20:23], v[160:163]
  buffer_load_dwordx4 v[236:239], v26, s[12:15], s40 offen sc1
  v_cvt_pk_bf16_f32 v56, v140, v141
  v_mfma_f32_16x16x32_bf16 v[160:163], v[180:183], a[36:39], v[160:163]
  v_mfma_f32_16x16x32_bf16 v[164:167], v[172:175], a[8:11], 0
  v_mfma_f32_16x16x32_bf16 v[164:167], v[176:179], a[24:27], v[164:167]
  v_cvt_pk_bf16_f32 v57, v142, v143
  v_mfma_f32_16x16x32_bf16 v[164:167], v[180:183], a[40:43], v[164:167]
  buffer_load_dwordx4 v[240:243], v27, s[12:15], s40 offen sc1
  v_mfma_f32_16x16x32_bf16 v[168:171], v[172:175], a[12:15], 0
  s_add_u32 s40, s40, 12288
  v_mfma_f32_16x16x32_bf16 v[168:171], v[176:179], a[28:31], v[168:171]
  v_cvt_pk_bf16_f32 v60, v144, v145
  v_mfma_f32_16x16x32_bf16 v[168:171], v[180:183], a[44:47], v[168:171]
  s_waitcnt vmcnt(14)
  v_mfma_f32_16x16x32_bf16 v[156:159], v[184:187], a[48:51], v[156:159]
  buffer_load_dwordx4 v[172:175], v25, s[12:15], s40 offen sc1
  v_mfma_f32_16x16x32_bf16 v[156:159], v[188:191], a[64:67], v[156:159]
  v_mfma_f32_16x16x32_bf16 v[156:159], v[192:195], a[80:83], v[156:159]
  v_cvt_pk_bf16_f32 v61, v146, v147
  v_mfma_f32_16x16x32_bf16 v[160:163], v[184:187], a[52:55], v[160:163]
  v_mfma_f32_16x16x32_bf16 v[160:163], v[188:191], a[68:71], v[160:163]
  buffer_load_dwordx4 v[176:179], v26, s[12:15], s40 offen sc1
  v_mfma_f32_16x16x32_bf16 v[160:163], v[192:195], a[84:87], v[160:163]
  v_cvt_pk_bf16_f32 v64, v148, v149
  v_mfma_f32_16x16x32_bf16 v[164:167], v[184:187], a[56:59], v[164:167]
  v_mfma_f32_16x16x32_bf16 v[164:167], v[188:191], a[72:75], v[164:167]
  v_cvt_pk_bf16_f32 v65, v150, v151
  v_mfma_f32_16x16x32_bf16 v[164:167], v[192:195], a[88:91], v[164:167]
  buffer_load_dwordx4 v[180:183], v27, s[12:15], s40 offen sc1
  v_mfma_f32_16x16x32_bf16 v[168:171], v[184:187], a[60:63], v[168:171]
  s_add_u32 s40, s40, 12288
  v_mfma_f32_16x16x32_bf16 v[168:171], v[188:191], a[76:79], v[168:171]
  v_mfma_f32_16x16x32_bf16 v[168:171], v[192:195], a[92:95], v[168:171]
  v_cvt_pk_bf16_f32 v68, v152, v153
  s_waitcnt vmcnt(13)
  v_mfma_f32_16x16x32_bf16 v[156:159], v[196:199], a[96:99], v[156:159]
  buffer_load_dwordx4 v[184:187], v25, s[12:15], s40 offen sc1
  v_mfma_f32_16x16x32_bf16 v[156:159], v[200:203], a[112:115], v[156:159]
  v_mfma_f32_16x16x32_bf16 v[156:159], v[204:207], a[128:131], v[156:159]
  v_cvt_pk_bf16_f32 v69, v154, v155
  v_mfma_f32_16x16x32_bf16 v[160:163], v[196:199], a[100:103], v[160:163]
  v_mfma_f32_16x16x32_bf16 v[160:163], v[200:203], a[116:119], v[160:163]
  buffer_load_dwordx4 v[188:191], v26, s[12:15], s40 offen sc1
  v_mfma_f32_16x16x32_bf16 v[160:163], v[204:207], a[132:135], v[160:163]
  v_mfma_f32_16x16x32_bf16 v[164:167], v[196:199], a[104:107], v[164:167]
  v_mfma_f32_16x16x32_bf16 v[164:167], v[200:203], a[120:123], v[164:167]
  v_mfma_f32_16x16x32_bf16 v[164:167], v[204:207], a[136:139], v[164:167]
  buffer_load_dwordx4 v[192:195], v27, s[12:15], s40 offen sc1
  v_mfma_f32_16x16x32_bf16 v[168:171], v[196:199], a[108:111], v[168:171]
  s_add_u32 s40, s40, 12288
  v_mfma_f32_16x16x32_bf16 v[168:171], v[200:203], a[124:127], v[168:171]
  v_mfma_f32_16x16x32_bf16 v[168:171], v[204:207], a[140:143], v[168:171]
  s_waitcnt vmcnt(13)
  v_mfma_f32_16x16x32_bf16 v[156:159], v[208:211], a[144:147], v[156:159]
  buffer_load_dwordx4 v[196:199], v25, s[12:15], s40 offen sc1
  v_mfma_f32_16x16x32_bf16 v[156:159], v[212:215], a[160:163], v[156:159]
  v_mfma_f32_16x16x32_bf16 v[156:159], v[216:219], a[176:179], v[156:159]
  v_mfma_f32_16x16x32_bf16 v[160:163], v[208:211], a[148:151], v[160:163]
  v_mfma_f32_16x16x32_bf16 v[160:163], v[212:215], a[164:167], v[160:163]
  buffer_load_dwordx4 v[200:203], v26, s[12:15], s40 offen sc1
  v_mfma_f32_16x16x32_bf16 v[160:163], v[216:219], a[180:183], v[160:163]
  v_mfma_f32_16x16x32_bf16 v[164:167], v[208:211], a[152:155], v[164:167]
  s_cmp_eq_u32 s42, s53
  s_cselect_b32 s58, s52, 2147483632
  v_mfma_f32_16x16x32_bf16 v[164:167], v[212:215], a[168:171], v[164:167]
  v_mfma_f32_16x16x32_bf16 v[164:167], v[216:219], a[184:187], v[164:167]
  buffer_load_dwordx4 v[204:207], v27, s[12:15], s40 offen sc1
  v_mfma_f32_16x16x32_bf16 v[168:171], v[208:211], a[156:159], v[168:171]
  s_add_u32 s40, s40, 12288
  v_mfma_f32_16x16x32_bf16 v[168:171], v[212:215], a[172:175], v[168:171]
  v_mfma_f32_16x16x32_bf16 v[168:171], v[216:219], a[188:191], v[168:171]
  s_waitcnt vmcnt(12)
  v_mfma_f32_16x16x32_bf16 v[156:159], v[220:223], a[192:195], v[156:159]
  buffer_load_dwordx4 v[208:211], v25, s[12:15], s40 offen sc1
  v_mfma_f32_16x16x32_bf16 v[156:159], v[224:227], a[208:211], v[156:159]
  v_mfma_f32_16x16x32_bf16 v[156:159], v[228:231], a[224:227], v[156:159]
  v_mfma_f32_16x16x32_bf16 v[160:163], v[220:223], a[196:199], v[160:163]
  v_mfma_f32_16x16x32_bf16 v[160:163], v[224:227], a[212:215], v[160:163]
  buffer_load_dwordx4 v[212:215], v26, s[12:15], s40 offen sc1
  s_barrier
  s_mov_b64 exec, 1
  buffer_atomic_add v8, off, s[8:11], s58
  s_mov_b64 exec, -1
  v_mfma_f32_16x16x32_bf16 v[160:163], v[228:231], a[228:231], v[160:163]
  v_mfma_f32_16x16x32_bf16 v[164:167], v[220:223], a[200:203], v[164:167]
  v_mfma_f32_16x16x32_bf16 v[164:167], v[224:227], a[216:219], v[164:167]
  v_mfma_f32_16x16x32_bf16 v[164:167], v[228:231], a[232:235], v[164:167]
  buffer_load_dwordx4 v[216:219], v27, s[12:15], s40 offen sc1
  v_mfma_f32_16x16x32_bf16 v[168:171], v[220:223], a[204:207], v[168:171]
  s_add_u32 s40, s40, 12288
  v_mfma_f32_16x16x32_bf16 v[168:171], v[224:227], a[220:223], v[168:171]
  v_mfma_f32_16x16x32_bf16 v[168:171], v[228:231], a[236:239], v[168:171]
  s_waitcnt vmcnt(13)
  v_mfma_f32_16x16x32_bf16 v[156:159], v[232:235], a[240:243], v[156:159]
  buffer_load_dwordx4 v[220:223], v25, s[12:15], s40 offen sc1
  v_mfma_f32_16x16x32_bf16 v[156:159], v[236:239], v[72:75], v[156:159]
  v_mfma_f32_16x16x32_bf16 v[156:159], v[240:243], v[88:91], v[156:159]
  v_mfma_f32_16x16x32_bf16 v[160:163], v[232:235], a[244:247], v[160:163]
  v_mfma_f32_16x16x32_bf16 v[160:163], v[236:239], v[76:79], v[160:163]
  buffer_load_dwordx4 v[224:227], v26, s[12:15], s40 offen sc1
  v_mfma_f32_16x16x32_bf16 v[160:163], v[240:243], v[92:95], v[160:163]
  v_mfma_f32_16x16x32_bf16 v[164:167], v[232:235], a[248:251], v[164:167]
  v_mfma_f32_16x16x32_bf16 v[164:167], v[236:239], v[80:83], v[164:167]
  v_mfma_f32_16x16x32_bf16 v[164:167], v[240:243], v[96:99], v[164:167]
  buffer_load_dwordx4 v[228:231], v27, s[12:15], s40 offen sc1
  v_mfma_f32_16x16x32_bf16 v[168:171], v[232:235], a[252:255], v[168:171]
  s_add_u32 s40, s40, 12288
  v_mfma_f32_16x16x32_bf16 v[168:171], v[236:239], v[84:87], v[168:171]
  v_mfma_f32_16x16x32_bf16 v[168:171], v[240:243], v[100:103], v[168:171]
  s_waitcnt vmcnt(13)
  v_mfma_f32_16x16x32_bf16 v[140:143], v[172:175], a[0:3], 0
  buffer_load_dwordx4 v[232:235], v25, s[12:15], s40 offen sc1
  v_mfma_f32_16x16x32_bf16 v[140:143], v[176:179], a[16:19], v[140:143]
  v_mfma_f32_16x16x32_bf16 v[140:143], v[180:183], a[32:35], v[140:143]
  v_mfma_f32_16x16x32_bf16 v[144:147], v[172:175], a[4:7], 0
  v_mfma_f32_16x16x32_bf16 v[144:147], v[176:179], a[20:23], v[144:147]
  buffer_load_dwordx4 v[236:239], v26, s[12:15], s40 offen sc1
  v_cvt_pk_bf16_f32 v58, v156, v157
  v_mfma_f32_16x16x32_bf16 v[144:147], v[180:183], a[36:39], v[144:147]
  v_mfma_f32_16x16x32_bf16 v[148:151], v[172:175], a[8:11], 0
  v_cvt_pk_bf16_f32 v59, v158, v159
  v_mfma_f32_16x16x32_bf16 v[148:151], v[176:179], a[24:27], v[148:151]
  v_mfma_f32_16x16x32_bf16 v[148:151], v[180:183], a[40:43], v[148:151]
  buffer_load_dwordx4 v[240:243], v27, s[12:15], s40 offen sc1
  v_mfma_f32_16x16x32_bf16 v[152:155], v[172:175], a[12:15], 0
  s_add_u32 s40, s40, 12288
  buffer_store_dwordx4 v[56:59], v4, s[8:11], s54 offen sc1
  v_mfma_f32_16x16x32_bf16 v[152:155], v[176:179], a[28:31], v[152:155]
  v_mfma_f32_16x16x32_bf16 v[152:155], v[180:183], a[44:47], v[152:155]
  s_waitcnt vmcnt(14)
  v_mfma_f32_16x16x32_bf16 v[140:143], v[184:187], a[48:51], v[140:143]
  buffer_load_dwordx4 v[172:175], v25, s[12:15], s40 offen sc1
  ds_write_b128 v116, v[56:59]
  v_mfma_f32_16x16x32_bf16 v[140:143], v[188:191], a[64:67], v[140:143]
  v_mfma_f32_16x16x32_bf16 v[140:143], v[192:195], a[80:83], v[140:143]
  v_mfma_f32_16x16x32_bf16 v[144:147], v[184:187], a[52:55], v[144:147]
  s_add_u32 s54, s54, 4096
  v_mfma_f32_16x16x32_bf16 v[144:147], v[188:191], a[68:71], v[144:147]
  buffer_load_dwordx4 v[176:179], v26, s[12:15], s40 offen sc1
  v_mfma_f32_16x16x32_bf16 v[144:147], v[192:195], a[84:87], v[144:147]
  v_add_u32 v116, 0x200, v116
  v_mfma_f32_16x16x32_bf16 v[148:151], v[184:187], a[56:59], v[148:151]
  v_mfma_f32_16x16x32_bf16 v[148:151], v[188:191], a[72:75], v[148:151]
  v_cvt_pk_bf16_f32 v62, v160, v161
  v_mfma_f32_16x16x32_bf16 v[148:151], v[192:195], a[88:91], v[148:151]
  buffer_load_dwordx4 v[180:183], v27, s[12:15], s40 offen sc1
  v_mfma_f32_16x16x32_bf16 v[152:155], v[184:187], a[60:63], v[152:155]
  s_add_u32 s40, s40, 12288
  v_mfma_f32_16x16x32_bf16 v[152:155], v[188:191], a[76:79], v[152:155]
  v_cvt_pk_bf16_f32 v63, v162, v163
  v_mfma_f32_16x16x32_bf16 v[152:155], v[192:195], a[92:95], v[152:155]
  s_waitcnt vmcnt(14)
  v_mfma_f32_16x16x32_bf16 v[140:143], v[196:199], a[96:99], v[140:143]
  buffer_load_dwordx4 v[184:187], v25, s[12:15], s40 offen sc1
  v_mfma_f32_16x16x32_bf16 v[140:143], v[200:203], a[112:115], v[140:143]
  v_mfma_f32_16x16x32_bf16 v[140:143], v[204:207], a[128:131], v[140:143]
  buffer_store_dwordx4 v[60:63], v4, s[8:11], s55 offen sc1
  v_mfma_f32_16x16x32_bf16 v[144:147], v[196:199], a[100:103], v[144:147]
  v_mfma_f32_16x16x32_bf16 v[144:147], v[200:203], a[116:119], v[144:147]
  buffer_load_dwordx4 v[188:191], v26, s[12:15], s40 offen sc1
  ds_write_b128 v117, v[60:63]
  v_mfma_f32_16x16x32_bf16 v[144:147], v[204:207], a[132:135], v[144:147]
  v_mfma_f32_16x16x32_bf16 v[148:151], v[196:199], a[104:107], v[148:151]
  s_add_u32 s55, s55, 4096
  v_mfma_f32_16x16x32_bf16 v[148:151], v[200:203], a[120:123], v[148:151]
  v_mfma_f32_16x16x32_bf16 v[148:151], v[204:207], a[136:139], v[148:151]
  buffer_load_dwordx4 v[192:195], v27, s[12:15], s40 offen sc1
  v_mfma_f32_16x16x32_bf16 v[152:155], v[196:199], a[108:111], v[152:155]
  s_add_u32 s40, s40, 12288
  v_mfma_f32_16x16x32_bf16 v[152:155], v[200:203], a[124:127], v[152:155]
  v_add_u32 v117, 0x200, v117
  v_mfma_f32_16x16x32_bf16 v[152:155], v[204:207], a[140:143], v[152:155]
  s_waitcnt vmcnt(14)
  v_mfma_f32_16x16x32_bf16 v[140:143], v[208:211], a[144:147], v[140:143]
  buffer_load_dwordx4 v[196:199], v25, s[12:15], s40 offen sc1
  v_mfma_f32_16x16x32_bf16 v[140:143], v[212:215], a[160:163], v[140:143]
  v_cvt_pk_bf16_f32 v66, v164, v165
  v_mfma_f32_16x16x32_bf16 v[140:143], v[216:219], a[176:179], v[140:143]
  v_mfma_f32_16x16x32_bf16 v[144:147], v[208:211], a[148:151], v[144:147]
  v_cvt_pk_bf16_f32 v67, v166, v167
  v_mfma_f32_16x16x32_bf16 v[144:147], v[212:215], a[164:167], v[144:147]
  buffer_load_dwordx4 v[200:203], v26, s[12:15], s40 offen sc1
  v_mfma_f32_16x16x32_bf16 v[144:147], v[216:219], a[180:183], v[144:147]
  buffer_store_dwordx4 v[64:67], v4, s[8:11], s56 offen sc1
  v_mfma_f32_16x16x32_bf16 v[148:151], v[208:211], a[152:155], v[148:151]
  v_mfma_f32_16x16x32_bf16 v[148:151], v[212:215], a[168:171], v[148:151]
  v_mfma_f32_16x16x32_bf16 v[148:151], v[216:219], a[184:187], v[148:151]
  buffer_load_dwordx4 v[204:207], v27, s[12:15], s40 offen sc1
  ds_write_b128 v118, v[64:67]
  v_mfma_f32_16x16x32_bf16 v[152:155], v[208:211], a[156:159], v[152:155]
  s_add_u32 s40, s40, 12288
  v_mfma_f32_16x16x32_bf16 v[152:155], v[212:215], a[172:175], v[152:155]
  v_mfma_f32_16x16x32_bf16 v[152:155], v[216:219], a[188:191], v[152:155]
  s_add_u32 s56, s56, 4096
  s_waitcnt vmcnt(15)
  v_mfma_f32_16x16x32_bf16 v[140:143], v[220:223], a[192:195], v[140:143]
  buffer_load_dwordx4 v[208:211], v25, s[12:15], s40 offen sc1
  v_mfma_f32_16x16x32_bf16 v[140:143], v[224:227], a[208:211], v[140:143]
  v_mfma_f32_16x16x32_bf16 v[140:143], v[228:231], a[224:227], v[140:143]
  v_add_u32 v118, 0x200, v118
  v_mfma_f32_16x16x32_bf16 v[144:147], v[220:223], a[196:199], v[144:147]
  v_mfma_f32_16x16x32_bf16 v[144:147], v[224:227], a[212:215], v[144:147]
  buffer_load_dwordx4 v[212:215], v26, s[12:15], s40 offen sc1
  v_mfma_f32_16x16x32_bf16 v[144:147], v[228:231], a[228:231], v[144:147]
  v_cvt_pk_bf16_f32 v70, v168, v169
  v_mfma_f32_16x16x32_bf16 v[148:151], v[220:223], a[200:203], v[148:151]
  v_mfma_f32_16x16x32_bf16 v[148:151], v[224:227], a[216:219], v[148:151]
  v_cvt_pk_bf16_f32 v71, v170, v171
  v_mfma_f32_16x16x32_bf16 v[148:151], v[228:231], a[232:235], v[148:151]
  buffer_load_dwordx4 v[216:219], v27, s[12:15], s40 offen sc1
  v_mfma_f32_16x16x32_bf16 v[152:155], v[220:223], a[204:207], v[152:155]
  s_add_u32 s40, s40, 12288
  v_mfma_f32_16x16x32_bf16 v[152:155], v[224:227], a[220:223], v[152:155]
  buffer_store_dwordx4 v[68:71], v4, s[8:11], s57 offen sc1
  v_mfma_f32_16x16x32_bf16 v[152:155], v[228:231], a[236:239], v[152:155]
  s_waitcnt vmcnt(16)
  v_mfma_f32_16x16x32_bf16 v[140:143], v[232:235], a[240:243], v[140:143]
  buffer_load_dwordx4 v[220:223], v25, s[12:15], s40 offen sc1
  v_mfma_f32_16x16x32_bf16 v[140:143], v[236:239], v[72:75], v[140:143]
  ds_write_b128 v119, v[68:71]
  v_mfma_f32_16x16x32_bf16 v[140:143], v[240:243], v[88:91], v[140:143]
  v_mfma_f32_16x16x32_bf16 v[144:147], v[232:235], a[244:247], v[144:147]
  s_add_u32 s57, s57, 4096
  v_mfma_f32_16x16x32_bf16 v[144:147], v[236:239], v[76:79], v[144:147]
  buffer_load_dwordx4 v[224:227], v26, s[12:15], s40 offen sc1
  v_mfma_f32_16x16x32_bf16 v[144:147], v[240:243], v[92:95], v[144:147]
  v_mfma_f32_16x16x32_bf16 v[148:151], v[232:235], a[248:251], v[148:151]
  v_add_u32 v119, 0x200, v119
  v_mfma_f32_16x16x32_bf16 v[148:151], v[236:239], v[80:83], v[148:151]
  v_mfma_f32_16x16x32_bf16 v[148:151], v[240:243], v[96:99], v[148:151]
  buffer_load_dwordx4 v[228:231], v27, s[12:15], s40 offen sc1
  buffer_load_dword v7, off, s[8:11], s52 sc1
  v_mfma_f32_16x16x32_bf16 v[152:155], v[232:235], a[252:255], v[152:155]
  s_add_u32 s40, s40, 12288
  v_mfma_f32_16x16x32_bf16 v[152:155], v[236:239], v[84:87], v[152:155]
  v_mfma_f32_16x16x32_bf16 v[152:155], v[240:243], v[100:103], v[152:155]
  s_waitcnt vmcnt(16)
  v_mfma_f32_16x16x32_bf16 v[156:159], v[172:175], a[0:3], 0
  buffer_load_dwordx4 v[232:235], v25, s[12:15], s40 offen sc1
  v_mfma_f32_16x16x32_bf16 v[156:159], v[176:179], a[16:19], v[156:159]
  v_mfma_f32_16x16x32_bf16 v[156:159], v[180:183], a[32:35], v[156:159]
  v_mfma_f32_16x16x32_bf16 v[160:163], v[172:175], a[4:7], 0
  v_mfma_f32_16x16x32_bf16 v[160:163], v[176:179], a[20:23], v[160:163]
  buffer_load_dwordx4 v[236:239], v26, s[12:15], s40 offen sc1
  v_cvt_pk_bf16_f32 v56, v140, v141
  v_mfma_f32_16x16x32_bf16 v[160:163], v[180:183], a[36:39], v[160:163]
  v_mfma_f32_16x16x32_bf16 v[164:167], v[172:175], a[8:11], 0
  v_cvt_pk_bf16_f32 v57, v142, v143
  v_mfma_f32_16x16x32_bf16 v[164:167], v[176:179], a[24:27], v[164:167]
  v_mfma_f32_16x16x32_bf16 v[164:167], v[180:183], a[40:43], v[164:167]
  buffer_load_dwordx4 v[240:243], v27, s[12:15], s40 offen sc1
  v_cvt_pk_bf16_f32 v60, v144, v145
  v_mfma_f32_16x16x32_bf16 v[168:171], v[172:175], a[12:15], 0
  s_add_u32 s40, s40, 12288
  v_mfma_f32_16x16x32_bf16 v[168:171], v[176:179], a[28:31], v[168:171]
  v_mfma_f32_16x16x32_bf16 v[168:171], v[180:183], a[44:47], v[168:171]
  v_cvt_pk_bf16_f32 v61, v146, v147
  s_waitcnt vmcnt(15)
  v_mfma_f32_16x16x32_bf16 v[156:159], v[184:187], a[48:51], v[156:159]
  s_waitcnt vmcnt(3)
  v_readfirstlane_b32 s35, v7
  s_nop 1
  s_cmp_ge_u32 s35, 8
  s_cbranch_scc0 L_kf_go4
  L_kf_ok4:
  v_mfma_f32_16x16x32_bf16 v[156:159], v[188:191], a[64:67], v[156:159]
  s_add_u32 m0, s37, 2048
  v_mfma_f32_16x16x32_bf16 v[156:159], v[192:195], a[80:83], v[156:159]
  buffer_load_dwordx4 v107, s[8:11], s89 offen sc1 lds
  v_mfma_f32_16x16x32_bf16 v[160:163], v[184:187], a[52:55], v[160:163]
  s_add_u32 m0, s37, 3072
  v_mfma_f32_16x16x32_bf16 v[160:163], v[188:191], a[68:71], v[160:163]
  buffer_load_dwordx4 v107, s[8:11], s90 offen sc1 lds
  v_cvt_pk_bf16_f32 v64, v148, v149
  v_mfma_f32_16x16x32_bf16 v[160:163], v[192:195], a[84:87], v[160:163]
  s_add_u32 m0, s37, 4096
  v_mfma_f32_16x16x32_bf16 v[164:167], v[184:187], a[56:59], v[164:167]
  buffer_load_dwordx4 v107, s[8:11], s91 offen sc1 lds
  v_mfma_f32_16x16x32_bf16 v[164:167], v[188:191], a[72:75], v[164:167]
  s_add_u32 m0, s37, 5120
  v_mfma_f32_16x16x32_bf16 v[164:167], v[192:195], a[88:91], v[164:167]
  buffer_load_dwordx4 v107, s[8:11], s92 offen sc1 lds
  v_cvt_pk_bf16_f32 v65, v150, v151
  v_mfma_f32_16x16x32_bf16 v[168:171], v[184:187], a[60:63], v[168:171]
  s_add_u32 m0, s37, 6144
  v_mfma_f32_16x16x32_bf16 v[168:171], v[188:191], a[76:79], v[168:171]
  buffer_load_dwordx4 v107, s[8:11], s93 offen sc1 lds
  v_mfma_f32_16x16x32_bf16 v[168:171], v[192:195], a[92:95], v[168:171]
  v_mfma_f32_16x16x32_bf16 v[156:159], v[196:199], a[96:99], v[156:159]
  v_cvt_pk_bf16_f32 v68, v152, v153
  v_mfma_f32_16x16x32_bf16 v[156:159], v[200:203], a[112:115], v[156:159]
  v_mfma_f32_16x16x32_bf16 v[156:159], v[204:207], a[128:131], v[156:159]
  v_cvt_pk_bf16_f32 v69, v154, v155
  v_mfma_f32_16x16x32_bf16 v[160:163], v[196:199], a[100:103], v[160:163]
  v_mfma_f32_16x16x32_bf16 v[160:163], v[200:203], a[116:119], v[160:163]
  v_add_u32 v120, s37, v4
  v_mfma_f32_16x16x32_bf16 v[160:163], v[204:207], a[132:135], v[160:163]
  v_mfma_f32_16x16x32_bf16 v[164:167], v[196:199], a[104:107], v[164:167]
  s_and_b32 s48, s44, 1
  v_mfma_f32_16x16x32_bf16 v[164:167], v[200:203], a[120:123], v[164:167]
  v_mfma_f32_16x16x32_bf16 v[164:167], v[204:207], a[136:139], v[164:167]
  s_lshl_b32 s48, s48, 3
  v_mfma_f32_16x16x32_bf16 v[168:171], v[196:199], a[108:111], v[168:171]
  v_mfma_f32_16x16x32_bf16 v[168:171], v[200:203], a[124:127], v[168:171]
  s_add_u32 s48, s48, s37
  v_mfma_f32_16x16x32_bf16 v[168:171], v[204:207], a[140:143], v[168:171]
  v_mfma_f32_16x16x32_bf16 v[156:159], v[208:211], a[144:147], v[156:159]
  v_lshlrev_b32 v121, 4, v2
  v_mfma_f32_16x16x32_bf16 v[156:159], v[212:215], a[160:163], v[156:159]
  v_mfma_f32_16x16x32_bf16 v[156:159], v[216:219], a[176:179], v[156:159]
  v_add_u32 v121, s48, v121
  v_mfma_f32_16x16x32_bf16 v[160:163], v[208:211], a[148:151], v[160:163]
  v_mfma_f32_16x16x32_bf16 v[160:163], v[212:215], a[164:167], v[160:163]
  v_lshrrev_b32 v5, 2, v2
  v_mfma_f32_16x16x32_bf16 v[160:163], v[216:219], a[180:183], v[160:163]
  v_mfma_f32_16x16x32_bf16 v[164:167], v[208:211], a[152:155], v[164:167]
  v_cmp_eq_u32 vcc, v5, v3
  v_mfma_f32_16x16x32_bf16 v[164:167], v[212:215], a[168:171], v[164:167]
  v_mfma_f32_16x16x32_bf16 v[164:167], v[216:219], a[184:187], v[164:167]
  v_and_b32 v5, 1, v2
  v_mfma_f32_16x16x32_bf16 v[168:171], v[208:211], a[156:159], v[168:171]
  v_mfma_f32_16x16x32_bf16 v[168:171], v[212:215], a[172:175], v[168:171]
  v_lshlrev_b32 v5, 4, v5
  v_mfma_f32_16x16x32_bf16 v[168:171], v[216:219], a[188:191], v[168:171]
  v_mfma_f32_16x16x32_bf16 v[156:159], v[220:223], a[192:195], v[156:159]
  v_mfma_f32_16x16x32_bf16 v[156:159], v[224:227], a[208:211], v[156:159]
  s_movk_i32 s46, 0x3f80
  v_mfma_f32_16x16x32_bf16 v[156:159], v[228:231], a[224:227], v[156:159]
  v_mfma_f32_16x16x32_bf16 v[160:163], v[220:223], a[196:199], v[160:163]
  v_lshlrev_b32 v5, v5, s46
  v_mfma_f32_16x16x32_bf16 v[160:163], v[224:227], a[212:215], v[160:163]
  v_mfma_f32_16x16x32_bf16 v[160:163], v[228:231], a[228:231], v[160:163]
  v_cndmask_b32 v5, 0, v5, vcc
  v_mfma_f32_16x16x32_bf16 v[164:167], v[220:223], a[200:203], v[164:167]
  v_mfma_f32_16x16x32_bf16 v[164:167], v[224:227], a[216:219], v[164:167]
  v_and_b32 v6, 2, v2
  v_mfma_f32_16x16x32_bf16 v[164:167], v[228:231], a[232:235], v[164:167]
  v_mfma_f32_16x16x32_bf16 v[168:171], v[220:223], a[204:207], v[168:171]
  v_cmp_eq_u32 vcc, 0, v6
  v_mfma_f32_16x16x32_bf16 v[168:171], v[224:227], a[220:223], v[168:171]
  v_mfma_f32_16x16x32_bf16 v[168:171], v[228:231], a[236:239], v[168:171]
  v_mov_b32 v124, 0
  s_waitcnt vmcnt(5)
  v_mfma_f32_16x16x32_bf16 v[156:159], v[232:235], a[240:243], v[156:159]
  v_mfma_f32_16x16x32_bf16 v[156:159], v[236:239], v[72:75], v[156:159]
  v_mov_b32 v125, 0
  v_mfma_f32_16x16x32_bf16 v[156:159], v[240:243], v[88:91], v[156:159]
  v_mfma_f32_16x16x32_bf16 v[160:163], v[232:235], a[244:247], v[160:163]
  v_cndmask_b32 v126, 0, v5, vcc
  v_mfma_f32_16x16x32_bf16 v[160:163], v[236:239], v[76:79], v[160:163]
  v_mfma_f32_16x16x32_bf16 v[160:163], v[240:243], v[92:95], v[160:163]
  v_cndmask_b32 v127, v5, 0, vcc
  v_mfma_f32_16x16x32_bf16 v[164:167], v[232:235], a[248:251], v[164:167]
  v_mfma_f32_16x16x32_bf16 v[164:167], v[236:239], v[80:83], v[164:167]
  v_mov_b32 v128, 0
  v_mfma_f32_16x16x32_bf16 v[164:167], v[240:243], v[96:99], v[164:167]
  v_mfma_f32_16x16x32_bf16 v[168:171], v[232:235], a[252:255], v[168:171]
  v_mov_b32 v129, 0
  v_mfma_f32_16x16x32_bf16 v[168:171], v[236:239], v[84:87], v[168:171]
  v_mfma_f32_16x16x32_bf16 v[168:171], v[240:243], v[100:103], v[168:171]
  v_cvt_pk_bf16_f32 v58, v156, v157
  v_cvt_pk_bf16_f32 v59, v158, v159
  buffer_store_dwordx4 v[56:59], v4, s[8:11], s54 offen sc1
  ds_write_b128 v116, v[56:59]
  v_cvt_pk_bf16_f32 v62, v160, v161
  v_cvt_pk_bf16_f32 v63, v162, v163
  buffer_store_dwordx4 v[60:63], v4, s[8:11], s55 offen sc1
  ds_write_b128 v117, v[60:63]
  v_cvt_pk_bf16_f32 v66, v164, v165
  v_cvt_pk_bf16_f32 v67, v166, v167
  buffer_store_dwordx4 v[64:67], v4, s[8:11], s56 offen sc1
  ds_write_b128 v118, v[64:67]
  v_cvt_pk_bf16_f32 v70, v168, v169
  v_cvt_pk_bf16_f32 v71, v170, v171
  buffer_store_dwordx4 v[68:71], v4, s[8:11], s57 offen sc1
  ds_write_b128 v119, v[68:71]
  s_waitcnt vmcnt(0)
  s_waitcnt lgkmcnt(0)
  s_barrier
  s_cmp_lg_u32 s32, 0
  s_cbranch_scc1 L_kf_ar5
  s_mov_b64 exec, 1
  buffer_atomic_add v8, off, s[8:11], s50
  s_mov_b64 exec, -1
  L_kf_ar5:
  s_add_u32 m0, s37, 7168
  s_nop 0
  buffer_load_dwordx4 v107, s[8:11], s94 offen sc1 lds
  s_add_u32 m0, s37, 8192
  s_nop 0
  buffer_load_dwordx4 v107, s[8:11], s95 offen sc1 lds
  s_add_u32 m0, s37, 9216
  s_mov_b32 exec_hi, 0
  buffer_load_dwordx4 v109, s[8:11], s88 offen sc1 lds
  s_mov_b32 exec_hi, -1
  s_add_u32 m0, s37, 9728
  s_mov_b32 exec_hi, 0
  buffer_load_dwordx4 v109, s[8:11], s89 offen sc1 lds
  s_mov_b32 exec_hi, -1
  s_add_u32 m0, s37, 10240
  s_mov_b32 exec_hi, 0
  buffer_load_dwordx4 v109, s[8:11], s90 offen sc1 lds
  s_mov_b32 exec_hi, -1
  s_add_u32 m0, s37, 10752
  s_mov_b32 exec_hi, 0
  buffer_load_dwordx4 v109, s[8:11], s91 offen sc1 lds
  s_mov_b32 exec_hi, -1
  s_add_u32 m0, s37, 11264
  s_mov_b32 exec_hi, 0
  buffer_load_dwordx4 v109, s[8:11], s92 offen sc1 lds
  s_mov_b32 exec_hi, -1
  s_add_u32 m0, s37, 11776
  s_mov_b32 exec_hi, 0
  buffer_load_dwordx4 v109, s[8:11], s93 offen sc1 lds
  s_mov_b32 exec_hi, -1
  s_add_u32 m0, s37, 12288
  s_mov_b32 exec_hi, 0
  buffer_load_dwordx4 v109, s[8:11], s94 offen sc1 lds
  s_mov_b32 exec_hi, -1
  s_add_u32 m0, s37, 12800
  s_mov_b32 exec_hi, 0
  buffer_load_dwordx4 v109, s[8:11], s95 offen sc1 lds
  s_mov_b32 exec_hi, -1
  buffer_load_dwordx4 v[32:35], v110, s[8:11], s39 offen sc1
  buffer_load_dwordx4 v[36:39], v113, s[24:27], 0 offen
  buffer_load_dwordx4 v[40:43], v111, s[8:11], s39 offen sc1
  buffer_load_dwordx4 v[44:47], v114, s[24:27], 0 offen
  buffer_load_dwordx4 v[48:51], v112, s[8:11], s39 offen sc1
  buffer_load_dwordx4 v[52:55], v115, s[24:27], 0 offen
  s_mov_b32 s36, 0
  L_kf_sp6:
  buffer_load_dword v7, off, s[8:11], s50 sc1
  s_waitcnt vmcnt(0)
  v_readfirstlane_b32 s35, v7
  s_add_u32 s36, s36, 1
  s_cmp_ge_u32 s35, 8
  s_cbranch_scc1 L_kf_ok6
  s_sleep 6
  s_cmp_lt_u32 s36, 4194304
  s_cbranch_scc1 L_kf_sp6
  L_kf_ok6:
  s_waitcnt vmcnt(0)
  buffer_load_dwordx4 a[36:39], v108, s[8:11], s89 offen sc1
  buffer_load_dwordx4 a[40:43], v108, s[8:11], s90 offen sc1
  buffer_load_dwordx4 a[44:47], v108, s[8:11], s91 offen sc1
  buffer_load_dwordx4 a[48:51], v108, s[8:11], s92 offen sc1
  buffer_load_dwordx4 a[52:55], v108, s[8:11], s93 offen sc1
  buffer_load_dwordx4 a[56:59], v108, s[8:11], s94 offen sc1
  buffer_load_dwordx4 a[60:63], v108, s[8:11], s95 offen sc1
  s_waitcnt vmcnt(7)
  ds_read_b128 a[0:3], v120 offset:0
  ds_read_b128 a[4:7], v120 offset:2048
  ds_read_b128 a[8:11], v120 offset:3072
  ds_read_b128 a[12:15], v120 offset:4096
  ds_read_b128 a[16:19], v120 offset:5120
  ds_read_b128 a[20:23], v120 offset:6144
  ds_read_b128 a[24:27], v120 offset:7168
  ds_read_b128 a[28:31], v120 offset:8192
  ds_read_b128 a[32:35], v120 offset:1024
  v_mfma_f32_16x16x32_bf16 v[140:143], v[126:129], v[32:35], 0
  v_mfma_f32_16x16x32_bf16 v[144:147], v[124:127], v[32:35], 0
  v_mfma_f32_16x16x32_bf16 v[140:143], v[126:129], v[36:39], v[140:143]
  v_mfma_f32_16x16x32_bf16 v[144:147], v[124:127], v[36:39], v[144:147]
  v_mfma_f32_16x16x32_bf16 v[148:151], v[126:129], v[40:43], 0
  v_mfma_f32_16x16x32_bf16 v[152:155], v[124:127], v[40:43], 0
  v_mfma_f32_16x16x32_bf16 v[148:151], v[126:129], v[44:47], v[148:151]
  v_mfma_f32_16x16x32_bf16 v[152:155], v[124:127], v[44:47], v[152:155]
  v_mfma_f32_16x16x32_bf16 v[156:159], v[126:129], v[48:51], 0
  v_mfma_f32_16x16x32_bf16 v[160:163], v[124:127], v[48:51], 0
  v_mfma_f32_16x16x32_bf16 v[156:159], v[126:129], v[52:55], v[156:159]
  v_mfma_f32_16x16x32_bf16 v[160:163], v[124:127], v[52:55], v[160:163]
  ds_read_b64 a[64:65], v121 offset:9216
  ds_read_b64 a[66:67], v121 offset:9472
  ds_read_b64 a[68:69], v121 offset:9728
  ds_read_b64 a[70:71], v121 offset:9984
  ds_read_b64 a[72:73], v121 offset:10240
  ds_read_b64 a[74:75], v121 offset:10496
  ds_read_b64 a[76:77], v121 offset:10752
  ds_read_b64 a[78:79], v121 offset:11008
  ds_read_b64 a[80:81], v121 offset:11264
  ds_read_b64 a[82:83], v121 offset:11520
  ds_read_b64 a[84:85], v121 offset:11776
  ds_read_b64 a[86:87], v121 offset:12032
  ds_read_b64 a[88:89], v121 offset:12288
  ds_read_b64 a[90:91], v121 offset:12544
  ds_read_b64 a[92:93], v121 offset:12800
  ds_read_b64 a[94:95], v121 offset:13056
  s_waitcnt lgkmcnt(15)
  v_mfma_f32_16x16x32_bf16 v[140:143], v[126:129], a[0:3], v[140:143]
  v_mfma_f32_16x16x32_bf16 v[144:147], v[124:127], a[0:3], v[144:147]
  v_mfma_f32_16x16x32_bf16 v[140:143], v[126:129], a[4:7], v[140:143]
  v_mfma_f32_16x16x32_bf16 v[144:147], v[124:127], a[4:7], v[144:147]
  v_mfma_f32_16x16x32_bf16 v[140:143], v[126:129], a[8:11], v[140:143]
  v_mfma_f32_16x16x32_bf16 v[144:147], v[124:127], a[8:11], v[144:147]
  v_mfma_f32_16x16x32_bf16 v[140:143], v[126:129], a[12:15], v[140:143]
  v_mfma_f32_16x16x32_bf16 v[144:147], v[124:127], a[12:15], v[144:147]
  v_mfma_f32_16x16x32_bf16 v[140:143], v[126:129], a[16:19], v[140:143]
  v_mfma_f32_16x16x32_bf16 v[144:147], v[124:127], a[16:19], v[144:147]
  v_mfma_f32_16x16x32_bf16 v[140:143], v[126:129], a[20:23], v[140:143]
  v_mfma_f32_16x16x32_bf16 v[144:147], v[124:127], a[20:23], v[144:147]
  v_mfma_f32_16x16x32_bf16 v[140:143], v[126:129], a[24:27], v[140:143]
  v_mfma_f32_16x16x32_bf16 v[144:147], v[124:127], a[24:27], v[144:147]
  v_mfma_f32_16x16x32_bf16 v[140:143], v[126:129], a[28:31], v[140:143]
  v_mfma_f32_16x16x32_bf16 v[144:147], v[124:127], a[28:31], v[144:147]
  s_nop 6
  v_cvt_pk_bf16_f32 v172, v140, v141
  v_cvt_pk_bf16_f32 v173, v142, v143
  v_cvt_pk_bf16_f32 v174, v144, v145
  v_cvt_pk_bf16_f32 v175, v146, v147
  buffer_store_dwordx4 v[172:175], v104, s[28:31], 0 offen
  s_waitcnt lgkmcnt(14)
  v_mfma_f32_16x16x32_bf16 v[156:159], v[126:129], a[64:67], v[156:159]
  v_mfma_f32_16x16x32_bf16 v[160:163], v[124:127], a[64:67], v[160:163]
  s_waitcnt lgkmcnt(12)
  v_mfma_f32_16x16x32_bf16 v[156:159], v[126:129], a[68:71], v[156:159]
  v_mfma_f32_16x16x32_bf16 v[160:163], v[124:127], a[68:71], v[160:163]
  s_waitcnt lgkmcnt(10)
  v_mfma_f32_16x16x32_bf16 v[156:159], v[126:129], a[72:75], v[156:159]
  v_mfma_f32_16x16x32_bf16 v[160:163], v[124:127], a[72:75], v[160:163]
  s_waitcnt lgkmcnt(8)
  v_mfma_f32_16x16x32_bf16 v[156:159], v[126:129], a[76:79], v[156:159]
  v_mfma_f32_16x16x32_bf16 v[160:163], v[124:127], a[76:79], v[160:163]
  s_waitcnt lgkmcnt(6)
  v_mfma_f32_16x16x32_bf16 v[156:159], v[126:129], a[80:83], v[156:159]
  v_mfma_f32_16x16x32_bf16 v[160:163], v[124:127], a[80:83], v[160:163]
  s_waitcnt lgkmcnt(4)
  v_mfma_f32_16x16x32_bf16 v[156:159], v[126:129], a[84:87], v[156:159]
  v_mfma_f32_16x16x32_bf16 v[160:163], v[124:127], a[84:87], v[160:163]
  s_waitcnt lgkmcnt(2)
  v_mfma_f32_16x16x32_bf16 v[156:159], v[126:129], a[88:91], v[156:159]
  v_mfma_f32_16x16x32_bf16 v[160:163], v[124:127], a[88:91], v[160:163]
  s_waitcnt lgkmcnt(0)
  v_mfma_f32_16x16x32_bf16 v[156:159], v[126:129], a[92:95], v[156:159]
  v_mfma_f32_16x16x32_bf16 v[160:163], v[124:127], a[92:95], v[160:163]
  s_nop 6
  v_cvt_pk_bf16_f32 v180, v156, v157
  v_cvt_pk_bf16_f32 v181, v158, v159
  v_cvt_pk_bf16_f32 v182, v160, v161
  v_cvt_pk_bf16_f32 v183, v162, v163
  buffer_store_dwordx4 v[180:183], v106, s[28:31], 0 offen
  v_mfma_f32_16x16x32_bf16 v[148:151], v[126:129], a[32:35], v[148:151]
  v_mfma_f32_16x16x32_bf16 v[152:155], v[124:127], a[32:35], v[152:155]
  s_waitcnt vmcnt(8)
  v_mfma_f32_16x16x32_bf16 v[148:151], v[126:129], a[36:39], v[148:151]
  v_mfma_f32_16x16x32_bf16 v[152:155], v[124:127], a[36:39], v[152:155]
  s_waitcnt vmcnt(7)
  v_mfma_f32_16x16x32_bf16 v[148:151], v[126:129], a[40:43], v[148:151]
  v_mfma_f32_16x16x32_bf16 v[152:155], v[124:127], a[40:43], v[152:155]
  s_waitcnt vmcnt(6)
  v_mfma_f32_16x16x32_bf16 v[148:151], v[126:129], a[44:47], v[148:151]
  v_mfma_f32_16x16x32_bf16 v[152:155], v[124:127], a[44:47], v[152:155]
  s_waitcnt vmcnt(5)
  v_mfma_f32_16x16x32_bf16 v[148:151], v[126:129], a[48:51], v[148:151]
  v_mfma_f32_16x16x32_bf16 v[152:155], v[124:127], a[48:51], v[152:155]
  s_waitcnt vmcnt(4)
  v_mfma_f32_16x16x32_bf16 v[148:151], v[126:129], a[52:55], v[148:151]
  v_mfma_f32_16x16x32_bf16 v[152:155], v[124:127], a[52:55], v[152:155]
  s_waitcnt vmcnt(3)
  v_mfma_f32_16x16x32_bf16 v[148:151], v[126:129], a[56:59], v[148:151]
  v_mfma_f32_16x16x32_bf16 v[152:155], v[124:127], a[56:59], v[152:155]
  s_waitcnt vmcnt(2)
  v_mfma_f32_16x16x32_bf16 v[148:151], v[126:129], a[60:63], v[148:151]
  v_mfma_f32_16x16x32_bf16 v[152:155], v[124:127], a[60:63], v[152:155]
  s_nop 6
  v_cvt_pk_bf16_f32 v176, v148, v149
  v_cvt_pk_bf16_f32 v177, v150, v151
  v_cvt_pk_bf16_f32 v178, v152, v153
  v_cvt_pk_bf16_f32 v179, v154, v155
  buffer_store_dwordx4 v[176:179], v105, s[28:31], 0 offen
L_kf_end:
  s_endpgm
  L_kf_go3:
  s_mov_b32 s36, 0
  L_kf_sp3:
  buffer_load_dword v7, off, s[8:11], s51 sc1
  s_waitcnt vmcnt(0)
  v_readfirstlane_b32 s35, v7
  s_add_u32 s36, s36, 1
  s_cmp_ge_u32 s35, 32
  s_cbranch_scc1 L_kf_ok3
  s_sleep 6
  s_cmp_lt_u32 s36, 4194304
  s_cbranch_scc1 L_kf_sp3
  s_branch L_kf_ok3
  L_kf_go4:
  s_mov_b32 s36, 0
  L_kf_sp4:
  buffer_load_dword v7, off, s[8:11], s52 sc1
  s_waitcnt vmcnt(0)
  v_readfirstlane_b32 s35, v7
  s_add_u32 s36, s36, 1
  s_cmp_ge_u32 s35, 8
  s_cbranch_scc1 L_kf_ok4
  s_sleep 6
  s_cmp_lt_u32 s36, 4194304
  s_cbranch_scc1 L_kf_sp4
  s_branch L_kf_ok4
.p2align 4
.type L_kf_tab,@object
L_kf_tab:
.long 737280
.long 811008
.long 884736
.long 958464
.long 1032192
.long 1105920
.long 1179648
.long 1253376
.long 663552
.long 663680
.long 737408
.long 811136
.long 884864
.long 958592
.long 1032320
.long 1106048
.long 1179776
.long 1253504
.long 737536
.long 811264
.long 884992
.long 958720
.long 1032448
.long 1106176
.long 1179904
.long 1253632
.long 663808
.long 663936
.long 737664
.long 811392
.long 885120
.long 958848
.long 1032576
.long 1106304
.long 1180032
.long 1253760
.long 0
.long 4096
.long 8192
.long 12288
.long 57344
.long 16384
.long 20480
.long 24576
.long 61440
.long 28672
.long 32768
.long 36864
.long 40960
.long 65536
.long 45056
.long 49152
.long 53248
.long 69632
.size L_kf_tab, 216
L_code_end:
.section .rodata,"a"
.p2align 6
.amdhsa_kernel qkv_kernel
  .amdhsa_next_free_vgpr 256
  .amdhsa_next_free_sgpr 96
  .amdhsa_accum_offset 256
  .amdhsa_group_segment_fixed_size 0
  .amdhsa_kernarg_size 88
  .amdhsa_user_sgpr_count 2
  .amdhsa_user_sgpr_kernarg_segment_ptr 1
  .amdhsa_system_sgpr_workgroup_id_x 1
  .amdhsa_float_denorm_mode_32 3
.end_amdhsa_kernel
.section .rodata,"a"
.p2align 6
.amdhsa_kernel attn_kernel
  .amdhsa_next_free_vgpr 512
  .amdhsa_next_free_sgpr 96
  .amdhsa_accum_offset 256
  .amdhsa_group_segment_fixed_size 0
  .amdhsa_kernarg_size 88
  .amdhsa_user_sgpr_count 2
  .amdhsa_user_sgpr_kernarg_segment_ptr 1
  .amdhsa_system_sgpr_workgroup_id_x 1
  .amdhsa_float_denorm_mode_32 3
.end_amdhsa_kernel
```
